```python
import torch

def _softmax(x, axis=-1):
    return torch.softmax(x, dim=axis)

def _gelu(x):
    return torch.nn.functional.gelu(x, approximate='tanh')

def _silu(x):
    return torch.nn.functional.silu(x)

def _sigmoid(x):
    return torch.sigmoid(x)

def _layernorm(x, axis=-1, eps=1e-05):
    m = x.mean(dim=axis, keepdim=True)
    v = x.var(dim=axis, keepdim=True, unbiased=False)
    return (x - m) / torch.sqrt(v + eps)

def _scatter_add(tgt, idx, src, axis=0):
    return tgt.clone().index_add_(axis, idx, src)

def _segment_sum(src, seg, n):
    out = torch.zeros((n,) + src.shape[1:], dtype=src.dtype)
    return out.index_add_(0, seg, src)

def _pad(x, pw):
    flat = tuple((v for pair in reversed(pw) for v in pair))
    return torch.nn.functional.pad(x, flat)
kernel_name = 'concat_heads__spectral_gfnet__memory_aug_recurrent_mem_tr__prompt'

def setup_inputs():

    _w = lambda a: (lambda t: t.to(torch.bfloat16) if t.is_floating_point() else t)(torch.as_tensor(a))

    def _A_setup():
        B, S, D = (1, 2048, 512)
        Df = D // 2 + 1
        return {'x': _w((lambda *s: torch.randn(*s, dtype=torch.bfloat16) * 0.05)(B, S, D)), 'w_r': _w((lambda *s: torch.randn(*s, dtype=torch.bfloat16) * 3.2)(S, Df) * 0.02), 'w_i': _w((lambda *s: torch.randn(*s, dtype=torch.bfloat16) * 3.2)(S, Df) * 0.02)}
    _A_in = _A_setup()

    def _B_setup():
        B, S, Dm = (1, 2048, 512)
        H, Dh = (32, 128)
        M, seg = (8, 32)
        seg = min(seg, S)
        S = S // seg * seg
        return {'x': _w((lambda *s: torch.randn(*s, dtype=torch.bfloat16) * 0.05)(B, S, Dm)), 'mem0': _w((lambda *s: torch.randn(*s, dtype=torch.bfloat16) * 0.4)(B, M, Dm)), 'Wq': _w((lambda *s: torch.randn(*s, dtype=torch.bfloat16) * 6.4)(Dm, H, Dh) * Dm ** (-0.5)), 'Wk': _w((lambda *s: torch.randn(*s, dtype=torch.bfloat16) * 6.4)(Dm, H, Dh) * Dm ** (-0.5)), 'Wv': _w((lambda *s: torch.randn(*s, dtype=torch.bfloat16) * 0.4)(Dm, H, Dh) * Dm ** (-0.5)), 'Wo': _w((lambda *s: torch.randn(*s, dtype=torch.bfloat16) * 0.4)(H, Dh, Dm) * (H * Dh) ** (-0.5)), 'seg_len': seg}
    _B_in = _B_setup()
    return {'A_x': _A_in['x'], 'A_w_r': _A_in['w_r'], 'A_w_i': _A_in['w_i'], 'B_x': _B_in['x'], 'B_mem0': _B_in['mem0'], 'B_Wq': _B_in['Wq'], 'B_Wk': _B_in['Wk'], 'B_Wv': _B_in['Wv'], 'B_Wo': _B_in['Wo'], 'B_seg_len': _B_in['seg_len']}

def reference(A_x, A_w_r, A_w_i, B_x, B_mem0, B_Wq, B_Wk, B_Wv, B_Wo, B_seg_len):

    def _A_ref(x, w_r, w_i):
        B, S, D = x.shape
        X = (lambda x, axes=(-2, -1): torch.fft.rfft2(x.float(), dim=axes))(x, axes=(-2, -1))
        W = w_r + 1j * w_i
        X = X * W
        y = (lambda x, s, axes=(-2, -1): torch.fft.irfft2(x, s=s, dim=axes).to(torch.bfloat16))(X, (S, D), axes=(-2, -1))
        return y

    def _B_ref(x, mem0, Wq, Wk, Wv, Wo, seg_len):
        B, S, Dm = x.shape
        H, Dh = (Wq.shape[1], Wq.shape[2])
        M = mem0.shape[1]
        scale = Dh ** (-0.5)
        n_seg = S // seg_len
        L = M + seg_len
        idx = torch.arange(L)
        mask = (idx[:, None] < M) | (idx[:, None] >= idx[None, :])
        mem = mem0
        outs = []
        for s in range(n_seg):
            xs = x[:, s * seg_len:(s + 1) * seg_len, :].clone()
            h = torch.concatenate([mem, xs], axis=1)
            q = torch.einsum('btd,dhe->bhte', h, Wq)
            k = torch.einsum('btd,dhe->bhte', h, Wk)
            v = torch.einsum('btd,dhe->bhte', h, Wv)
            scores = torch.einsum('bhqe,bhke->bhqk', q, k) * scale
            scores = torch.where(mask[None, None], scores, -1000000000.0)
            p = _softmax(scores, axis=-1)
            o = torch.einsum('bhqk,bhke->bhqe', p, v)
            o = torch.einsum('bhte,hed->btd', o, Wo)
            mem = o[:, :M, :].clone()
            outs.append(o[:, M:, :])
        return torch.concatenate(outs, axis=1)
    a = _A_ref(A_x, A_w_r, A_w_i)
    b = _B_ref(B_x, B_mem0, B_Wq, B_Wk, B_Wv, B_Wo, B_seg_len)
    return torch.concatenate([a, b], axis=-1)
```

```asm
; @launch grid=(256,1,1) block=(256,1,1) lds=163840
.amdgcn_target "amdgcn-amd-amdhsa--gfx950"
.text
.globl concat_heads__spectral_gfnet__memory_aug_recurrent_mem_tr__prompt_kernel
.p2align 8
.type concat_heads__spectral_gfnet__memory_aug_recurrent_mem_tr__prompt_kernel,@function
concat_heads__spectral_gfnet__memory_aug_recurrent_mem_tr__prompt_kernel:
    s_cmp_ge_u32 s2, 256
    s_cbranch_scc1 EXIT
    s_load_dwordx16 s[8:23], s[0:1], 0
    s_load_dwordx8 s[24:31], s[0:1], 64
    s_load_dwordx2 s[32:33], s[0:1], 96
    v_lshrrev_b32 v1, 6, v0
    s_getreg_b32 s46, hwreg(HW_REG_XCC_ID, 0, 4)
    v_readfirstlane_b32 s44, v1
    s_waitcnt lgkmcnt(0)
    s_mov_b32 s36, s32
    s_mov_b32 s37, s33
    s_mov_b32 s38, 66060288
    s_mov_b32 s39, 0x20000
    s_xor_b32 s46, s46, 3
    s_lshl_b32 s48, s46, 2
    s_lshr_b32 s48, 0x43216570, s48
    s_and_b32 s48, s48, 7
    s_cmp_lt_u32 s46, 8
    s_cselect_b32 s46, s48, s46
    s_sub_u32 s48, s46, 5
    s_cmp_ge_u32 s48, 2
    s_cbranch_scc1 NOWARM
    s_bfe_u32 s49, s2, 0x50003
    s_lshl_b32 s49, s49, 1
    s_add_u32 s48, s48, s49
    s_lshl_b32 s48, s48, 15
    v_lshlrev_b32 v8, 7, v0
    v_add_u32 v8, s48, v8
    v_add_u32 v9, 2097152, v8
    s_mov_b32 s40, s20
    s_mov_b32 s41, s21
    s_mov_b32 s42, 4194304
    s_mov_b32 s43, 0x20000
    buffer_load_dword v20, v8, s[40:43], 0 offen
    buffer_load_dword v21, v9, s[40:43], 0 offen
    s_mov_b32 s40, s22
    s_mov_b32 s41, s23
    s_mov_b32 s42, 4194304
    s_mov_b32 s43, 0x20000
    buffer_load_dword v22, v8, s[40:43], 0 offen
    buffer_load_dword v23, v9, s[40:43], 0 offen
    s_mov_b32 s40, s18
    s_mov_b32 s41, s19
    s_mov_b32 s42, 4194304
    s_mov_b32 s43, 0x20000
    buffer_load_dword v24, v8, s[40:43], 0 offen
    buffer_load_dword v25, v9, s[40:43], 0 offen
NOWARM:
    v_mov_b32 v2, 163836
    s_cmp_lg_u32 s44, 0
    s_cbranch_scc1 ROLE_OTHER
    s_mov_b64 exec, 1
    v_mov_b32 v3, 1
    s_min_u32 s48, s46, 8
    s_lshl_b32 s49, s48, 2
    s_add_u32 s49, s49, 124
    s_cmp_eq_u32 s48, 0
    s_cselect_b32 s49, 0, s49
    s_cbranch_scc1 TICKET
    s_sleep 8
TICKET:
    v_mov_b32 v4, s49
    global_atomic_add v6, v4, v3, s[30:31] sc0
    s_mov_b64 exec, -1
    s_mov_b32 s40, s20
    s_mov_b32 s41, s21
    s_mov_b32 s42, 4194304
    s_mov_b32 s43, 0x20000
    s_bfe_u32 s49, s2, 0x50003
    s_lshl_b32 s49, s49, 2
    s_add_u32 s49, s49, s44
    s_and_b32 s50, s49, 7
    s_bfe_u32 s51, s49, 0x10003
    s_lshl_b32 s51, s51, 4
    s_add_u32 s50, s50, s51
    s_lshr_b32 s51, s49, 4
    s_lshl_b32 s51, s51, 6
    s_add_u32 s50, s50, s51
    s_lshl_b32 s50, s50, 13
    s_cmp_eq_u32 s46, 0
    s_cselect_b32 s50, s50, 0x40000000
    v_and_b32 v7, 63, v0
    v_lshlrev_b32 v7, 7, v7
    v_add_u32 v7, s50, v7
    buffer_load_dword v250, v7, s[40:43], 0 offen
    v_add_u32 v7, 262144, v7
    s_mov_b64 exec, 1
    s_lshl_b32 s45, s48, 5
    s_waitcnt vmcnt(1)
    v_readfirstlane_b32 s49, v6
    s_nop 0
    s_add_u32 s45, s45, s49
    s_cmp_lt_u32 s49, 32
    s_cselect_b32 s49, s48, 8
    s_cmp_lt_u32 s49, 8
    s_cbranch_scc1 ROLE_SET
    v_mov_b32 v4, 8
    global_atomic_add v6, v4, v3, s[30:31] sc0
    s_waitcnt vmcnt(0)
    v_readfirstlane_b32 s50, v6
    s_mov_b64 exec, -1
    v_mbcnt_lo_u32_b32 v4, -1, 0
    v_and_b32 v4, 15, v4
    v_lshlrev_b32 v4, 2, v4
    v_add_u32 v4, 124, v4
    v_writelane_b32 v4, 0, 0
    s_mov_b32 s51, 0
ROLE_ALL:
    global_load_dword v6, v4, s[30:31] sc1
    s_add_u32 s51, s51, 1
    s_cmp_gt_u32 s51, 65536
    s_cbranch_scc1 ROLE_NONE
    s_waitcnt vmcnt(0)
    v_readlane_b32 s52, v6, 0
    v_readlane_b32 vcc_lo, v6, 1
    s_nop 0
    s_add_u32 s52, s52, vcc_lo
    v_readlane_b32 vcc_lo, v6, 2
    s_nop 0
    s_add_u32 s52, s52, vcc_lo
    v_readlane_b32 vcc_lo, v6, 3
    s_nop 0
    s_add_u32 s52, s52, vcc_lo
    v_readlane_b32 vcc_lo, v6, 4
    s_nop 0
    s_add_u32 s52, s52, vcc_lo
    v_readlane_b32 vcc_lo, v6, 5
    s_nop 0
    s_add_u32 s52, s52, vcc_lo
    v_readlane_b32 vcc_lo, v6, 6
    s_nop 0
    s_add_u32 s52, s52, vcc_lo
    v_readlane_b32 vcc_lo, v6, 7
    s_nop 0
    s_add_u32 s52, s52, vcc_lo
    v_readlane_b32 vcc_lo, v6, 8
    s_nop 0
    s_add_u32 s52, s52, vcc_lo
    s_cmp_lt_u32 s52, 256
    s_cbranch_scc1 ROLE_ALL
    s_mov_b32 s53, 0
ROLE_SCAN:
    v_readlane_b32 s48, v6, s53
    s_nop 0
    s_min_u32 s48, s48, 32
    s_sub_u32 s49, 32, s48
    s_lshl_b32 s45, s53, 5
    s_add_u32 s45, s45, s48
    s_add_u32 s45, s45, s50
    s_cmp_lt_u32 s50, s49
    s_cbranch_scc1 ROLE_SET
    s_sub_u32 s50, s50, s49
    s_add_u32 s53, s53, 1
    s_cmp_lt_u32 s53, 8
    s_cbranch_scc1 ROLE_SCAN
ROLE_NONE:
    s_mov_b32 s45, 256
ROLE_SET:
    v_mov_b32 v3, s45
    ds_write_b32 v2, v3
    s_waitcnt lgkmcnt(0)
    s_mov_b64 exec, -1
    s_branch ROLE_WAIT
ROLE_OTHER:
    s_nop 15
    s_mov_b32 s40, s20
    s_mov_b32 s41, s21
    s_mov_b32 s42, 4194304
    s_mov_b32 s43, 0x20000
    s_bfe_u32 s49, s2, 0x50003
    s_lshl_b32 s49, s49, 2
    s_add_u32 s49, s49, s44
    s_and_b32 s50, s49, 7
    s_bfe_u32 s51, s49, 0x10003
    s_lshl_b32 s51, s51, 4
    s_add_u32 s50, s50, s51
    s_lshr_b32 s51, s49, 4
    s_lshl_b32 s51, s51, 6
    s_add_u32 s50, s50, s51
    s_lshl_b32 s50, s50, 13
    s_cmp_eq_u32 s46, 0
    s_cselect_b32 s50, s50, 0x40000000
    v_and_b32 v7, 63, v0
    v_lshlrev_b32 v7, 7, v7
    v_add_u32 v7, s50, v7
    buffer_load_dword v250, v7, s[40:43], 0 offen
    v_add_u32 v7, 262144, v7
ROLE_WAIT:
    s_waitcnt vmcnt(1)
    s_barrier
    ds_read_b32 v3, v2
    s_waitcnt lgkmcnt(0)
    v_readfirstlane_b32 s45, v3
    s_barrier
    s_cmp_lt_u32 s45, 32
    s_cbranch_scc1 TOCHAIN
    s_waitcnt vmcnt(0)
TOCHAIN:
    s_cmp_ge_u32 s45, 160
    s_cbranch_scc1 REST
    s_cmp_ge_u32 s45, 32
    s_cbranch_scc1 QA
    s_mov_b32 s52, s45
CHAIN:
    v_and_b32 v24, 63, v0
    v_lshlrev_b32 v0, 4, v24
    s_lshl_b32 s54, s44, 11
    v_add_u32 v1, s54, v0
    v_add_u32 v0, 131072, v0
    v_add_u32 v2, 0x10000, v1
    v_add_u32 v3, 131072, v1
    s_mul_i32 s58, s52, 8448
    s_add_u32 s58, s58, 1048576
    s_lshl_b32 s54, s44, 11
    s_sub_u32 s58, s58, s54
    s_add_u32 s59, s58, 4096
    s_lshl_b32 s4, s52, 2
    s_add_u32 s4, s4, 98304
    s_and_b32 s5, s52, 7
    s_lshl_b32 s5, s5, 7
    s_add_u32 s5, s5, 98304
    s_lshl_b32 s6, s52, 7
    s_add_u32 s0, s32, s6
    s_addc_u32 s1, s33, 0
    s_add_u32 s6, s6, 8192
    s_mov_b32 s7, 0
    v_lshrrev_b32 v16, 4, v24
    s_and_b32 s54, s44, 1
    s_lshl_b32 s55, s54, 2
    v_add_u32 v17, s55, v16
    v_lshlrev_b32 v17, 1, v17
    v_and_b32 v18, 15, v24
    v_xor_b32 v17, v17, v18
    v_lshlrev_b32 v17, 4, v17
    v_lshrrev_b32 v18, 1, v16
    v_and_b32 v19, 1, v16
    v_lshlrev_b32 v25, 6, v19
    v_lshl_add_u32 v25, v18, 4, v25
    s_lshl_b32 s55, s44, 1
    v_add_u32 v25, s55, v25
    v_lshl_add_u32 v25, v25, 13, v17
    s_lshl_b32 s55, s52, 8
    v_add_u32 v25, s55, v25
    v_lshl_add_u32 v18, v18, 5, v19
    s_lshl_b32 s54, s54, 4
    s_lshr_b32 s55, s44, 1
    s_lshl_b32 s55, s55, 2
    s_add_u32 s54, s54, s55
    v_add_u32 v18, s54, v18
    s_and_b32 s55, s44, 1
    s_lshl_b32 s55, s55, 3
    v_lshlrev_b32 v19, 2, v19
    v_or_b32 v19, s55, v19
    v_and_b32 v17, 15, v24
    v_xor_b32 v17, v17, v19
    v_lshlrev_b32 v17, 4, v17
    v_and_b32 v19, 128, v17
    v_add_u32 v17, v17, v19
    v_lshl_add_u32 v26, v18, 10, v17
    s_lshl_b32 s55, s52, 17
    v_add_u32 v26, s55, v26
    v_lshrrev_b32 v16, 4, v24
    v_bfe_u32 v17, v24, 2, 2
    v_and_b32 v18, 3, v24
    v_and_b32 v19, 1, v16
    v_lshl_add_u32 v19, v19, 2, v17
    v_lshlrev_b32 v19, 5, v19
    v_lshl_add_u32 v19, v18, 3, v19
    v_lshl_add_u32 v19, v17, 8, v19
    v_lshl_add_u32 v27, v16, 10, v19
    v_and_b32 v20, 1, v17
    v_lshrrev_b32 v21, 1, v17
    v_lshl_add_u32 v21, v20, 1, v21
    v_and_b32 v19, 1, v16
    v_lshl_add_u32 v21, v19, 2, v21
    v_lshlrev_b32 v21, 5, v21
    v_lshl_add_u32 v21, v18, 3, v21
    v_lshl_add_u32 v21, v20, 8, v21
    v_lshl_add_u32 v31, v16, 10, v21
    s_and_b32 s54, s44, 1
    s_mul_i32 s54, s54, 640
    s_lshr_b32 s55, s44, 1
    s_mul_i32 s55, s55, 49152
    s_add_u32 s54, s54, s55
    v_xor_b32 v31, s54, v31
    s_lshl_b32 s56, s44, 10
    s_mov_b32 s40, s20
    s_mov_b32 s41, s21
    s_mov_b32 s42, 4194304
    s_mov_b32 s43, 0x20000
    s_add_u32 m0, s56, 0
    s_mov_b32 s54, 0
    buffer_load_dwordx4 v25, s[40:43], s54 offen lds
    s_add_u32 m0, s56, 4096
    s_mov_b32 s54, 8192
    buffer_load_dwordx4 v25, s[40:43], s54 offen lds
    s_add_u32 m0, s56, 16384
    s_mov_b32 s54, 1048576
    buffer_load_dwordx4 v25, s[40:43], s54 offen lds
    s_add_u32 m0, s56, 20480
    s_mov_b32 s54, 1056768
    buffer_load_dwordx4 v25, s[40:43], s54 offen lds
    s_add_u32 m0, s56, 32768
    s_mov_b32 s54, 2097152
    buffer_load_dwordx4 v25, s[40:43], s54 offen lds
    s_add_u32 m0, s56, 36864
    s_mov_b32 s54, 2105344
    buffer_load_dwordx4 v25, s[40:43], s54 offen lds
    s_add_u32 m0, s56, 49152
    s_mov_b32 s54, 3145728
    buffer_load_dwordx4 v25, s[40:43], s54 offen lds
    s_add_u32 m0, s56, 53248
    s_mov_b32 s54, 3153920
    buffer_load_dwordx4 v25, s[40:43], s54 offen lds
    s_add_u32 m0, s56, 8192
    s_mov_b32 s54, 262144
    buffer_load_dwordx4 v25, s[40:43], s54 offen lds
    s_add_u32 m0, s56, 12288
    s_mov_b32 s54, 270336
    buffer_load_dwordx4 v25, s[40:43], s54 offen lds
    s_add_u32 m0, s56, 24576
    s_mov_b32 s54, 1310720
    buffer_load_dwordx4 v25, s[40:43], s54 offen lds
    s_add_u32 m0, s56, 28672
    s_mov_b32 s54, 1318912
    buffer_load_dwordx4 v25, s[40:43], s54 offen lds
    s_add_u32 m0, s56, 40960
    s_mov_b32 s54, 2359296
    buffer_load_dwordx4 v25, s[40:43], s54 offen lds
    s_add_u32 m0, s56, 45056
    s_mov_b32 s54, 2367488
    buffer_load_dwordx4 v25, s[40:43], s54 offen lds
    s_add_u32 m0, s56, 57344
    s_mov_b32 s54, 3407872
    buffer_load_dwordx4 v25, s[40:43], s54 offen lds
    s_add_u32 m0, s56, 61440
    s_mov_b32 s54, 3416064
    buffer_load_dwordx4 v25, s[40:43], s54 offen lds
    s_add_u32 m0, s56, 65536
    s_mov_b32 s54, 65536
    buffer_load_dwordx4 v25, s[40:43], s54 offen lds
    s_add_u32 m0, s56, 69632
    s_mov_b32 s54, 73728
    buffer_load_dwordx4 v25, s[40:43], s54 offen lds
    s_add_u32 m0, s56, 81920
    s_mov_b32 s54, 1114112
    buffer_load_dwordx4 v25, s[40:43], s54 offen lds
    s_add_u32 m0, s56, 86016
    s_mov_b32 s54, 1122304
    buffer_load_dwordx4 v25, s[40:43], s54 offen lds
    s_add_u32 m0, s56, 98304
    s_mov_b32 s54, 2162688
    buffer_load_dwordx4 v25, s[40:43], s54 offen lds
    s_add_u32 m0, s56, 102400
    s_mov_b32 s54, 2170880
    buffer_load_dwordx4 v25, s[40:43], s54 offen lds
    s_add_u32 m0, s56, 114688
    s_mov_b32 s54, 3211264
    buffer_load_dwordx4 v25, s[40:43], s54 offen lds
    s_add_u32 m0, s56, 118784
    s_mov_b32 s54, 3219456
    buffer_load_dwordx4 v25, s[40:43], s54 offen lds
    s_add_u32 m0, s56, 73728
    s_mov_b32 s54, 327680
    buffer_load_dwordx4 v25, s[40:43], s54 offen lds
    s_add_u32 m0, s56, 77824
    s_mov_b32 s54, 335872
    buffer_load_dwordx4 v25, s[40:43], s54 offen lds
    s_add_u32 m0, s56, 90112
    s_mov_b32 s54, 1376256
    buffer_load_dwordx4 v25, s[40:43], s54 offen lds
    s_add_u32 m0, s56, 94208
    s_mov_b32 s54, 1384448
    buffer_load_dwordx4 v25, s[40:43], s54 offen lds
    s_add_u32 m0, s56, 106496
    s_mov_b32 s54, 2424832
    buffer_load_dwordx4 v25, s[40:43], s54 offen lds
    s_add_u32 m0, s56, 110592
    s_mov_b32 s54, 2433024
    buffer_load_dwordx4 v25, s[40:43], s54 offen lds
    s_add_u32 m0, s56, 122880
    s_mov_b32 s54, 3473408
    buffer_load_dwordx4 v25, s[40:43], s54 offen lds
    s_add_u32 m0, s56, 126976
    s_mov_b32 s54, 3481600
    buffer_load_dwordx4 v25, s[40:43], s54 offen lds
    v_and_b32 v16, 15, v24
    v_lshrrev_b32 v17, 4, v24
    v_and_b32 v18, 3, v24
    v_bfe_u32 v19, v24, 2, 2
    s_lshl_b32 s54, s44, 8
    s_add_u32 s55, s54, 155648
    v_mul_u32_u24 v21, 1088, v17
    v_lshl_add_u32 v21, v16, 3, v21
    v_add_u32 v4, s55, v21
    v_and_b32 v20, 1, v17
    v_lshl_add_u32 v20, v20, 2, v19
    v_lshrrev_b32 v21, 1, v17
    v_lshl_add_u32 v20, v21, 4, v20
    v_mul_u32_u24 v21, 1088, v18
    v_lshl_add_u32 v20, v20, 3, v21
    v_add_u32 v5, 155648, v20
    v_and_b32 v10, 31, v24
    v_lshlrev_b32 v10, 2, v10
    v_cmp_lt_u32 vcc, 1, v18
    v_mov_b32 v21, 0x4444
    v_mov_b32 v22, 0xeeee
    v_cndmask_b32 v7, v21, v22, vcc
    v_and_b32 v20, 1, v24
    v_lshl_add_u32 v23, v19, 1, v20
    v_lshlrev_b32 v20, 4, v23
    v_lshl_add_u32 v20, v17, 7, v20
    s_lshl_b32 s54, s44, 9
    s_add_u32 s54, s54, 131072
    v_add_u32 v6, s54, v20
    v_mov_b32 v22, 0x80000000
    v_bfe_u32 v20, v24, 2, 1
    v_bfe_u32 v21, v24, 3, 1
    v_lshl_add_u32 v9, v20, 1, v21
    v_lshl_add_u32 v9, v9, 2, v18
    v_lshlrev_b32 v9, 2, v9
    v_lshl_add_u32 v9, v17, 8, v9
    s_lshr_b32 s54, s52, 3
    s_lshl_b32 s54, s54, 10
    s_and_b32 s55, s52, 1
    s_lshl_b32 s55, s55, 12
    s_add_u32 s54, s54, s55
    s_and_b32 s55, s52, 6
    s_lshl_b32 s55, s55, 5
    s_add_u32 s54, s54, s55
    s_cmp_eq_u32 s44, 0
    s_cselect_b32 s54, s54, 0x80000000
    v_add_u32 v9, s54, v9
    v_lshl_add_u32 v21, v17, 1, v21
    s_lshl_b32 s55, s44, 3
    v_add_u32 v21, s55, v21
    v_mul_u32_u24 v21, 8448, v21
    v_lshl_add_u32 v21, v18, 4, v21
    v_lshl_add_u32 v21, v20, 3, v21
    s_lshl_b32 s54, s52, 6
    v_add_u32 v8, s54, v21
    v_and_b32 v21, 1, v24
    v_lshlrev_b32 v21, 4, v21
    v_mov_b32 v22, 0x3f80
    v_lshlrev_b32 v21, v21, v22
    v_bfe_u32 v22, v24, 1, 3
    v_cmp_eq_u32 vcc, 4, v22
    s_nop 1
    v_cndmask_b32 v12, 0, v21, vcc
    v_cmp_eq_u32 vcc, 5, v22
    s_nop 1
    v_cndmask_b32 v13, 0, v21, vcc
    v_cmp_eq_u32 vcc, 6, v22
    s_nop 1
    v_cndmask_b32 v14, 0, v21, vcc
    v_cmp_eq_u32 vcc, 7, v22
    s_nop 1
    v_cndmask_b32 v15, 0, v21, vcc
    ds_write_b128 v0, v[12:15] offset:30208
    s_waitcnt lgkmcnt(0)
    v_cmp_eq_u32 vcc, 0, v22
    s_nop 1
    v_cndmask_b32 v12, 0, v21, vcc
    v_cmp_eq_u32 vcc, 1, v22
    s_nop 1
    v_cndmask_b32 v13, 0, v21, vcc
    v_cmp_eq_u32 vcc, 2, v22
    s_nop 1
    v_cndmask_b32 v14, 0, v21, vcc
    v_cmp_eq_u32 vcc, 3, v22
    s_nop 1
    v_cndmask_b32 v15, 0, v21, vcc
    ds_write_b128 v0, v[12:15] offset:28928
    s_waitcnt lgkmcnt(0)
    v_mov_b64 v[12:13], 0
    v_mov_b64 v[14:15], 0
    s_mov_b32 s53, -1
    s_lshl_b32 s54, s52, 13
    s_add_u32 s63, s54, 2097152
    s_add_u32 s64, s54, 18612224
    s_mov_b32 s65, 37224448
    s_mov_b32 s48, 0x3e0293ee
    s_mov_b32 s49, 0x3e0293ee
    s_mov_b32 s50, 0x3f803f80
    s_mov_b32 s51, 0x3f803f80
    s_lshl_b32 s54, s44, 11
    s_add_u32 s47, s54, 131072
    s_mov_b32 s60, 16384
    s_add_u32 s69, s64, s54
    s_add_u32 s69, s69, 0
    s_lshl_b32 s61, s52, 8
    s_add_u32 s61, s61, 32768
    s_lshl_b32 s90, s44, 10
    s_sub_u32 s90, 65536, s90
    s_mov_b32 s62, s90
    s_add_u32 s91, s90, 3072
    s_mov_b32 s67, 0
    s_cmp_eq_u32 s44, 0
    s_cselect_b32 s12, 0xff, 0
    s_mov_b32 s13, 0
    s_mov_b32 s98, 1048576
    s_mov_b32 s99, 1050624
    s_mov_b32 s100, 1052672
    s_mov_b32 s101, 1054720
    s_lshl_b32 s54, s44, 6
    v_add_u32 v16, s54, v24
    v_bfe_u32 v17, v16, 1, 3
    v_bfe_u32 v18, v16, 4, 1
    v_lshl_add_u32 v17, v18, 4, v17
    v_lshrrev_b32 v18, 5, v16
    v_lshl_add_u32 v17, v18, 6, v17
    v_and_b32 v19, 1, v16
    v_lshlrev_b32 v19, 7, v19
    v_lshl_add_u32 v30, v17, 13, v19
    v_bfe_u32 v17, v16, 2, 3
    v_lshl_add_u32 v17, v18, 4, v17
    v_and_b32 v19, 3, v16
    v_lshlrev_b32 v19, 8, v19
    v_lshl_add_u32 v14, v17, 10, v19
    s_lshl_b32 s54, s44, 6
    s_add_u32 s54, s54, 0
    s_xor_b32 s55, s44, 0
    s_lshl_b32 s55, s55, 14
    v_xor_b32 v16, s54, v27
    v_add_u32 v16, s55, v16
    s_lshl_b32 s54, s44, 6
    s_add_u32 s54, s54, 0
    s_xor_b32 s55, s44, 1
    s_lshl_b32 s55, s55, 14
    v_xor_b32 v17, s54, v27
    v_add_u32 v17, s55, v17
    s_lshl_b32 s54, s44, 6
    s_add_u32 s54, s54, 0
    s_xor_b32 s55, s44, 2
    s_lshl_b32 s55, s55, 14
    v_xor_b32 v18, s54, v27
    v_add_u32 v18, s55, v18
    s_lshl_b32 s54, s44, 6
    s_add_u32 s54, s54, 0
    s_xor_b32 s55, s44, 3
    s_lshl_b32 s55, s55, 14
    v_xor_b32 v19, s54, v27
    v_add_u32 v19, s55, v19
    s_lshl_b32 s54, s44, 6
    s_add_u32 s54, s54, 32
    s_xor_b32 s55, s44, 0
    s_lshl_b32 s55, s55, 14
    v_xor_b32 v20, s54, v27
    v_add_u32 v20, s55, v20
    s_lshl_b32 s54, s44, 6
    s_add_u32 s54, s54, 32
    s_xor_b32 s55, s44, 1
    s_lshl_b32 s55, s55, 14
    v_xor_b32 v21, s54, v27
    v_add_u32 v21, s55, v21
    s_lshl_b32 s54, s44, 6
    s_add_u32 s54, s54, 32
    s_xor_b32 s55, s44, 2
    s_lshl_b32 s55, s55, 14
    v_xor_b32 v22, s54, v27
    v_add_u32 v22, s55, v22
    s_lshl_b32 s54, s44, 6
    s_add_u32 s54, s54, 32
    s_xor_b32 s55, s44, 3
    s_lshl_b32 s55, s55, 14
    v_xor_b32 v23, s54, v27
    v_add_u32 v23, s55, v23
    s_waitcnt vmcnt(24)
    s_barrier
    ds_read_b64_tr_b16 v[104:105], v16 offset:0
    ds_read_b64_tr_b16 v[106:107], v16 offset:4096
    ds_read_b64_tr_b16 v[200:201], v17 offset:0
    ds_read_b64_tr_b16 v[202:203], v17 offset:4096
    ds_read_b64_tr_b16 v[224:225], v18 offset:0
    ds_read_b64_tr_b16 v[226:227], v18 offset:4096
    ds_read_b64_tr_b16 v[248:249], v19 offset:0
    ds_read_b64_tr_b16 v[250:251], v19 offset:4096
    ds_read_b64_tr_b16 v[120:121], v20 offset:0
    ds_read_b64_tr_b16 v[122:123], v20 offset:4096
    ds_read_b64_tr_b16 a[48:49], v21 offset:0
    ds_read_b64_tr_b16 a[50:51], v21 offset:4096
    ds_read_b64_tr_b16 a[56:57], v22 offset:0
    ds_read_b64_tr_b16 a[58:59], v22 offset:4096
    ds_read_b64_tr_b16 a[64:65], v23 offset:0
    ds_read_b64_tr_b16 a[66:67], v23 offset:4096
    s_waitcnt lgkmcnt(0)
    s_barrier
    s_mov_b32 s40, s22
    s_mov_b32 s41, s23
    s_mov_b32 s42, 4194304
    s_mov_b32 s43, 0x20000
    s_add_u32 m0, s56, 0
    s_mov_b32 s54, 0
    buffer_load_dwordx4 v25, s[40:43], s54 offen lds
    s_add_u32 m0, s56, 4096
    s_mov_b32 s54, 8192
    buffer_load_dwordx4 v25, s[40:43], s54 offen lds
    s_add_u32 m0, s56, 16384
    s_mov_b32 s54, 1048576
    buffer_load_dwordx4 v25, s[40:43], s54 offen lds
    s_add_u32 m0, s56, 20480
    s_mov_b32 s54, 1056768
    buffer_load_dwordx4 v25, s[40:43], s54 offen lds
    s_add_u32 m0, s56, 32768
    s_mov_b32 s54, 2097152
    buffer_load_dwordx4 v25, s[40:43], s54 offen lds
    s_add_u32 m0, s56, 36864
    s_mov_b32 s54, 2105344
    buffer_load_dwordx4 v25, s[40:43], s54 offen lds
    s_add_u32 m0, s56, 49152
    s_mov_b32 s54, 3145728
    buffer_load_dwordx4 v25, s[40:43], s54 offen lds
    s_add_u32 m0, s56, 53248
    s_mov_b32 s54, 3153920
    buffer_load_dwordx4 v25, s[40:43], s54 offen lds
    s_waitcnt vmcnt(24)
    s_barrier
    ds_read_b64_tr_b16 v[108:109], v16 offset:8192
    ds_read_b64_tr_b16 v[110:111], v16 offset:12288
    ds_read_b64_tr_b16 v[204:205], v17 offset:8192
    ds_read_b64_tr_b16 v[206:207], v17 offset:12288
    ds_read_b64_tr_b16 v[228:229], v18 offset:8192
    ds_read_b64_tr_b16 v[230:231], v18 offset:12288
    ds_read_b64_tr_b16 v[252:253], v19 offset:8192
    ds_read_b64_tr_b16 v[254:255], v19 offset:12288
    ds_read_b64_tr_b16 v[124:125], v20 offset:8192
    ds_read_b64_tr_b16 v[126:127], v20 offset:12288
    ds_read_b64_tr_b16 a[52:53], v21 offset:8192
    ds_read_b64_tr_b16 a[54:55], v21 offset:12288
    ds_read_b64_tr_b16 a[60:61], v22 offset:8192
    ds_read_b64_tr_b16 a[62:63], v22 offset:12288
    ds_read_b64_tr_b16 a[68:69], v23 offset:8192
    ds_read_b64_tr_b16 a[70:71], v23 offset:12288
    s_waitcnt lgkmcnt(0)
    s_barrier
    s_add_u32 m0, s56, 8192
    s_mov_b32 s54, 262144
    buffer_load_dwordx4 v25, s[40:43], s54 offen lds
    s_add_u32 m0, s56, 12288
    s_mov_b32 s54, 270336
    buffer_load_dwordx4 v25, s[40:43], s54 offen lds
    s_add_u32 m0, s56, 24576
    s_mov_b32 s54, 1310720
    buffer_load_dwordx4 v25, s[40:43], s54 offen lds
    s_add_u32 m0, s56, 28672
    s_mov_b32 s54, 1318912
    buffer_load_dwordx4 v25, s[40:43], s54 offen lds
    s_add_u32 m0, s56, 40960
    s_mov_b32 s54, 2359296
    buffer_load_dwordx4 v25, s[40:43], s54 offen lds
    s_add_u32 m0, s56, 45056
    s_mov_b32 s54, 2367488
    buffer_load_dwordx4 v25, s[40:43], s54 offen lds
    s_add_u32 m0, s56, 57344
    s_mov_b32 s54, 3407872
    buffer_load_dwordx4 v25, s[40:43], s54 offen lds
    s_add_u32 m0, s56, 61440
    s_mov_b32 s54, 3416064
    buffer_load_dwordx4 v25, s[40:43], s54 offen lds
    v_xor_b32 v16, 0x10000, v16
    v_xor_b32 v17, 0x10000, v17
    v_xor_b32 v18, 0x10000, v18
    v_xor_b32 v19, 0x10000, v19
    v_xor_b32 v20, 0x10000, v20
    v_xor_b32 v21, 0x10000, v21
    v_xor_b32 v22, 0x10000, v22
    v_xor_b32 v23, 0x10000, v23
    s_waitcnt vmcnt(24)
    s_barrier
    ds_read_b64_tr_b16 v[152:153], v16 offset:0
    ds_read_b64_tr_b16 v[154:155], v16 offset:4096
    ds_read_b64_tr_b16 a[16:17], v17 offset:0
    ds_read_b64_tr_b16 a[18:19], v17 offset:4096
    ds_read_b64_tr_b16 v[72:73], v18 offset:0
    ds_read_b64_tr_b16 v[74:75], v18 offset:4096
    ds_read_b64_tr_b16 v[88:89], v19 offset:0
    ds_read_b64_tr_b16 v[90:91], v19 offset:4096
    ds_read_b64_tr_b16 v[168:169], v20 offset:0
    ds_read_b64_tr_b16 v[170:171], v20 offset:4096
    ds_read_b64_tr_b16 a[72:73], v21 offset:0
    ds_read_b64_tr_b16 a[74:75], v21 offset:4096
    ds_read_b64_tr_b16 a[80:81], v22 offset:0
    ds_read_b64_tr_b16 a[82:83], v22 offset:4096
    ds_read_b64_tr_b16 a[88:89], v23 offset:0
    ds_read_b64_tr_b16 a[90:91], v23 offset:4096
    s_waitcnt lgkmcnt(0)
    s_barrier
    s_add_u32 m0, s56, 65536
    s_mov_b32 s54, 65536
    buffer_load_dwordx4 v25, s[40:43], s54 offen lds
    s_add_u32 m0, s56, 69632
    s_mov_b32 s54, 73728
    buffer_load_dwordx4 v25, s[40:43], s54 offen lds
    s_add_u32 m0, s56, 81920
    s_mov_b32 s54, 1114112
    buffer_load_dwordx4 v25, s[40:43], s54 offen lds
    s_add_u32 m0, s56, 86016
    s_mov_b32 s54, 1122304
    buffer_load_dwordx4 v25, s[40:43], s54 offen lds
    s_add_u32 m0, s56, 98304
    s_mov_b32 s54, 2162688
    buffer_load_dwordx4 v25, s[40:43], s54 offen lds
    s_add_u32 m0, s56, 102400
    s_mov_b32 s54, 2170880
    buffer_load_dwordx4 v25, s[40:43], s54 offen lds
    s_add_u32 m0, s56, 114688
    s_mov_b32 s54, 3211264
    buffer_load_dwordx4 v25, s[40:43], s54 offen lds
    s_add_u32 m0, s56, 118784
    s_mov_b32 s54, 3219456
    buffer_load_dwordx4 v25, s[40:43], s54 offen lds
    s_waitcnt vmcnt(24)
    s_barrier
    ds_read_b64_tr_b16 v[156:157], v16 offset:8192
    ds_read_b64_tr_b16 v[158:159], v16 offset:12288
    ds_read_b64_tr_b16 a[20:21], v17 offset:8192
    ds_read_b64_tr_b16 a[22:23], v17 offset:12288
    ds_read_b64_tr_b16 v[76:77], v18 offset:8192
    ds_read_b64_tr_b16 v[78:79], v18 offset:12288
    ds_read_b64_tr_b16 v[92:93], v19 offset:8192
    ds_read_b64_tr_b16 v[94:95], v19 offset:12288
    ds_read_b64_tr_b16 v[172:173], v20 offset:8192
    ds_read_b64_tr_b16 v[174:175], v20 offset:12288
    ds_read_b64_tr_b16 a[76:77], v21 offset:8192
    ds_read_b64_tr_b16 a[78:79], v21 offset:12288
    ds_read_b64_tr_b16 a[84:85], v22 offset:8192
    ds_read_b64_tr_b16 a[86:87], v22 offset:12288
    ds_read_b64_tr_b16 a[92:93], v23 offset:8192
    ds_read_b64_tr_b16 a[94:95], v23 offset:12288
    s_waitcnt lgkmcnt(0)
    s_barrier
    s_add_u32 m0, s56, 73728
    s_mov_b32 s54, 327680
    buffer_load_dwordx4 v25, s[40:43], s54 offen lds
    s_add_u32 m0, s56, 77824
    s_mov_b32 s54, 335872
    buffer_load_dwordx4 v25, s[40:43], s54 offen lds
    s_add_u32 m0, s56, 90112
    s_mov_b32 s54, 1376256
    buffer_load_dwordx4 v25, s[40:43], s54 offen lds
    s_add_u32 m0, s56, 94208
    s_mov_b32 s54, 1384448
    buffer_load_dwordx4 v25, s[40:43], s54 offen lds
    s_add_u32 m0, s56, 106496
    s_mov_b32 s54, 2424832
    buffer_load_dwordx4 v25, s[40:43], s54 offen lds
    s_add_u32 m0, s56, 110592
    s_mov_b32 s54, 2433024
    buffer_load_dwordx4 v25, s[40:43], s54 offen lds
    s_add_u32 m0, s56, 122880
    s_mov_b32 s54, 3473408
    buffer_load_dwordx4 v25, s[40:43], s54 offen lds
    s_add_u32 m0, s56, 126976
    s_mov_b32 s54, 3481600
    buffer_load_dwordx4 v25, s[40:43], s54 offen lds
    v_xor_b32 v16, 0x10000, v16
    v_xor_b32 v17, 0x10000, v17
    v_xor_b32 v18, 0x10000, v18
    v_xor_b32 v19, 0x10000, v19
    v_xor_b32 v20, 0x10000, v20
    v_xor_b32 v21, 0x10000, v21
    v_xor_b32 v22, 0x10000, v22
    v_xor_b32 v23, 0x10000, v23
    s_waitcnt vmcnt(24)
    s_barrier
    ds_read_b64_tr_b16 v[128:129], v16 offset:0
    ds_read_b64_tr_b16 v[130:131], v16 offset:4096
    ds_read_b64_tr_b16 a[96:97], v17 offset:0
    ds_read_b64_tr_b16 a[98:99], v17 offset:4096
    ds_read_b64_tr_b16 v[48:49], v18 offset:0
    ds_read_b64_tr_b16 v[50:51], v18 offset:4096
    ds_read_b64_tr_b16 a[128:129], v19 offset:0
    ds_read_b64_tr_b16 a[130:131], v19 offset:4096
    ds_read_b64_tr_b16 v[136:137], v20 offset:0
    ds_read_b64_tr_b16 v[138:139], v20 offset:4096
    ds_read_b64_tr_b16 a[104:105], v21 offset:0
    ds_read_b64_tr_b16 a[106:107], v21 offset:4096
    ds_read_b64_tr_b16 v[56:57], v22 offset:0
    ds_read_b64_tr_b16 v[58:59], v22 offset:4096
    ds_read_b64_tr_b16 a[136:137], v23 offset:0
    ds_read_b64_tr_b16 a[138:139], v23 offset:4096
    s_waitcnt lgkmcnt(0)
    s_barrier
    s_mov_b32 s40, s18
    s_mov_b32 s41, s19
    s_mov_b32 s42, 4194304
    s_mov_b32 s43, 0x20000
    s_add_u32 m0, s56, 0
    s_mov_b32 s54, 0
    buffer_load_dwordx4 v25, s[40:43], s54 offen lds
    s_add_u32 m0, s56, 4096
    s_mov_b32 s54, 8192
    buffer_load_dwordx4 v25, s[40:43], s54 offen lds
    s_add_u32 m0, s56, 16384
    s_mov_b32 s54, 1048576
    buffer_load_dwordx4 v25, s[40:43], s54 offen lds
    s_add_u32 m0, s56, 20480
    s_mov_b32 s54, 1056768
    buffer_load_dwordx4 v25, s[40:43], s54 offen lds
    s_add_u32 m0, s56, 32768
    s_mov_b32 s54, 2097152
    buffer_load_dwordx4 v25, s[40:43], s54 offen lds
    s_add_u32 m0, s56, 36864
    s_mov_b32 s54, 2105344
    buffer_load_dwordx4 v25, s[40:43], s54 offen lds
    s_add_u32 m0, s56, 49152
    s_mov_b32 s54, 3145728
    buffer_load_dwordx4 v25, s[40:43], s54 offen lds
    s_add_u32 m0, s56, 53248
    s_mov_b32 s54, 3153920
    buffer_load_dwordx4 v25, s[40:43], s54 offen lds
    s_waitcnt vmcnt(24)
    s_barrier
    ds_read_b64_tr_b16 v[132:133], v16 offset:8192
    ds_read_b64_tr_b16 v[134:135], v16 offset:12288
    ds_read_b64_tr_b16 a[100:101], v17 offset:8192
    ds_read_b64_tr_b16 a[102:103], v17 offset:12288
    ds_read_b64_tr_b16 v[52:53], v18 offset:8192
    ds_read_b64_tr_b16 v[54:55], v18 offset:12288
    ds_read_b64_tr_b16 a[132:133], v19 offset:8192
    ds_read_b64_tr_b16 a[134:135], v19 offset:12288
    ds_read_b64_tr_b16 v[140:141], v20 offset:8192
    ds_read_b64_tr_b16 v[142:143], v20 offset:12288
    ds_read_b64_tr_b16 a[108:109], v21 offset:8192
    ds_read_b64_tr_b16 a[110:111], v21 offset:12288
    ds_read_b64_tr_b16 v[60:61], v22 offset:8192
    ds_read_b64_tr_b16 v[62:63], v22 offset:12288
    ds_read_b64_tr_b16 a[140:141], v23 offset:8192
    ds_read_b64_tr_b16 a[142:143], v23 offset:12288
    s_waitcnt lgkmcnt(0)
    s_barrier
    v_mov_b32 v12, 0
    global_load_dwordx2 v[28:29], v12, s[30:31] sc1
    s_add_u32 m0, s56, 8192
    s_mov_b32 s54, 262144
    buffer_load_dwordx4 v25, s[40:43], s54 offen lds
    s_add_u32 m0, s56, 12288
    s_mov_b32 s54, 270336
    buffer_load_dwordx4 v25, s[40:43], s54 offen lds
    s_add_u32 m0, s56, 24576
    s_mov_b32 s54, 1310720
    buffer_load_dwordx4 v25, s[40:43], s54 offen lds
    s_add_u32 m0, s56, 28672
    s_mov_b32 s54, 1318912
    buffer_load_dwordx4 v25, s[40:43], s54 offen lds
    s_add_u32 m0, s56, 40960
    s_mov_b32 s54, 2359296
    buffer_load_dwordx4 v25, s[40:43], s54 offen lds
    s_add_u32 m0, s56, 45056
    s_mov_b32 s54, 2367488
    buffer_load_dwordx4 v25, s[40:43], s54 offen lds
    s_add_u32 m0, s56, 57344
    s_mov_b32 s54, 3407872
    buffer_load_dwordx4 v25, s[40:43], s54 offen lds
    s_add_u32 m0, s56, 61440
    s_mov_b32 s54, 3416064
    buffer_load_dwordx4 v25, s[40:43], s54 offen lds
    v_xor_b32 v16, 0x10000, v16
    v_xor_b32 v17, 0x10000, v17
    v_xor_b32 v18, 0x10000, v18
    v_xor_b32 v19, 0x10000, v19
    v_xor_b32 v20, 0x10000, v20
    v_xor_b32 v21, 0x10000, v21
    v_xor_b32 v22, 0x10000, v22
    v_xor_b32 v23, 0x10000, v23
    s_waitcnt vmcnt(24)
    s_barrier
    ds_read_b64_tr_b16 v[176:177], v16 offset:0
    ds_read_b64_tr_b16 v[178:179], v16 offset:4096
    ds_read_b64_tr_b16 v[32:33], v17 offset:0
    ds_read_b64_tr_b16 v[34:35], v17 offset:4096
    ds_read_b64_tr_b16 a[112:113], v18 offset:0
    ds_read_b64_tr_b16 a[114:115], v18 offset:4096
    ds_read_b64_tr_b16 a[144:145], v19 offset:0
    ds_read_b64_tr_b16 a[146:147], v19 offset:4096
    ds_read_b64_tr_b16 v[184:185], v20 offset:0
    ds_read_b64_tr_b16 v[186:187], v20 offset:4096
    ds_read_b64_tr_b16 v[40:41], v21 offset:0
    ds_read_b64_tr_b16 v[42:43], v21 offset:4096
    ds_read_b64_tr_b16 a[120:121], v22 offset:0
    ds_read_b64_tr_b16 a[122:123], v22 offset:4096
    ds_read_b64_tr_b16 a[152:153], v23 offset:0
    ds_read_b64_tr_b16 a[154:155], v23 offset:4096
    s_waitcnt lgkmcnt(0)
    s_barrier
    s_add_u32 m0, s56, 65536
    s_mov_b32 s54, 65536
    buffer_load_dwordx4 v25, s[40:43], s54 offen lds
    s_add_u32 m0, s56, 69632
    s_mov_b32 s54, 73728
    buffer_load_dwordx4 v25, s[40:43], s54 offen lds
    s_add_u32 m0, s56, 81920
    s_mov_b32 s54, 1114112
    buffer_load_dwordx4 v25, s[40:43], s54 offen lds
    s_add_u32 m0, s56, 86016
    s_mov_b32 s54, 1122304
    buffer_load_dwordx4 v25, s[40:43], s54 offen lds
    s_add_u32 m0, s56, 98304
    s_mov_b32 s54, 2162688
    buffer_load_dwordx4 v25, s[40:43], s54 offen lds
    s_add_u32 m0, s56, 102400
    s_mov_b32 s54, 2170880
    buffer_load_dwordx4 v25, s[40:43], s54 offen lds
    s_add_u32 m0, s56, 114688
    s_mov_b32 s54, 3211264
    buffer_load_dwordx4 v25, s[40:43], s54 offen lds
    s_add_u32 m0, s56, 118784
    s_mov_b32 s54, 3219456
    buffer_load_dwordx4 v25, s[40:43], s54 offen lds
    s_waitcnt vmcnt(24)
    s_barrier
    ds_read_b64_tr_b16 v[180:181], v16 offset:8192
    ds_read_b64_tr_b16 v[182:183], v16 offset:12288
    ds_read_b64_tr_b16 v[36:37], v17 offset:8192
    ds_read_b64_tr_b16 v[38:39], v17 offset:12288
    ds_read_b64_tr_b16 a[116:117], v18 offset:8192
    ds_read_b64_tr_b16 a[118:119], v18 offset:12288
    ds_read_b64_tr_b16 a[148:149], v19 offset:8192
    ds_read_b64_tr_b16 a[150:151], v19 offset:12288
    ds_read_b64_tr_b16 v[188:189], v20 offset:8192
    ds_read_b64_tr_b16 v[190:191], v20 offset:12288
    ds_read_b64_tr_b16 v[44:45], v21 offset:8192
    ds_read_b64_tr_b16 v[46:47], v21 offset:12288
    ds_read_b64_tr_b16 a[124:125], v22 offset:8192
    ds_read_b64_tr_b16 a[126:127], v22 offset:12288
    ds_read_b64_tr_b16 a[156:157], v23 offset:8192
    ds_read_b64_tr_b16 a[158:159], v23 offset:12288
    s_waitcnt lgkmcnt(0)
    s_barrier
    s_add_u32 m0, s56, 73728
    s_mov_b32 s54, 327680
    buffer_load_dwordx4 v25, s[40:43], s54 offen lds
    s_add_u32 m0, s56, 77824
    s_mov_b32 s54, 335872
    buffer_load_dwordx4 v25, s[40:43], s54 offen lds
    s_add_u32 m0, s56, 90112
    s_mov_b32 s54, 1376256
    buffer_load_dwordx4 v25, s[40:43], s54 offen lds
    s_add_u32 m0, s56, 94208
    s_mov_b32 s54, 1384448
    buffer_load_dwordx4 v25, s[40:43], s54 offen lds
    s_add_u32 m0, s56, 106496
    s_mov_b32 s54, 2424832
    buffer_load_dwordx4 v25, s[40:43], s54 offen lds
    s_add_u32 m0, s56, 110592
    s_mov_b32 s54, 2433024
    buffer_load_dwordx4 v25, s[40:43], s54 offen lds
    s_add_u32 m0, s56, 122880
    s_mov_b32 s54, 3473408
    buffer_load_dwordx4 v25, s[40:43], s54 offen lds
    s_add_u32 m0, s56, 126976
    s_mov_b32 s54, 3481600
    buffer_load_dwordx4 v25, s[40:43], s54 offen lds
    v_xor_b32 v16, 0x10000, v16
    v_xor_b32 v17, 0x10000, v17
    v_xor_b32 v18, 0x10000, v18
    v_xor_b32 v19, 0x10000, v19
    v_xor_b32 v20, 0x10000, v20
    v_xor_b32 v21, 0x10000, v21
    v_xor_b32 v22, 0x10000, v22
    v_xor_b32 v23, 0x10000, v23
    s_waitcnt vmcnt(24)
    s_barrier
    ds_read_b64_tr_b16 v[96:97], v16 offset:0
    ds_read_b64_tr_b16 v[98:99], v16 offset:4096
    ds_read_b64_tr_b16 v[192:193], v17 offset:0
    ds_read_b64_tr_b16 v[194:195], v17 offset:4096
    ds_read_b64_tr_b16 v[216:217], v18 offset:0
    ds_read_b64_tr_b16 v[218:219], v18 offset:4096
    ds_read_b64_tr_b16 v[240:241], v19 offset:0
    ds_read_b64_tr_b16 v[242:243], v19 offset:4096
    ds_read_b64_tr_b16 v[112:113], v20 offset:0
    ds_read_b64_tr_b16 v[114:115], v20 offset:4096
    ds_read_b64_tr_b16 v[208:209], v21 offset:0
    ds_read_b64_tr_b16 v[210:211], v21 offset:4096
    ds_read_b64_tr_b16 v[232:233], v22 offset:0
    ds_read_b64_tr_b16 v[234:235], v22 offset:4096
    ds_read_b64_tr_b16 a[0:1], v23 offset:0
    ds_read_b64_tr_b16 a[2:3], v23 offset:4096
    s_waitcnt lgkmcnt(0)
    s_barrier
    s_mov_b32 s40, s24
    s_mov_b32 s41, s25
    s_mov_b32 s42, 4194304
    s_mov_b32 s43, 0x20000
    s_add_u32 m0, s56, 0
    s_mov_b32 s54, 0
    buffer_load_dwordx4 v26, s[40:43], s54 offen lds
    s_add_u32 m0, s56, 4096
    s_mov_b32 s54, 2048
    buffer_load_dwordx4 v26, s[40:43], s54 offen lds
    s_add_u32 m0, s56, 16384
    s_mov_b32 s54, 65536
    buffer_load_dwordx4 v26, s[40:43], s54 offen lds
    s_add_u32 m0, s56, 20480
    s_mov_b32 s54, 67584
    buffer_load_dwordx4 v26, s[40:43], s54 offen lds
    s_add_u32 m0, s56, 32768
    s_mov_b32 s54, 512
    buffer_load_dwordx4 v26, s[40:43], s54 offen lds
    s_add_u32 m0, s56, 36864
    s_mov_b32 s54, 2560
    buffer_load_dwordx4 v26, s[40:43], s54 offen lds
    s_add_u32 m0, s56, 49152
    s_mov_b32 s54, 66048
    buffer_load_dwordx4 v26, s[40:43], s54 offen lds
    s_add_u32 m0, s56, 53248
    s_mov_b32 s54, 68096
    buffer_load_dwordx4 v26, s[40:43], s54 offen lds
    s_waitcnt vmcnt(24)
    s_barrier
    ds_read_b64_tr_b16 v[100:101], v16 offset:8192
    ds_read_b64_tr_b16 v[102:103], v16 offset:12288
    ds_read_b64_tr_b16 v[196:197], v17 offset:8192
    ds_read_b64_tr_b16 v[198:199], v17 offset:12288
    ds_read_b64_tr_b16 v[220:221], v18 offset:8192
    ds_read_b64_tr_b16 v[222:223], v18 offset:12288
    ds_read_b64_tr_b16 v[244:245], v19 offset:8192
    ds_read_b64_tr_b16 v[246:247], v19 offset:12288
    ds_read_b64_tr_b16 v[116:117], v20 offset:8192
    ds_read_b64_tr_b16 v[118:119], v20 offset:12288
    ds_read_b64_tr_b16 v[212:213], v21 offset:8192
    ds_read_b64_tr_b16 v[214:215], v21 offset:12288
    ds_read_b64_tr_b16 v[236:237], v22 offset:8192
    ds_read_b64_tr_b16 v[238:239], v22 offset:12288
    ds_read_b64_tr_b16 a[4:5], v23 offset:8192
    ds_read_b64_tr_b16 a[6:7], v23 offset:12288
    s_waitcnt lgkmcnt(0)
    s_barrier
    s_add_u32 m0, s56, 8192
    s_mov_b32 s54, 8192
    buffer_load_dwordx4 v26, s[40:43], s54 offen lds
    s_add_u32 m0, s56, 12288
    s_mov_b32 s54, 10240
    buffer_load_dwordx4 v26, s[40:43], s54 offen lds
    s_add_u32 m0, s56, 24576
    s_mov_b32 s54, 73728
    buffer_load_dwordx4 v26, s[40:43], s54 offen lds
    s_add_u32 m0, s56, 28672
    s_mov_b32 s54, 75776
    buffer_load_dwordx4 v26, s[40:43], s54 offen lds
    s_add_u32 m0, s56, 40960
    s_mov_b32 s54, 8704
    buffer_load_dwordx4 v26, s[40:43], s54 offen lds
    s_add_u32 m0, s56, 45056
    s_mov_b32 s54, 10752
    buffer_load_dwordx4 v26, s[40:43], s54 offen lds
    s_add_u32 m0, s56, 57344
    s_mov_b32 s54, 74240
    buffer_load_dwordx4 v26, s[40:43], s54 offen lds
    s_add_u32 m0, s56, 61440
    s_mov_b32 s54, 76288
    buffer_load_dwordx4 v26, s[40:43], s54 offen lds
    v_xor_b32 v16, 0x10000, v16
    v_xor_b32 v17, 0x10000, v17
    v_xor_b32 v18, 0x10000, v18
    v_xor_b32 v19, 0x10000, v19
    v_xor_b32 v20, 0x10000, v20
    v_xor_b32 v21, 0x10000, v21
    v_xor_b32 v22, 0x10000, v22
    v_xor_b32 v23, 0x10000, v23
    v_readfirstlane_b32 s54, v28
    v_readfirstlane_b32 s55, v29
    s_mov_b32 s35, 1
    s_cmp_ge_u32 s54, 32
    s_cbranch_scc1 CH_MODE
    v_mbcnt_lo_u32_b32 v28, -1, 0
    v_and_b32 v28, 15, v28
    v_lshlrev_b32 v28, 2, v28
    v_add_u32 v28, 124, v28
    v_writelane_b32 v28, 0, 0
    s_mov_b32 s57, 0
CH_ROSTER:
    global_load_dword v29, v28, s[30:31] sc1
    s_add_u32 s57, s57, 1
    s_cmp_gt_u32 s57, 65536
    s_cbranch_scc1 CH_DONE
    s_waitcnt vmcnt(0)
    v_readlane_b32 s54, v29, 0
    s_nop 0
    s_cmp_ge_u32 s54, 32
    s_cbranch_scc1 CH_MODE
    v_readlane_b32 vcc_lo, v29, 1
    s_nop 0
    s_add_u32 s54, s54, vcc_lo
    v_readlane_b32 vcc_lo, v29, 2
    s_nop 0
    s_add_u32 s54, s54, vcc_lo
    v_readlane_b32 vcc_lo, v29, 3
    s_nop 0
    s_add_u32 s54, s54, vcc_lo
    v_readlane_b32 vcc_lo, v29, 4
    s_nop 0
    s_add_u32 s54, s54, vcc_lo
    v_readlane_b32 vcc_lo, v29, 5
    s_nop 0
    s_add_u32 s54, s54, vcc_lo
    v_readlane_b32 vcc_lo, v29, 6
    s_nop 0
    s_add_u32 s54, s54, vcc_lo
    v_readlane_b32 vcc_lo, v29, 7
    s_nop 0
    s_add_u32 s54, s54, vcc_lo
    v_readlane_b32 vcc_lo, v29, 8
    s_nop 0
    s_add_u32 s54, s54, vcc_lo
    s_cmp_lt_u32 s54, 256
    s_cbranch_scc1 CH_ROSTER
    s_mov_b32 s35, 0
CH_MODE:
    s_mov_b32 s57, 0
CH_INIT:
    s_cmp_ge_u32 s55, 128
    s_cbranch_scc1 CH_G2
    global_load_dword v29, v12, s[30:31] offset:4 sc1
    s_add_u32 s57, s57, 1
    s_cmp_gt_u32 s57, 65536
    s_cbranch_scc1 CH_DONE
    s_waitcnt vmcnt(0)
    v_readfirstlane_b32 s55, v29
    s_branch CH_INIT
CH_G2:
    s_waitcnt vmcnt(24)
    s_barrier
    ds_read_b64_tr_b16 v[144:145], v16 offset:0
    ds_read_b64_tr_b16 v[146:147], v16 offset:4096
    ds_read_b64_tr_b16 a[8:9], v17 offset:0
    ds_read_b64_tr_b16 a[10:11], v17 offset:4096
    ds_read_b64_tr_b16 v[64:65], v18 offset:0
    ds_read_b64_tr_b16 v[66:67], v18 offset:4096
    ds_read_b64_tr_b16 v[80:81], v19 offset:0
    ds_read_b64_tr_b16 v[82:83], v19 offset:4096
    ds_read_b64_tr_b16 v[160:161], v20 offset:0
    ds_read_b64_tr_b16 v[162:163], v20 offset:4096
    ds_read_b64_tr_b16 a[24:25], v21 offset:0
    ds_read_b64_tr_b16 a[26:27], v21 offset:4096
    ds_read_b64_tr_b16 a[32:33], v22 offset:0
    ds_read_b64_tr_b16 a[34:35], v22 offset:4096
    ds_read_b64_tr_b16 a[40:41], v23 offset:0
    ds_read_b64_tr_b16 a[42:43], v23 offset:4096
    s_waitcnt lgkmcnt(0)
    s_barrier
    s_add_u32 m0, s56, 65536
    s_mov_b32 s54, 128
    buffer_load_dwordx4 v26, s[40:43], s54 offen lds
    s_add_u32 m0, s56, 69632
    s_mov_b32 s54, 2176
    buffer_load_dwordx4 v26, s[40:43], s54 offen lds
    s_add_u32 m0, s56, 81920
    s_mov_b32 s54, 65664
    buffer_load_dwordx4 v26, s[40:43], s54 offen lds
    s_add_u32 m0, s56, 86016
    s_mov_b32 s54, 67712
    buffer_load_dwordx4 v26, s[40:43], s54 offen lds
    s_add_u32 m0, s56, 98304
    s_mov_b32 s54, 640
    buffer_load_dwordx4 v26, s[40:43], s54 offen lds
    s_add_u32 m0, s56, 102400
    s_mov_b32 s54, 2688
    buffer_load_dwordx4 v26, s[40:43], s54 offen lds
    s_add_u32 m0, s56, 114688
    s_mov_b32 s54, 66176
    buffer_load_dwordx4 v26, s[40:43], s54 offen lds
    s_add_u32 m0, s56, 118784
    s_mov_b32 s54, 68224
    buffer_load_dwordx4 v26, s[40:43], s54 offen lds
    s_waitcnt vmcnt(24)
    s_barrier
    ds_read_b64_tr_b16 v[148:149], v16 offset:8192
    ds_read_b64_tr_b16 v[150:151], v16 offset:12288
    ds_read_b64_tr_b16 a[12:13], v17 offset:8192
    ds_read_b64_tr_b16 a[14:15], v17 offset:12288
    ds_read_b64_tr_b16 v[68:69], v18 offset:8192
    ds_read_b64_tr_b16 v[70:71], v18 offset:12288
    ds_read_b64_tr_b16 v[84:85], v19 offset:8192
    ds_read_b64_tr_b16 v[86:87], v19 offset:12288
    ds_read_b64_tr_b16 v[164:165], v20 offset:8192
    ds_read_b64_tr_b16 v[166:167], v20 offset:12288
    ds_read_b64_tr_b16 a[28:29], v21 offset:8192
    ds_read_b64_tr_b16 a[30:31], v21 offset:12288
    ds_read_b64_tr_b16 a[36:37], v22 offset:8192
    ds_read_b64_tr_b16 a[38:39], v22 offset:12288
    ds_read_b64_tr_b16 a[44:45], v23 offset:8192
    ds_read_b64_tr_b16 a[46:47], v23 offset:12288
    s_waitcnt lgkmcnt(0)
    s_barrier
    s_lshl_b32 s54, s44, 12
    v_lshlrev_b32 v15, 6, v24
    v_add_u32 v15, s54, v15
    s_getpc_b64 s[72:73]
    global_load_dword v15, v15, s[72:73]
    s_add_u32 m0, s56, 73728
    s_mov_b32 s54, 8320
    buffer_load_dwordx4 v26, s[40:43], s54 offen lds
    s_add_u32 m0, s56, 77824
    s_mov_b32 s54, 10368
    buffer_load_dwordx4 v26, s[40:43], s54 offen lds
    s_add_u32 m0, s56, 90112
    s_mov_b32 s54, 73856
    buffer_load_dwordx4 v26, s[40:43], s54 offen lds
    s_add_u32 m0, s56, 94208
    s_mov_b32 s54, 75904
    buffer_load_dwordx4 v26, s[40:43], s54 offen lds
    s_add_u32 m0, s56, 106496
    s_mov_b32 s54, 8832
    buffer_load_dwordx4 v26, s[40:43], s54 offen lds
    s_add_u32 m0, s56, 110592
    s_mov_b32 s54, 10880
    buffer_load_dwordx4 v26, s[40:43], s54 offen lds
    s_add_u32 m0, s56, 122880
    s_mov_b32 s54, 74368
    buffer_load_dwordx4 v26, s[40:43], s54 offen lds
    s_add_u32 m0, s56, 126976
    s_mov_b32 s54, 76416
    buffer_load_dwordx4 v26, s[40:43], s54 offen lds
    v_xor_b32 v16, 0, v31
    v_xor_b32 v17, 512, v31
    v_xor_b32 v18, 16384, v31
    v_xor_b32 v19, 16896, v31
    v_xor_b32 v20, 64, v31
    v_xor_b32 v21, 576, v31
    v_xor_b32 v22, 16448, v31
    v_xor_b32 v23, 16960, v31
    s_add_u32 s54, s90, 36634624
    s_add_u32 s55, s54, 3072
    s_mov_b32 m0, s47
    s_nop 0
    buffer_load_dwordx4 v1, s[36:39], s54 offen sc1 lds
    buffer_load_dwordx4 v1, s[36:39], s55 offen offset:1024 sc1 lds
    s_cmp_lg_u32 s67, 0
    s_cbranch_scc1 CH_FK_A
    s_mov_b32 s57, 0
    s_load_dwordx4 s[8:11], s[0:1], 0 glc
    s_waitcnt lgkmcnt(0)
    s_lshl_b32 s8, s8, 2
    s_lshl_b32 s9, s9, 2
    s_add_u32 s9, s9, 1
    s_min_u32 s8, s8, s9
    s_lshl_b32 s10, s10, 2
    s_add_u32 s10, s10, 2
    s_min_u32 s8, s8, s10
    s_lshl_b32 s11, s11, 2
    s_add_u32 s11, s11, 3
    s_min_u32 s8, s8, s11
    s_mov_b32 s7, s8
    s_cmp_lt_u32 s7, 2
    s_cbranch_scc1 CH_FK_A
    s_add_u32 m0, s47, 8192
    s_mov_b32 s67, 1
    buffer_load_dwordx4 v1, s[36:39], s63 offen sc1 lds
    buffer_load_dwordx4 v1, s[36:39], s63 offen offset:1024 sc1 lds
    v_lshlrev_b32 v28, 1, v0
    s_mov_b32 m0, 161024
    s_nop 0
    buffer_load_dword v28, s[36:39], s69 offen sc1 lds
CH_FK_A:
    s_waitcnt vmcnt(18)
    s_barrier
    ds_read_b64_tr_b16 a[160:161], v16 offset:0
    ds_read_b64_tr_b16 a[162:163], v16 offset:4096
    ds_read_b64_tr_b16 a[192:193], v17 offset:0
    ds_read_b64_tr_b16 a[194:195], v17 offset:4096
    ds_read_b64_tr_b16 a[200:201], v18 offset:0
    ds_read_b64_tr_b16 a[202:203], v18 offset:4096
    ds_read_b64_tr_b16 a[208:209], v19 offset:0
    ds_read_b64_tr_b16 a[210:211], v19 offset:4096
    ds_read_b64_tr_b16 a[168:169], v20 offset:0
    ds_read_b64_tr_b16 a[170:171], v20 offset:4096
    ds_read_b64_tr_b16 a[216:217], v21 offset:0
    ds_read_b64_tr_b16 a[218:219], v21 offset:4096
    ds_read_b64_tr_b16 a[224:225], v22 offset:0
    ds_read_b64_tr_b16 a[226:227], v22 offset:4096
    ds_read_b64_tr_b16 a[232:233], v23 offset:0
    ds_read_b64_tr_b16 a[234:235], v23 offset:4096
    ds_read_b64_tr_b16 a[164:165], v16 offset:8192
    ds_read_b64_tr_b16 a[166:167], v16 offset:12288
    ds_read_b64_tr_b16 a[196:197], v17 offset:8192
    ds_read_b64_tr_b16 a[198:199], v17 offset:12288
    ds_read_b64_tr_b16 a[204:205], v18 offset:8192
    ds_read_b64_tr_b16 a[206:207], v18 offset:12288
    ds_read_b64_tr_b16 a[212:213], v19 offset:8192
    ds_read_b64_tr_b16 a[214:215], v19 offset:12288
    ds_read_b64_tr_b16 a[172:173], v20 offset:8192
    ds_read_b64_tr_b16 a[174:175], v20 offset:12288
    ds_read_b64_tr_b16 a[220:221], v21 offset:8192
    ds_read_b64_tr_b16 a[222:223], v21 offset:12288
    ds_read_b64_tr_b16 a[228:229], v22 offset:8192
    ds_read_b64_tr_b16 a[230:231], v22 offset:12288
    ds_read_b64_tr_b16 a[236:237], v23 offset:8192
    ds_read_b64_tr_b16 a[238:239], v23 offset:12288
    v_xor_b32 v16, 0x10000, v16
    v_xor_b32 v17, 0x10000, v17
    v_xor_b32 v18, 0x10000, v18
    v_xor_b32 v19, 0x10000, v19
    v_xor_b32 v20, 0x10000, v20
    v_xor_b32 v21, 0x10000, v21
    v_xor_b32 v22, 0x10000, v22
    v_xor_b32 v23, 0x10000, v23
    s_waitcnt lgkmcnt(0)
    s_barrier
    ds_write_b128 v1, v[64:67] offset:8192
    ds_write_b128 v1, v[68:71] offset:9216
    ds_write_b128 v1, v[72:75] offset:24576
    ds_write_b128 v1, v[76:79] offset:25600
    ds_write_b128 v1, v[80:83] offset:40960
    ds_write_b128 v1, v[84:87] offset:41984
    ds_write_b128 v1, v[88:91] offset:57344
    ds_write_b128 v1, v[92:95] offset:58368
    ds_write_b128 v1, v[96:99] offset:0
    ds_write_b128 v1, v[100:103] offset:1024
    ds_write_b128 v1, v[104:107] offset:16384
    ds_write_b128 v1, v[108:111] offset:17408
    ds_write_b128 v1, v[112:115] offset:32768
    ds_write_b128 v1, v[116:119] offset:33792
    ds_write_b128 v1, v[120:123] offset:49152
    ds_write_b128 v1, v[124:127] offset:50176
    s_waitcnt vmcnt(2) lgkmcnt(8)
    s_barrier
    ds_read_b64_tr_b16 a[176:177], v16 offset:0
    ds_read_b64_tr_b16 a[178:179], v16 offset:4096
    ds_read_b64_tr_b16 a[240:241], v17 offset:0
    ds_read_b64_tr_b16 a[242:243], v17 offset:4096
    ds_read_b64_tr_b16 a[248:249], v18 offset:0
    ds_read_b64_tr_b16 a[250:251], v18 offset:4096
    ds_read_b64_tr_b16 v[64:65], v19 offset:0
    ds_read_b64_tr_b16 v[66:67], v19 offset:4096
    ds_read_b64_tr_b16 a[184:185], v20 offset:0
    ds_read_b64_tr_b16 a[186:187], v20 offset:4096
    ds_read_b64_tr_b16 v[72:73], v21 offset:0
    ds_read_b64_tr_b16 v[74:75], v21 offset:4096
    ds_read_b64_tr_b16 v[80:81], v22 offset:0
    ds_read_b64_tr_b16 v[82:83], v22 offset:4096
    ds_read_b64_tr_b16 v[88:89], v23 offset:0
    ds_read_b64_tr_b16 v[90:91], v23 offset:4096
    ds_read_b64_tr_b16 a[180:181], v16 offset:8192
    ds_read_b64_tr_b16 a[182:183], v16 offset:12288
    ds_read_b64_tr_b16 a[244:245], v17 offset:8192
    ds_read_b64_tr_b16 a[246:247], v17 offset:12288
    ds_read_b64_tr_b16 a[252:253], v18 offset:8192
    ds_read_b64_tr_b16 a[254:255], v18 offset:12288
    ds_read_b64_tr_b16 v[68:69], v19 offset:8192
    ds_read_b64_tr_b16 v[70:71], v19 offset:12288
    ds_read_b64_tr_b16 a[188:189], v20 offset:8192
    ds_read_b64_tr_b16 a[190:191], v20 offset:12288
    ds_read_b64_tr_b16 v[76:77], v21 offset:8192
    ds_read_b64_tr_b16 v[78:79], v21 offset:12288
    ds_read_b64_tr_b16 v[84:85], v22 offset:8192
    ds_read_b64_tr_b16 v[86:87], v22 offset:12288
    ds_read_b64_tr_b16 v[92:93], v23 offset:8192
    ds_read_b64_tr_b16 v[94:95], v23 offset:12288
    s_waitcnt lgkmcnt(0)
    s_barrier
    ds_write_b128 v2, v[64:67] offset:8192
    ds_write_b128 v2, v[68:71] offset:9216
    ds_write_b128 v2, v[72:75] offset:24576
    ds_write_b128 v2, v[76:79] offset:25600
    ds_write_b128 v2, v[80:83] offset:40960
    ds_write_b128 v2, v[84:87] offset:41984
    ds_write_b128 v2, v[88:91] offset:57344
    ds_write_b128 v2, v[92:95] offset:58368
    ds_write_b128 v2, v[32:35] offset:0
    ds_write_b128 v2, v[36:39] offset:1024
    ds_write_b128 v2, v[40:43] offset:16384
    ds_write_b128 v2, v[44:47] offset:17408
    ds_write_b128 v2, v[48:51] offset:32768
    ds_write_b128 v2, v[52:55] offset:33792
    ds_write_b128 v2, v[56:59] offset:49152
    ds_write_b128 v2, v[60:63] offset:50176
    v_mov_b32 v16, -1
    ds_write_b32 v0, v16 offset:31232
    s_cmp_lg_u32 s67, 0
    s_cbranch_scc1 CH_FK_B
    s_mov_b32 s57, 0
    s_mov_b32 s55, 2
    s_min_u32 s55, s55, 64
CH_KV0:
    s_cmp_ge_u32 s7, s55
    s_cbranch_scc1 CH_KV0_OK
    s_load_dwordx4 s[8:11], s[0:1], 0 glc
    s_add_u32 s57, s57, 1
    s_cmp_gt_u32 s57, 65536
    s_cbranch_scc1 CH_DONE
    s_waitcnt lgkmcnt(0)
    s_lshl_b32 s8, s8, 2
    s_lshl_b32 s9, s9, 2
    s_add_u32 s9, s9, 1
    s_min_u32 s8, s8, s9
    s_lshl_b32 s10, s10, 2
    s_add_u32 s10, s10, 2
    s_min_u32 s8, s8, s10
    s_lshl_b32 s11, s11, 2
    s_add_u32 s11, s11, 3
    s_min_u32 s8, s8, s11
    s_mov_b32 s7, s8
    s_branch CH_KV0
CH_KV0_OK:
    s_add_u32 m0, s47, 8192
    s_mov_b32 s67, 1
    buffer_load_dwordx4 v1, s[36:39], s63 offen sc1 lds
    buffer_load_dwordx4 v1, s[36:39], s63 offen offset:1024 sc1 lds
    v_lshlrev_b32 v17, 1, v0
    s_mov_b32 m0, 161024
    s_nop 0
    buffer_load_dword v17, s[36:39], s69 offen sc1 lds
CH_FK_B:
    s_mov_b32 s34, 745472
    s_mov_b32 s70, 0
    s_mov_b32 s71, 0
    s_mov_b32 s72, 0
    s_mov_b32 s73, 0
    s_mov_b32 s57, 0
    s_mov_b32 s68, 0
    s_waitcnt vmcnt(0)
    v_mov_b32 v14, 0
    ds_read_b128 v[64:67], v3
    ds_read_b128 v[68:71], v3 offset:1024
    v_mov_b64 v[16:17], 0
    v_mov_b64 v[18:19], 0
    v_mov_b64 v[20:21], 0
    v_mov_b64 v[22:23], 0
    v_mov_b64 v[24:25], 0
    v_mov_b64 v[26:27], 0
    v_mov_b64 v[28:29], 0
    v_mov_b64 v[30:31], 0
    s_waitcnt lgkmcnt(2)
    v_xor_b32 v45, 2048, v3
    v_xor_b32 v46, 4096, v3
    v_xor_b32 v47, 6144, v3
    s_add_u32 s69, s69, 262144
    s_sub_u32 s54, s6, 8195
    v_lshl_add_u32 v44, v0, 1, s69
    s_mov_b64 exec, 0x8888
    v_lshrrev_b32 v44, 2, v10
    v_add_u32 v44, s54, v44
    s_mov_b64 exec, -1
    s_add_u32 s63, s63, 262144
    s_add_u32 s64, s64, 262144
    s_mov_b32 m0, s47
    v_mov_b64 v[32:33], 0
    v_mov_b64 v[34:35], 0
    v_mov_b64 v[36:37], 0
    v_mov_b64 v[38:39], 0
    s_waitcnt vmcnt(0) lgkmcnt(0)
    s_cmp_eq_u32 s35, 1
    s_cbranch_scc0 CH_TOP_slow
    s_branch CH_TOP_fast
.p2align 6
CH_POLL_fast:
    s_barrier
    buffer_load_dwordx4 v[64:67], v1, s[36:39], s62 offen sc1
    v_mov_b64_e64 v[16:17], 0
    s_mov_b32 m0, s47
    s_add_u32 s69, s69, 262144
    s_sub_u32 s54, s6, 8195
    v_mov_b64 v[18:19], 0
    s_add_u32 s63, s63, 262144
    s_add_u32 s64, s64, 262144
    s_nop 0
    v_mov_b64 v[20:21], 0
    s_nop 2
    buffer_load_dwordx4 v[68:71], v1, s[36:39], s91 offen offset:1024 sc1
    v_mov_b64 v[22:23], 0
    s_nop 2
    v_mov_b64 v[24:25], 0
    s_nop 2
    v_mov_b64 v[26:27], 0
    s_nop 2
    buffer_load_dwordx4 v1, s[36:39], s91 offen offset:1024 sc1 lds
    s_waitcnt lgkmcnt(0)
    v_mov_b64 v[28:29], 0
    v_mov_b64 v[30:31], 0
    s_nop 1
    v_mov_b64 v[32:33], 0
    v_mov_b64 v[34:35], 0
    s_nop 1
    v_lshl_add_u32 v44, v0, 1, s69
    s_nop 1
    s_mov_b64 exec, 0x8888
    v_lshrrev_b32 v44, 2, v10
    v_add_u32 v44, s54, v44
    s_mov_b64 exec, -1
    s_nop 0
    v_mov_b64 v[36:37], 0
    v_mov_b64_e64 v[38:39], 0
    s_nop 1
    v_xor_b32 v45, 2048, v3
    v_xor_b32 v46, 4096, v3
    v_xor_b32 v47, 6144, v3
    s_nop 0
    v_mov_b64 v[16:17], 0
    s_nop 2
    v_mov_b64 v[16:17], 0
    s_nop 2
CH_TOP_fast:
    s_waitcnt vmcnt(2)
    v_smfmac_f32_16x16x64_bf16 v[16:19], v[64:67], v[96:103], v7
    ds_write_b128 v3, v[64:67]
    v_max3_u32 v11, v64, v65, v66
    v_smfmac_f32_16x16x64_bf16 v[20:23], v[64:67], v[104:111], v7
    v_max_u32_e64 v11, v11, v67
    v_smfmac_f32_16x16x64_bf16 v[24:27], v[64:67], v[112:119], v7
    buffer_load_dwordx4 v[56:59], v1, s[36:39], s64 offen sc1
    v_smfmac_f32_16x16x64_bf16 v[28:31], v[64:67], v[120:127], v7
    s_waitcnt vmcnt(2)
    v_max3_u32 v11, v11, v68, v69
    v_smfmac_f32_16x16x64_bf16 v[32:35], v[64:67], v[128:135], v7
    v_max3_u32 v11, v11, v70, v71
    v_smfmac_f32_16x16x64_bf16 v[36:39], v[64:67], v[136:143], v7
    v_cmp_eq_u32 vcc, -1, v11
    v_smfmac_f32_16x16x64_bf16 v[16:19], v[68:71], v[144:151], v7
    buffer_load_dwordx4 v[60:63], v1, s[36:39], s64 offen offset:1024 sc1
    v_smfmac_f32_16x16x64_bf16 v[20:23], v[68:71], v[152:159], v7
    s_cbranch_vccnz CH_RETRY_fast
CH_JOIN_fast:
    s_waitcnt vmcnt(2) lgkmcnt(0)
    s_barrier
    ds_read_b128 v[72:75], v45 offset:0
    v_smfmac_f32_16x16x64_bf16 v[24:27], v[68:71], v[160:167], v7
    ds_read_b128 v[80:83], v46 offset:0
    v_smfmac_f32_16x16x64_bf16 v[28:31], v[68:71], v[168:175], v7
    s_add_u32 m0, s60, s47
    ds_read_b128 v[88:91], v47 offset:0
    v_smfmac_f32_16x16x64_bf16 v[32:35], v[68:71], v[176:183], v7
    buffer_store_dword v40, v9, s[36:39], s65 offen sc1
    v_smfmac_f32_16x16x64_bf16 v[36:39], v[68:71], v[184:191], v7
    ds_read_b128 v[96:99], v1 offset:8192
    s_waitcnt lgkmcnt(3)
    v_smfmac_f32_16x16x64_bf16 v[16:19], v[72:75], v[192:199], v7
    s_add_u32 s53, s53, 1
    ds_read_b128 v[100:103], v1 offset:9216
    buffer_load_dwordx4 v1, s[36:39], s63 offen sc1 lds
    v_smfmac_f32_16x16x64_bf16 v[20:23], v[72:75], v[200:207], v7
    ds_read_b128 v[104:107], v1 offset:24576
    v_smfmac_f32_16x16x64_bf16 v[24:27], v[72:75], v[208:215], v7
    s_waitcnt lgkmcnt(4)
    ds_read_b128 v[108:111], v1 offset:25600
    v_smfmac_f32_16x16x64_bf16 v[16:19], v[80:83], v[216:223], v7
    ds_read_b128 v[76:79], v45 offset:1024
    v_smfmac_f32_16x16x64_bf16 v[20:23], v[80:83], v[224:231], v7
    ds_read_b128 v[84:87], v46 offset:1024
    buffer_load_dwordx4 v1, s[36:39], s63 offen offset:1024 sc1 lds
    v_smfmac_f32_16x16x64_bf16 v[24:27], v[80:83], v[232:239], v7
    s_waitcnt lgkmcnt(6)
    ds_read_b128 v[92:95], v47 offset:1024
    v_smfmac_f32_16x16x64_bf16 v[16:19], v[88:91], v[240:247], v7
    s_and_b32 s66, s53, 1
    v_smfmac_f32_16x16x64_bf16 v[20:23], v[88:91], v[248:255], v7
    s_mov_b32 s57, 0
    ds_read_b128 v[112:115], v1 offset:40960
    v_smfmac_f32_16x16x64_bf16 v[24:27], v[88:91], a[0:7], v7
    s_waitcnt lgkmcnt(3)
    ds_read_b128 v[116:119], v1 offset:41984
    v_smfmac_f32_16x16x64_bf16 v[16:19], v[76:79], a[8:15], v7
    s_mov_b32 m0, 161024
    ds_read_b128 v[120:123], v1 offset:57344
    buffer_load_dword v44, s[36:39], 0 offen sc1 lds
    v_smfmac_f32_16x16x64_bf16 v[20:23], v[76:79], a[16:23], v7
    s_xor_b32 s60, s60, 24576
    ds_read_b128 v[124:127], v1 offset:58368
    v_smfmac_f32_16x16x64_bf16 v[24:27], v[76:79], a[24:31], v7
    s_waitcnt lgkmcnt(4)
    v_add_u32_e64 v11, s60, v0
    v_smfmac_f32_16x16x64_bf16 v[16:19], v[84:87], v[96:103], v7
    s_add_u32 s56, s53, 3
    v_smfmac_f32_16x16x64_bf16 v[20:23], v[84:87], v[104:111], v7
    s_waitcnt lgkmcnt(2)
    ds_read_b128 v[96:99], v2 offset:0
    v_smfmac_f32_16x16x64_bf16 v[16:19], v[92:95], v[112:119], v7
    s_waitcnt lgkmcnt(1)
    ds_read_b128 v[100:103], v2 offset:1024
    v_smfmac_f32_16x16x64_bf16 v[20:23], v[92:95], v[120:127], v7
    ds_read_b128 v[104:107], v2 offset:16384
    v_smfmac_f32_16x16x64_bf16 v[24:27], v[84:87], a[32:39], v7
    s_and_b32 s56, s56, 3
    ds_read_b128 v[108:111], v2 offset:17408
    v_add_f32 v16, v16, v18
    v_smfmac_f32_16x16x64_bf16 v[24:27], v[92:95], a[40:47], v7
    s_lshl_b32 s54, s56, 13
    ds_read_b128 v[112:115], v2 offset:32768
    v_add_f32_e64 v17, v17, v19
    v_smfmac_f32_16x16x64_bf16 v[28:31], v[72:75], a[48:55], v7
    s_add_u32 s67, s54, s61
    ds_read_b128 v[116:119], v2 offset:33792
    v_cvt_pk_bf16_f32 v16, v16, v17
    v_smfmac_f32_16x16x64_bf16 v[28:31], v[80:83], a[56:63], v7
    s_xor_b32 s54, s54, 16384
    ds_read_b128 v[120:123], v2 offset:49152
    v_add_f32 v20, v20, v22
    v_smfmac_f32_16x16x64_bf16 v[28:31], v[88:91], a[64:71], v7
    s_add_u32 s62, s54, s90
    ds_read_b128 v[124:127], v2 offset:50176
    v_add_f32 v21, v21, v23
    v_smfmac_f32_16x16x64_bf16 v[28:31], v[76:79], a[72:79], v7
    s_add_u32 s91, s62, 3072
    s_lshl_b32 s65, s53, 13
    v_cvt_pk_bf16_f32 v17, v20, v21
    v_smfmac_f32_16x16x64_bf16 v[28:31], v[84:87], a[80:87], v7
    ds_write_b64 v4, v[16:17]
    v_add_f32 v24, v24, v26
    v_smfmac_f32_16x16x64_bf16 v[28:31], v[92:95], a[88:95], v7
    s_add_u32 s65, s65, 36708352
    v_add_f32 v25, v25, v27
    v_smfmac_f32_16x16x64_bf16 v[32:35], v[72:75], a[96:103], v7
    s_waitcnt lgkmcnt(1)
    v_cvt_pk_bf16_f32 v24, v24, v25
    v_smfmac_f32_16x16x64_bf16 v[36:39], v[72:75], a[104:111], v7
    v_add_f32 v28, v28, v30
    v_add_f32 v29, v29, v31
    v_cvt_pk_bf16_f32 v25, v28, v29
    v_smfmac_f32_16x16x64_bf16 v[32:35], v[76:79], v[96:103], v7
    ds_write_b64 v4, v[24:25] offset:128
    v_smfmac_f32_16x16x64_bf16 v[36:39], v[76:79], v[104:111], v7
    v_smfmac_f32_16x16x64_bf16 v[32:35], v[80:83], v[112:119], v7
    v_smfmac_f32_16x16x64_bf16 v[36:39], v[80:83], v[120:127], v7
    v_smfmac_f32_16x16x64_bf16 v[32:35], v[84:87], a[112:119], v7
    s_waitcnt lgkmcnt(0)
    s_barrier
    v_smfmac_f32_16x16x64_bf16 v[36:39], v[84:87], a[120:127], v7
    ds_read_b64_tr_b16 v[40:41], v5 offset:0
    ds_read_b64_tr_b16 v[42:43], v5 offset:64
    v_smfmac_f32_16x16x64_bf16 v[32:35], v[88:91], a[128:135], v7
    ds_read_b64_tr_b16 v[44:45], v5 offset:256
    ds_read_b64_tr_b16 v[46:47], v5 offset:320
    v_smfmac_f32_16x16x64_bf16 v[36:39], v[88:91], a[136:143], v7
    ds_read_b64_tr_b16 v[48:49], v5 offset:512
    ds_read_b64_tr_b16 v[50:51], v5 offset:576
    v_smfmac_f32_16x16x64_bf16 v[32:35], v[92:95], a[144:151], v7
    ds_read_b64_tr_b16 v[52:53], v5 offset:768
    ds_read_b64_tr_b16 v[54:55], v5 offset:832
    v_smfmac_f32_16x16x64_bf16 v[36:39], v[92:95], a[152:159], v7
    ds_read_b128 v[96:99], v11 offset:0
    s_waitcnt lgkmcnt(7)
    v_mfma_f32_16x16x32_bf16 v[24:27], v[40:43], v[40:43], 0
    s_waitcnt lgkmcnt(5)
    ds_read_b128 v[100:103], v11 offset:1024
    ds_read_b128 v[104:107], v11 offset:2048
    v_mfma_f32_16x16x32_bf16 v[24:27], v[44:47], v[44:47], v[24:27]
    s_waitcnt lgkmcnt(5)
    ds_read_b128 v[108:111], v11 offset:3072
    ds_read_b128 v[112:115], v11 offset:4096
    v_mfma_f32_16x16x32_bf16 v[24:27], v[48:51], v[48:51], v[24:27]
    s_waitcnt lgkmcnt(5)
    ds_read_b128 v[116:119], v11 offset:5120
    ds_read_b128 v[120:123], v11 offset:6144
    v_mfma_f32_16x16x32_bf16 v[24:27], v[52:55], v[52:55], v[24:27]
    s_waitcnt lgkmcnt(6)
    ds_read_b128 v[124:127], v11 offset:7168
    v_mfma_f32_16x16x32_bf16 v[16:19], v[96:99], v[40:43], 0
    s_waitcnt lgkmcnt(6)
    v_mov_b64 v[80:81], s[50:51]
    v_mov_b64 v[82:83], s[50:51]
    v_mfma_f32_16x16x32_bf16 v[16:19], v[100:103], v[44:47], v[16:19]
    s_waitcnt lgkmcnt(5)
    v_mov_b64 v[64:65], 0
    v_mov_b64_e64 v[66:67], 0
    v_mfma_f32_16x16x32_bf16 v[16:19], v[104:107], v[48:51], v[16:19]
    s_waitcnt lgkmcnt(4)
    v_mov_b64 v[68:69], 0
    v_mov_b64 v[70:71], 0
    v_mfma_f32_16x16x32_bf16 v[16:19], v[108:111], v[52:55], v[16:19]
    s_waitcnt lgkmcnt(3)
    v_mov_b64 v[72:73], 0
    v_mov_b64 v[74:75], 0
    v_mfma_f32_16x16x32_bf16 v[20:23], v[112:115], v[40:43], 0
    s_waitcnt lgkmcnt(2)
    v_mov_b64 v[76:77], 0
    v_mov_b64_e64 v[78:79], 0
    v_mfma_f32_16x16x32_bf16 v[20:23], v[116:119], v[44:47], v[20:23]
    s_waitcnt lgkmcnt(1)
    v_add_f32 v32, v32, v34
    v_add_f32 v33, v33, v35
    v_mfma_f32_16x16x32_bf16 v[20:23], v[120:123], v[48:51], v[20:23]
    s_waitcnt lgkmcnt(0)
    v_max3_f32 v28, v26, v27, v16
    v_max3_f32 v28, v28, v17, v18
    v_mfma_f32_16x16x32_bf16 v[20:23], v[124:127], v[52:55], v[20:23]
    v_max_f32_e64 v28, v28, v19
    v_cvt_pk_bf16_f32 v32, v32, v33
    v_add_f32 v36, v36, v38
    v_add_f32_e64 v37, v37, v39
    v_cvt_pk_bf16_f32 v33, v36, v37
    s_nop 1
    v_max3_f32 v28, v28, v20, v21
    v_max3_f32 v30, v28, v22, v23
    v_max3_f32 v28, v28, v22, v23
    s_nop 1
    v_permlane16_swap_b32 v28, v30
    v_max_f32 v31, v28, v30
    v_max_f32 v28, v28, v30
    s_nop 1
    v_permlane32_swap_b32 v28, v31
    v_max_f32 v28, v28, v31
    v_mul_f32 v28, s48, v28
    v_pk_fma_f32 v[26:27], v[26:27], s[48:49], v[28:29] op_sel_hi:[1,1,0] neg_lo:[0,0,1] neg_hi:[0,0,1]
    v_pk_fma_f32 v[16:17], v[16:17], s[48:49], v[28:29] op_sel_hi:[1,1,0] neg_lo:[0,0,1] neg_hi:[0,0,1]
    v_pk_fma_f32 v[18:19], v[18:19], s[48:49], v[28:29] op_sel_hi:[1,1,0] neg_lo:[0,0,1] neg_hi:[0,0,1]
    v_pk_fma_f32 v[20:21], v[20:21], s[48:49], v[28:29] op_sel_hi:[1,1,0] neg_lo:[0,0,1] neg_hi:[0,0,1]
    v_pk_fma_f32 v[22:23], v[22:23], s[48:49], v[28:29] op_sel_hi:[1,1,0] neg_lo:[0,0,1] neg_hi:[0,0,1]
    v_exp_f32 v26, v26
    v_exp_f32 v27, v27
    v_exp_f32 v16, v16
    v_cvt_pk_bf16_f32 v12, v26, v27
    v_cvt_pk_bf16_f32 v15, v26, v27
    v_exp_f32 v17, v17
    v_mfma_f32_16x16x16_bf16 v[44:47], v[80:81], v[12:13], 0
    v_exp_f32 v18, v18
    v_mfma_f32_16x16x16_bf16 v[48:51], v[32:33], v[12:13], 0
    v_exp_f32 v19, v19
    v_mfma_f32_16x16x16_bf16 v[52:55], v[32:33], v[14:15], 0
    v_exp_f32 v20, v20
    v_exp_f32 v21, v21
    v_exp_f32 v22, v22
    v_exp_f32 v23, v23
    v_cvt_pk_bf16_f32 v40, v16, v17
    v_cvt_pk_bf16_f32 v41, v18, v19
    v_cvt_pk_bf16_f32 v42, v20, v21
    v_cvt_pk_bf16_f32 v43, v22, v23
    s_nop 1
    v_mfma_f32_16x16x32_bf16 v[44:47], v[80:83], v[40:43], v[44:47]
    s_waitcnt vmcnt(4)
    v_xor_b32 v21, 512, v6
    v_xor_b32 v22, 1024, v6
    v_mfma_f32_16x16x32_bf16 v[48:51], v[56:59], v[40:43], v[48:51]
    v_xor_b32 v23, 1536, v6
    v_lshlrev_b32 v25, 5, v10
    v_mfma_f32_16x16x32_bf16 v[52:55], v[60:63], v[40:43], v[52:55]
    v_rcp_f32_dpp v30, v44 quad_perm:[0,1,0,1] row_mask:0xf bank_mask:0xf
    v_mov_b32_e64 v24, s53
    s_nop 0
    v_mul_f32_dpp v48, v48, v30 quad_perm:[0,1,0,1] row_mask:0xf bank_mask:0xf
    v_mul_f32_dpp v49, v49, v30 quad_perm:[0,1,0,1] row_mask:0xf bank_mask:0xf
    v_mul_f32_dpp v50, v50, v30 quad_perm:[0,1,0,1] row_mask:0xf bank_mask:0xf
    v_mul_f32_dpp v51, v51, v30 quad_perm:[0,1,0,1] row_mask:0xf bank_mask:0xf
    v_cvt_pk_bf16_f32 v80, v48, v49
    v_cvt_pk_bf16_f32 v81, v50, v51
    v_mul_f32_dpp v52, v52, v30 quad_perm:[0,1,0,1] row_mask:0xf bank_mask:0xf
    v_mul_f32_dpp v53, v53, v30 quad_perm:[0,1,0,1] row_mask:0xf bank_mask:0xf
    v_mul_f32_dpp v54, v54, v30 quad_perm:[0,1,0,1] row_mask:0xf bank_mask:0xf
    v_mul_f32_dpp v55, v55, v30 quad_perm:[0,1,0,1] row_mask:0xf bank_mask:0xf
    v_cvt_pk_bf16_f32 v82, v52, v53
    v_cvt_pk_bf16_f32 v83, v54, v55
    ds_write_b128 v6, v[80:83]
    s_nop 0
    v_smfmac_f32_16x16x64_bf16 v[64:67], v[80:83], a[160:167], v7
    ds_read_b128 v[96:99], v2 offset:8192
    v_smfmac_f32_16x16x64_bf16 v[68:71], v[80:83], a[168:175], v7
    ds_read_b128 v[100:103], v2 offset:9216
    v_smfmac_f32_16x16x64_bf16 v[72:75], v[80:83], a[176:183], v7
    ds_read_b128 v[104:107], v2 offset:24576
    v_lshlrev_b32 v25, 5, v10
    s_waitcnt lgkmcnt(3)
    s_barrier
    ds_read_b128 v[84:87], v21
    ds_read_b128 v[88:91], v22
    ds_read_b128 v[92:95], v23
    v_smfmac_f32_16x16x64_bf16 v[76:79], v[80:83], a[184:191], v7
    v_lshlrev_b32 v25, 5, v10
    s_waitcnt lgkmcnt(2)
    v_smfmac_f32_16x16x64_bf16 v[64:67], v[84:87], a[192:199], v7
    ds_read_b128 v[108:111], v2 offset:25600
    s_waitcnt lgkmcnt(2)
    v_smfmac_f32_16x16x64_bf16 v[64:67], v[88:91], a[200:207], v7
    ds_read_b128 v[112:115], v2 offset:40960
    s_waitcnt lgkmcnt(2)
    v_smfmac_f32_16x16x64_bf16 v[64:67], v[92:95], a[208:215], v7
    ds_read_b128 v[116:119], v2 offset:41984
    v_smfmac_f32_16x16x64_bf16 v[68:71], v[84:87], a[216:223], v7
    ds_read_b128 v[120:123], v2 offset:57344
    v_smfmac_f32_16x16x64_bf16 v[68:71], v[88:91], a[224:231], v7
    ds_read_b128 v[124:127], v2 offset:58368
    v_cvt_pk_bf16_f32 v44, v64, v65
    v_cvt_pk_bf16_f32 v45, v66, v67
    v_bfi_b32 v44, 1, s66, v44
    v_smfmac_f32_16x16x64_bf16 v[68:71], v[92:95], a[232:239], v7
    ds_read_b32 v26, v0 offset:31232
    buffer_store_dwordx2 v[44:45], v8, s[36:39], s98 offen
    v_smfmac_f32_16x16x64_bf16 v[72:75], v[84:87], a[240:247], v7
    v_smfmac_f32_16x16x64_bf16 v[72:75], v[88:91], a[248:255], v7
    s_waitcnt lgkmcnt(10)
    v_cvt_pk_bf16_f32 v46, v68, v69
    v_cvt_pk_bf16_f32 v47, v70, v71
    v_smfmac_f32_16x16x64_bf16 v[72:75], v[92:95], v[96:103], v7
    s_waitcnt lgkmcnt(5)
    v_bfi_b32 v46, 1, s66, v46
    v_smfmac_f32_16x16x64_bf16 v[76:79], v[84:87], v[104:111], v7
    s_waitcnt lgkmcnt(3)
    buffer_store_dwordx2 v[46:47], v8, s[36:39], s99 offen
    v_smfmac_f32_16x16x64_bf16 v[76:79], v[88:91], v[112:119], v7
    s_waitcnt lgkmcnt(1)
    v_cvt_pk_bf16_f32 v48, v72, v73
    v_smfmac_f32_16x16x64_bf16 v[76:79], v[92:95], v[120:127], v7
    s_cmp_lg_u32 s44, 0
    v_cvt_pk_bf16_f32 v49, v74, v75
    v_bfi_b32 v48, 1, s66, v48
    buffer_store_dwordx2 v[48:49], v8, s[36:39], s100 offen
    s_nop 0
    v_cvt_pk_bf16_f32 v50, v76, v77
    v_cvt_pk_bf16_f32 v51, v78, v79
    v_bfi_b32 v50, 1, s66, v50
    buffer_store_dwordx2 v[50:51], v8, s[36:39], s101 offen
    s_cbranch_scc1 CH_HK_fast
    s_waitcnt lgkmcnt(0)
    v_readfirstlane_b32 s54, v26
    s_nop 0
    s_cmp_eq_u32 s54, s53
    s_cbranch_scc1 CH_LW0_fast_L
CH_LW0_fast:
    s_nop 6
    s_nop 6
    s_nop 6
    s_nop 7
CH_SW_fast:
    buffer_load_dwordx4 v[64:67], v1, s[36:39], s58 offen offset:0 sc1
    buffer_load_dwordx4 v[68:71], v1, s[36:39], s58 offen offset:1024 sc1
    s_nop 9
    buffer_load_dwordx4 v[72:75], v1, s[36:39], s58 offen offset:2048 sc1
    buffer_load_dwordx4 v[76:79], v1, s[36:39], s58 offen offset:3072 sc1
    s_nop 9
    buffer_load_dwordx4 v[80:83], v1, s[36:39], s59 offen offset:0 sc1
    buffer_load_dwordx4 v[84:87], v1, s[36:39], s59 offen offset:1024 sc1
    s_nop 9
    buffer_load_dwordx4 v[88:91], v1, s[36:39], s59 offen offset:2048 sc1
    buffer_load_dwordx4 v[92:95], v1, s[36:39], s59 offen offset:3072 sc1
    s_mov_b64 exec, 0xff
    buffer_store_dword v24, v25, s[36:39], s4 offen offset:0
    s_mov_b64 exec, -1
    s_barrier
    ds_read_b128 v[16:19], v0 offset:28928
    ds_read_b128 v[20:23], v0 offset:30208
    s_cmp_lg_u32 s66, 0
    s_waitcnt lgkmcnt(0)
    s_cbranch_scc1 CH_ODD_fast
    s_waitcnt vmcnt(8)
    v_mfma_f32_16x16x32_bf16 v[40:43], v[16:19], v[64:67], 0
    v_bitop3_b32 v11, v64, v64, v66 bitop3:0xfe
    s_waitcnt vmcnt(7)
    v_mfma_f32_16x16x32_bf16 v[40:43], v[16:19], v[68:71], v[40:43]
    v_bitop3_b32 v11, v11, v68, v70 bitop3:0xfe
    s_waitcnt vmcnt(6)
    v_mfma_f32_16x16x32_bf16 v[40:43], v[20:23], v[72:75], v[40:43]
    v_bitop3_b32 v11, v11, v72, v74 bitop3:0xfe
    s_waitcnt vmcnt(5)
    v_mfma_f32_16x16x32_bf16 v[40:43], v[20:23], v[76:79], v[40:43]
    v_bitop3_b32 v11, v11, v76, v78 bitop3:0xfe
    s_waitcnt vmcnt(4)
    v_mfma_f32_16x16x32_bf16 v[52:55], v[16:19], v[80:83], 0
    v_bitop3_b32 v11, v11, v80, v82 bitop3:0xfe
    s_waitcnt vmcnt(3)
    v_mfma_f32_16x16x32_bf16 v[52:55], v[16:19], v[84:87], v[52:55]
    v_bitop3_b32 v11, v11, v84, v86 bitop3:0xfe
    v_add_f32_dpp v40, v40, v40 row_ror:8 row_mask:0xf bank_mask:0x3
    v_add_f32_dpp v40, v41, v41 row_ror:8 row_mask:0xf bank_mask:0xc
    v_add_f32_dpp v42, v42, v42 row_ror:8 row_mask:0xf bank_mask:0x3
    v_add_f32_dpp v42, v43, v43 row_ror:8 row_mask:0xf bank_mask:0xc
    s_waitcnt vmcnt(2)
    v_mfma_f32_16x16x32_bf16 v[52:55], v[20:23], v[88:91], v[52:55]
    v_bitop3_b32 v11, v11, v88, v90 bitop3:0xfe
    s_waitcnt vmcnt(1)
    v_mfma_f32_16x16x32_bf16 v[52:55], v[20:23], v[92:95], v[52:55]
    v_bitop3_b32 v11, v11, v92, v94 bitop3:0xfe
    v_and_b32 v11, 1, v11
    v_cmp_ne_u32 vcc, 0, v11
    v_add_f32_dpp v41, v40, v40 row_ror:12 row_mask:0xf bank_mask:0x5
    v_add_f32_dpp v41, v42, v42 row_ror:4 row_mask:0xf bank_mask:0xa
    s_nop 1
    v_add_f32_dpp v52, v52, v52 row_ror:8 row_mask:0xf bank_mask:0x3
    v_add_f32_dpp v52, v53, v53 row_ror:8 row_mask:0xf bank_mask:0xc
    v_add_f32_dpp v54, v54, v54 row_ror:8 row_mask:0xf bank_mask:0x3
    v_add_f32_dpp v54, v55, v55 row_ror:8 row_mask:0xf bank_mask:0xc
    v_add_f32_dpp v53, v52, v52 row_ror:12 row_mask:0xf bank_mask:0x5
    s_cbranch_vccnz CH_RED2_fast
    v_add_f32_dpp v53, v54, v54 row_ror:4 row_mask:0xf bank_mask:0xa
    v_cvt_pk_bf16_f32 v40, v41, v53
    buffer_store_dword v40, v9, s[36:39], s62 offen
CH_MST_fast:
    s_cmp_eq_u32 s53, 62
    s_cbranch_scc0 CH_ON_fast
    buffer_store_dword v40, v9, s[36:39], s65 offen sc1
    s_branch CH_LAST
CH_ON_fast:
    ds_read_b128 v[96:99], v1 offset:0
    ds_read_b128 v[100:103], v1 offset:1024
    ds_read_b128 v[104:107], v1 offset:16384
    ds_read_b128 v[108:111], v1 offset:17408
    ds_read_b128 v[112:115], v1 offset:32768
    ds_read_b128 v[116:119], v1 offset:33792
    ds_read_b128 v[120:123], v1 offset:49152
    ds_read_b128 v[124:127], v1 offset:50176
    s_branch CH_POLL_fast
.p2align 6
CH_ODD_fast:
    s_waitcnt vmcnt(8)
    v_mfma_f32_16x16x32_bf16 v[40:43], v[16:19], v[64:67], 0
    v_bitop3_b32 v11, v64, v64, v66 bitop3:0x80
    s_waitcnt vmcnt(7)
    v_mfma_f32_16x16x32_bf16 v[40:43], v[16:19], v[68:71], v[40:43]
    v_bitop3_b32 v11, v11, v68, v70 bitop3:0x80
    s_waitcnt vmcnt(6)
    v_mfma_f32_16x16x32_bf16 v[40:43], v[20:23], v[72:75], v[40:43]
    v_bitop3_b32 v11, v11, v72, v74 bitop3:0x80
    s_waitcnt vmcnt(5)
    v_mfma_f32_16x16x32_bf16 v[40:43], v[20:23], v[76:79], v[40:43]
    v_bitop3_b32 v11, v11, v76, v78 bitop3:0x80
    s_waitcnt vmcnt(4)
    v_mfma_f32_16x16x32_bf16 v[52:55], v[16:19], v[80:83], 0
    v_bitop3_b32 v11, v11, v80, v82 bitop3:0x80
    s_waitcnt vmcnt(3)
    v_mfma_f32_16x16x32_bf16 v[52:55], v[16:19], v[84:87], v[52:55]
    v_bitop3_b32 v11, v11, v84, v86 bitop3:0x80
    v_add_f32_dpp v40, v40, v40 row_ror:8 row_mask:0xf bank_mask:0x3
    v_add_f32_dpp v40, v41, v41 row_ror:8 row_mask:0xf bank_mask:0xc
    v_add_f32_dpp v42, v42, v42 row_ror:8 row_mask:0xf bank_mask:0x3
    v_add_f32_dpp v42, v43, v43 row_ror:8 row_mask:0xf bank_mask:0xc
    s_waitcnt vmcnt(2)
    v_mfma_f32_16x16x32_bf16 v[52:55], v[20:23], v[88:91], v[52:55]
    v_bitop3_b32 v11, v11, v88, v90 bitop3:0x80
    s_waitcnt vmcnt(1)
    v_mfma_f32_16x16x32_bf16 v[52:55], v[20:23], v[92:95], v[52:55]
    v_bitop3_b32 v11, v11, v92, v94 bitop3:0x80
    v_and_b32 v11, 1, v11
    v_cmp_ne_u32_e64 vcc, 1, v11
    v_add_f32_dpp v41, v40, v40 row_ror:12 row_mask:0xf bank_mask:0x5
    v_add_f32_dpp v41, v42, v42 row_ror:4 row_mask:0xf bank_mask:0xa
    s_nop 1
    v_add_f32_dpp v52, v52, v52 row_ror:8 row_mask:0xf bank_mask:0x3
    v_add_f32_dpp v52, v53, v53 row_ror:8 row_mask:0xf bank_mask:0xc
    v_add_f32_dpp v54, v54, v54 row_ror:8 row_mask:0xf bank_mask:0x3
    v_add_f32_dpp v54, v55, v55 row_ror:8 row_mask:0xf bank_mask:0xc
    v_add_f32_dpp v53, v52, v52 row_ror:12 row_mask:0xf bank_mask:0x5
    s_cbranch_vccnz CH_RED2_fast
    v_add_f32_dpp v53, v54, v54 row_ror:4 row_mask:0xf bank_mask:0xa
    v_cvt_pk_bf16_f32 v40, v41, v53
    buffer_store_dword v40, v9, s[36:39], s62 offen
    s_branch CH_MST_fast
.p2align 6
CH_RED2_fast:
    buffer_load_dwordx4 v[64:67], v1, s[36:39], s58 offen offset:0 sc1
    buffer_load_dwordx4 v[68:71], v1, s[36:39], s58 offen offset:1024 sc1
    buffer_load_dwordx4 v[72:75], v1, s[36:39], s58 offen offset:2048 sc1
    buffer_load_dwordx4 v[76:79], v1, s[36:39], s58 offen offset:3072 sc1
    buffer_load_dwordx4 v[80:83], v1, s[36:39], s59 offen offset:0 sc1
    buffer_load_dwordx4 v[84:87], v1, s[36:39], s59 offen offset:1024 sc1
    buffer_load_dwordx4 v[88:91], v1, s[36:39], s59 offen offset:2048 sc1
    buffer_load_dwordx4 v[92:95], v1, s[36:39], s59 offen offset:3072 sc1
    s_add_u32 s54, s53, 1
    v_mov_b32 v11, s54
    ds_write_b32 v0, v11 offset:31232
    s_add_u32 s57, s57, 1
    s_cmp_gt_u32 s57, 65536
    s_cbranch_scc1 CH_DONE
    s_cmp_lg_u32 s66, 0
    s_cbranch_scc1 CH_ODD2_fast
    s_waitcnt vmcnt(7)
    v_mfma_f32_16x16x32_bf16 v[40:43], v[16:19], v[64:67], 0
    v_bitop3_b32 v11, v64, v64, v66 bitop3:0xfe
    s_waitcnt vmcnt(6)
    v_mfma_f32_16x16x32_bf16 v[40:43], v[16:19], v[68:71], v[40:43]
    v_bitop3_b32 v11, v11, v68, v70 bitop3:0xfe
    s_waitcnt vmcnt(5)
    v_mfma_f32_16x16x32_bf16 v[40:43], v[20:23], v[72:75], v[40:43]
    v_bitop3_b32 v11, v11, v72, v74 bitop3:0xfe
    s_waitcnt vmcnt(4)
    v_mfma_f32_16x16x32_bf16 v[40:43], v[20:23], v[76:79], v[40:43]
    v_bitop3_b32 v11, v11, v76, v78 bitop3:0xfe
    s_waitcnt vmcnt(3)
    v_mfma_f32_16x16x32_bf16 v[52:55], v[16:19], v[80:83], 0
    v_bitop3_b32 v11, v11, v80, v82 bitop3:0xfe
    s_waitcnt vmcnt(2)
    v_mfma_f32_16x16x32_bf16 v[52:55], v[16:19], v[84:87], v[52:55]
    v_bitop3_b32 v11, v11, v84, v86 bitop3:0xfe
    v_add_f32_dpp v40, v40, v40 row_ror:8 row_mask:0xf bank_mask:0x3
    v_add_f32_dpp v40, v41, v41 row_ror:8 row_mask:0xf bank_mask:0xc
    v_add_f32_dpp v42, v42, v42 row_ror:8 row_mask:0xf bank_mask:0x3
    v_add_f32_dpp v42, v43, v43 row_ror:8 row_mask:0xf bank_mask:0xc
    s_waitcnt vmcnt(1)
    v_mfma_f32_16x16x32_bf16 v[52:55], v[20:23], v[88:91], v[52:55]
    v_bitop3_b32 v11, v11, v88, v90 bitop3:0xfe
    s_waitcnt vmcnt(0)
    v_mfma_f32_16x16x32_bf16 v[52:55], v[20:23], v[92:95], v[52:55]
    v_bitop3_b32 v11, v11, v92, v94 bitop3:0xfe
    v_and_b32 v11, 1, v11
    v_cmp_ne_u32 vcc, 0, v11
    v_add_f32_dpp v41, v40, v40 row_ror:12 row_mask:0xf bank_mask:0x5
    v_add_f32_dpp v41, v42, v42 row_ror:4 row_mask:0xf bank_mask:0xa
    s_nop 1
    v_add_f32_dpp v52, v52, v52 row_ror:8 row_mask:0xf bank_mask:0x3
    v_add_f32_dpp v52, v53, v53 row_ror:8 row_mask:0xf bank_mask:0xc
    v_add_f32_dpp v54, v54, v54 row_ror:8 row_mask:0xf bank_mask:0x3
    v_add_f32_dpp v54, v55, v55 row_ror:8 row_mask:0xf bank_mask:0xc
    v_add_f32_dpp v53, v52, v52 row_ror:12 row_mask:0xf bank_mask:0x5
    s_cbranch_vccnz CH_RED2_fast
    v_add_f32_dpp v53, v54, v54 row_ror:4 row_mask:0xf bank_mask:0xa
    v_cvt_pk_bf16_f32 v40, v41, v53
    buffer_store_dword v40, v9, s[36:39], s62 offen
    s_branch CH_MST_fast
CH_ODD2_fast:
    s_waitcnt vmcnt(7)
    v_mfma_f32_16x16x32_bf16 v[40:43], v[16:19], v[64:67], 0
    v_bitop3_b32 v11, v64, v64, v66 bitop3:0x80
    s_waitcnt vmcnt(6)
    v_mfma_f32_16x16x32_bf16 v[40:43], v[16:19], v[68:71], v[40:43]
    v_bitop3_b32 v11, v11, v68, v70 bitop3:0x80
    s_waitcnt vmcnt(5)
    v_mfma_f32_16x16x32_bf16 v[40:43], v[20:23], v[72:75], v[40:43]
    v_bitop3_b32 v11, v11, v72, v74 bitop3:0x80
    s_waitcnt vmcnt(4)
    v_mfma_f32_16x16x32_bf16 v[40:43], v[20:23], v[76:79], v[40:43]
    v_bitop3_b32 v11, v11, v76, v78 bitop3:0x80
    s_waitcnt vmcnt(3)
    v_mfma_f32_16x16x32_bf16 v[52:55], v[16:19], v[80:83], 0
    v_bitop3_b32 v11, v11, v80, v82 bitop3:0x80
    s_waitcnt vmcnt(2)
    v_mfma_f32_16x16x32_bf16 v[52:55], v[16:19], v[84:87], v[52:55]
    v_bitop3_b32 v11, v11, v84, v86 bitop3:0x80
    v_add_f32_dpp v40, v40, v40 row_ror:8 row_mask:0xf bank_mask:0x3
    v_add_f32_dpp v40, v41, v41 row_ror:8 row_mask:0xf bank_mask:0xc
    v_add_f32_dpp v42, v42, v42 row_ror:8 row_mask:0xf bank_mask:0x3
    v_add_f32_dpp v42, v43, v43 row_ror:8 row_mask:0xf bank_mask:0xc
    s_waitcnt vmcnt(1)
    v_mfma_f32_16x16x32_bf16 v[52:55], v[20:23], v[88:91], v[52:55]
    v_bitop3_b32 v11, v11, v88, v90 bitop3:0x80
    s_waitcnt vmcnt(0)
    v_mfma_f32_16x16x32_bf16 v[52:55], v[20:23], v[92:95], v[52:55]
    v_bitop3_b32 v11, v11, v92, v94 bitop3:0x80
    v_and_b32 v11, 1, v11
    v_cmp_ne_u32_e64 vcc, 1, v11
    v_add_f32_dpp v41, v40, v40 row_ror:12 row_mask:0xf bank_mask:0x5
    v_add_f32_dpp v41, v42, v42 row_ror:4 row_mask:0xf bank_mask:0xa
    s_nop 1
    v_add_f32_dpp v52, v52, v52 row_ror:8 row_mask:0xf bank_mask:0x3
    v_add_f32_dpp v52, v53, v53 row_ror:8 row_mask:0xf bank_mask:0xc
    v_add_f32_dpp v54, v54, v54 row_ror:8 row_mask:0xf bank_mask:0x3
    v_add_f32_dpp v54, v55, v55 row_ror:8 row_mask:0xf bank_mask:0xc
    v_add_f32_dpp v53, v52, v52 row_ror:12 row_mask:0xf bank_mask:0x5
    s_cbranch_vccnz CH_RED2_fast
    v_add_f32_dpp v53, v54, v54 row_ror:4 row_mask:0xf bank_mask:0xa
    v_cvt_pk_bf16_f32 v40, v41, v53
    buffer_store_dword v40, v9, s[36:39], s62 offen
    s_branch CH_MST_fast
.p2align 6
CH_RETRY_fast:
    s_mov_b64 exec, vcc
    buffer_load_dwordx4 v[64:67], v1, s[36:39], s62 offen sc1
    buffer_load_dwordx4 v[68:71], v1, s[36:39], s91 offen offset:1024 sc1
    s_mov_b64 exec, -1
    s_waitcnt vmcnt(4)
    ds_read_b128 v[72:75], v3
    ds_read_b128 v[76:79], v3 offset:1024
    v_mov_b64 v[16:17], 0
    v_mov_b64 v[18:19], 0
    v_mov_b64 v[20:21], 0
    v_mov_b64 v[22:23], 0
    v_mov_b64 v[24:25], 0
    v_mov_b64 v[26:27], 0
    v_mov_b64 v[28:29], 0
    v_mov_b64 v[30:31], 0
    v_mov_b64 v[32:33], 0
    v_mov_b64 v[34:35], 0
    v_mov_b64 v[36:37], 0
    v_mov_b64 v[38:39], 0
    s_mov_b64 exec, vcc
    s_waitcnt lgkmcnt(0)
    v_mov_b64 v[64:65], v[72:73]
    v_mov_b64 v[66:67], v[74:75]
    v_mov_b64 v[68:69], v[76:77]
    v_mov_b64_e64 v[70:71], v[78:79]
    v_max3_u32 v11, v64, v65, v66
    v_max3_u32 v11, v11, v67, v68
    v_max3_u32 v11, v11, v69, v70
    v_max_u32 v11, v11, v71
    v_cmp_eq_u32 vcc, -1, v11
    buffer_load_dwordx4 v[64:67], v1, s[36:39], s62 offen sc1
    buffer_load_dwordx4 v[68:71], v1, s[36:39], s91 offen offset:1024 sc1
    s_mov_b64 exec, -1
    s_cbranch_vccnz CH_RETRY2_fast
CH_FIN_fast:
    s_add_u32 s54, s53, 1
    v_mov_b32 v11, s54
    ds_write_b32 v0, v11 offset:31232
    ds_write_b128 v3, v[64:67]
    ds_write_b128 v3, v[68:71] offset:1024
    v_smfmac_f32_16x16x64_bf16 v[16:19], v[64:67], v[96:103], v7
    v_smfmac_f32_16x16x64_bf16 v[20:23], v[64:67], v[104:111], v7
    v_smfmac_f32_16x16x64_bf16 v[24:27], v[64:67], v[112:119], v7
    v_smfmac_f32_16x16x64_bf16 v[28:31], v[64:67], v[120:127], v7
    v_smfmac_f32_16x16x64_bf16 v[32:35], v[64:67], v[128:135], v7
    v_smfmac_f32_16x16x64_bf16 v[36:39], v[64:67], v[136:143], v7
    v_smfmac_f32_16x16x64_bf16 v[16:19], v[68:71], v[144:151], v7
    v_smfmac_f32_16x16x64_bf16 v[20:23], v[68:71], v[152:159], v7
    s_waitcnt vmcnt(0) lgkmcnt(0)
    s_branch CH_JOIN_fast
CH_RETRY2_fast:
    s_mov_b64 exec, vcc
    buffer_load_dwordx4 v[64:67], v1, s[36:39], s62 offen sc1
    buffer_load_dwordx4 v[68:71], v1, s[36:39], s91 offen offset:1024 sc1
    s_add_u32 s57, s57, 1
    s_waitcnt vmcnt(4)
    v_max3_u32 v11, v64, v65, v66
    v_max3_u32 v11, v11, v67, v68
    v_max3_u32 v11, v11, v69, v70
    v_max_u32 v11, v11, v71
    v_cmp_eq_u32 vcc, -1, v11
    s_cmp_gt_u32 s57, 65536
    s_cbranch_scc1 CH_DONE
    s_mov_b64 exec, -1
    s_cbranch_vccz CH_FIN_fast
    s_branch CH_RETRY2_fast
.p2align 6
CH_HK_fast:
    ds_read_b128 v[96:99], v1 offset:0
    ds_read_b128 v[100:103], v1 offset:1024
    ds_read_b128 v[104:107], v1 offset:16384
    ds_read_b128 v[108:111], v1 offset:17408
    ds_read_b128 v[112:115], v1 offset:32768
    ds_read_b128 v[116:119], v1 offset:33792
    ds_read_b128 v[120:123], v1 offset:49152
    ds_read_b128 v[124:127], v1 offset:50176
    s_waitcnt lgkmcnt(0)
    s_cmp_eq_u32 s53, 62
    s_cselect_b32 s54, 4, s44
    s_cmp_eq_u32 s54, 1
    s_barrier
    s_cbranch_scc0 CH_HK23_fast
    s_nop 5
    s_nop 5
    s_nop 5
    s_nop 5
    s_mov_b64 vcc, -1
    buffer_load_dword v74, v10, s[36:39], s5 offen sc1
    s_nop 6
    buffer_load_dword v75, v10, s[36:39], s5 offen sc1
    s_nop 6
    buffer_load_dword v76, v10, s[36:39], s5 offen sc1
    s_nop 6
    buffer_load_dword v77, v10, s[36:39], s5 offen sc1
    s_nop 6
    buffer_load_dword v78, v10, s[36:39], s5 offen sc1
    s_nop 6
    buffer_load_dword v79, v10, s[36:39], s5 offen sc1
    s_nop 6
    buffer_load_dword v80, v10, s[36:39], s5 offen sc1
    s_nop 13
CH_PROBE_fast:
    buffer_load_dword v81, v10, s[36:39], s5 offen sc1
    s_waitcnt vmcnt(7)
    s_cbranch_vccz CH_POLL_fast
    v_cmp_gt_i32 vcc, s53, v74
    s_nop 1
    buffer_load_dword v74, v10, s[36:39], s5 offen sc1
    s_waitcnt vmcnt(7)
    s_cbranch_vccz CH_POLL_fast
    v_cmp_gt_i32 vcc, s53, v75
    s_nop 1
    buffer_load_dword v75, v10, s[36:39], s5 offen sc1
    s_waitcnt vmcnt(7)
    s_cbranch_vccz CH_POLL_fast
    v_cmp_gt_i32 vcc, s53, v76
    s_nop 1
    buffer_load_dword v76, v10, s[36:39], s5 offen sc1
    s_waitcnt vmcnt(7)
    s_cbranch_vccz CH_POLL_fast
    v_cmp_gt_i32 vcc, s53, v77
    s_nop 1
    buffer_load_dword v77, v10, s[36:39], s5 offen sc1
    s_waitcnt vmcnt(7)
    s_cbranch_vccz CH_POLL_fast
    v_cmp_gt_i32 vcc, s53, v78
    s_nop 1
    buffer_load_dword v78, v10, s[36:39], s5 offen sc1
    s_waitcnt vmcnt(7)
    s_cbranch_vccz CH_POLL_fast
    v_cmp_gt_i32 vcc, s53, v79
    s_nop 1
    buffer_load_dword v79, v10, s[36:39], s5 offen sc1
    s_waitcnt vmcnt(7)
    s_cbranch_vccz CH_POLL_fast
    v_cmp_gt_i32 vcc, s53, v80
    s_nop 1
    buffer_load_dword v80, v10, s[36:39], s5 offen sc1
    s_waitcnt vmcnt(7)
    s_cbranch_vccz CH_POLL_fast
    v_cmp_gt_i32 vcc, s53, v81
    s_nop 1
    s_add_u32 s57, s57, 1
    s_cmp_gt_u32 s57, 65536
    s_cbranch_scc0 CH_PROBE_fast
    s_branch CH_DONE
.p2align 6
CH_HK23_fast:
    s_waitcnt vmcnt(0)
    s_cmp_eq_u32 s54, 2
    s_cbranch_scc1 CH_POLL_fast
    s_cmp_eq_u32 s54, 3
    s_cbranch_scc1 CH_HK3_fast
    s_endpgm
CH_HK3_fast:
    v_mov_b32 v40, -1
    v_lshrrev_b32 v41, 2, v0
    s_waitcnt vmcnt(0)
    buffer_store_dword v40, v41, s[36:39], s67 offen
    v_add_u32 v11, 161024, v10
    ds_read_b32 v11, v11
    s_waitcnt lgkmcnt(0)
    v_readlane_b32 s8, v11, 3
    v_readlane_b32 s9, v11, 7
    v_readlane_b32 s10, v11, 11
    v_readlane_b32 s11, v11, 15
    s_lshl_b32 s8, s8, 2
    s_lshl_b32 s9, s9, 2
    s_add_u32 s9, s9, 1
    s_min_u32 s8, s8, s9
    s_lshl_b32 s10, s10, 2
    s_add_u32 s10, s10, 2
    s_min_u32 s8, s8, s10
    s_lshl_b32 s11, s11, 2
    s_add_u32 s11, s11, 3
    s_min_u32 s8, s8, s11
    s_max_u32 s7, s7, s8
    s_add_u32 s55, s53, 3
    s_min_u32 s55, s55, 64
CH_KV_fast:
    s_cmp_ge_u32 s7, s55
    s_cbranch_scc1 CH_KV_fast_OK
    s_load_dwordx4 s[8:11], s[0:1], 0 glc
    s_add_u32 s57, s57, 1
    s_cmp_gt_u32 s57, 65536
    s_cbranch_scc1 CH_DONE
    s_waitcnt lgkmcnt(0)
    s_lshl_b32 s8, s8, 2
    s_lshl_b32 s9, s9, 2
    s_add_u32 s9, s9, 1
    s_min_u32 s8, s8, s9
    s_lshl_b32 s10, s10, 2
    s_add_u32 s10, s10, 2
    s_min_u32 s8, s8, s10
    s_lshl_b32 s11, s11, 2
    s_add_u32 s11, s11, 3
    s_min_u32 s8, s8, s11
    s_mov_b32 s7, s8
    s_branch CH_KV_fast
CH_KV_fast_OK:
    s_branch CH_POLL_fast
CH_LW0_fast_L:
    s_nop 15
    s_nop 15
    s_nop 15
    s_nop 7
    s_branch CH_LW0_fast
CH_POLL_slow:
    s_barrier
    buffer_load_dwordx4 v[64:67], v1, s[36:39], s62 offen sc1
    v_mov_b64 v[16:17], 0
    s_mov_b32 m0, s47
    s_add_u32 s69, s69, 262144
    s_sub_u32 s54, s6, 8195
    v_mov_b64 v[18:19], 0
    s_add_u32 s63, s63, 262144
    s_add_u32 s64, s64, 262144
    s_nop 0
    v_mov_b64 v[20:21], 0
    s_nop 2
    buffer_load_dwordx4 v[68:71], v1, s[36:39], s91 offen offset:1024 sc1
    v_mov_b64 v[22:23], 0
    s_nop 2
    v_mov_b64 v[24:25], 0
    s_nop 2
    v_mov_b64 v[26:27], 0
    s_nop 2
    buffer_load_dwordx4 v1, s[36:39], s91 offen offset:1024 sc1 lds
    s_waitcnt lgkmcnt(0)
    v_mov_b64 v[28:29], 0
    v_mov_b64 v[30:31], 0
    s_nop 1
    v_mov_b64 v[32:33], 0
    v_mov_b64 v[34:35], 0
    s_nop 1
    v_lshl_add_u32 v44, v0, 1, s69
    s_nop 1
    s_mov_b64 exec, 0x8888
    v_lshrrev_b32 v44, 2, v10
    v_add_u32 v44, s54, v44
    s_mov_b64 exec, -1
    s_nop 0
    v_mov_b64 v[36:37], 0
    v_mov_b64 v[38:39], 0
    s_nop 1
    v_xor_b32 v45, 2048, v3
    v_xor_b32 v46, 4096, v3
    v_xor_b32 v47, 6144, v3
    s_nop 0
    v_mov_b64 v[16:17], 0
    s_nop 2
    v_mov_b64 v[16:17], 0
    s_nop 2
CH_TOP_slow:
    s_waitcnt vmcnt(2)
    v_smfmac_f32_16x16x64_bf16 v[16:19], v[64:67], v[96:103], v7
    ds_write_b128 v3, v[64:67]
    v_max3_u32 v11, v64, v65, v66
    v_smfmac_f32_16x16x64_bf16 v[20:23], v[64:67], v[104:111], v7
    v_max_u32 v11, v11, v67
    v_smfmac_f32_16x16x64_bf16 v[24:27], v[64:67], v[112:119], v7
    buffer_load_dwordx4 v[56:59], v1, s[36:39], s64 offen sc1
    v_smfmac_f32_16x16x64_bf16 v[28:31], v[64:67], v[120:127], v7
    s_waitcnt vmcnt(2)
    v_max3_u32 v11, v11, v68, v69
    v_smfmac_f32_16x16x64_bf16 v[32:35], v[64:67], v[128:135], v7
    v_max3_u32 v11, v11, v70, v71
    v_smfmac_f32_16x16x64_bf16 v[36:39], v[64:67], v[136:143], v7
    v_cmp_eq_u32 vcc, -1, v11
    v_smfmac_f32_16x16x64_bf16 v[16:19], v[68:71], v[144:151], v7
    buffer_load_dwordx4 v[60:63], v1, s[36:39], s64 offen offset:1024 sc1
    v_smfmac_f32_16x16x64_bf16 v[20:23], v[68:71], v[152:159], v7
    s_cbranch_vccnz CH_RETRY_slow
CH_JOIN_slow:
    s_waitcnt vmcnt(2) lgkmcnt(0)
    s_barrier
    ds_read_b128 v[72:75], v45 offset:0
    v_smfmac_f32_16x16x64_bf16 v[24:27], v[68:71], v[160:167], v7
    ds_read_b128 v[80:83], v46 offset:0
    v_smfmac_f32_16x16x64_bf16 v[28:31], v[68:71], v[168:175], v7
    s_add_u32 m0, s60, s47
    ds_read_b128 v[88:91], v47 offset:0
    v_smfmac_f32_16x16x64_bf16 v[32:35], v[68:71], v[176:183], v7
    buffer_store_dword v40, v9, s[36:39], s65 offen sc1
    v_smfmac_f32_16x16x64_bf16 v[36:39], v[68:71], v[184:191], v7
    ds_read_b128 v[96:99], v1 offset:8192
    s_waitcnt lgkmcnt(3)
    v_smfmac_f32_16x16x64_bf16 v[16:19], v[72:75], v[192:199], v7
    s_add_u32 s53, s53, 1
    ds_read_b128 v[100:103], v1 offset:9216
    buffer_load_dwordx4 v1, s[36:39], s63 offen sc1 lds
    v_smfmac_f32_16x16x64_bf16 v[20:23], v[72:75], v[200:207], v7
    ds_read_b128 v[104:107], v1 offset:24576
    v_smfmac_f32_16x16x64_bf16 v[24:27], v[72:75], v[208:215], v7
    s_waitcnt lgkmcnt(4)
    ds_read_b128 v[108:111], v1 offset:25600
    v_smfmac_f32_16x16x64_bf16 v[16:19], v[80:83], v[216:223], v7
    ds_read_b128 v[76:79], v45 offset:1024
    v_smfmac_f32_16x16x64_bf16 v[20:23], v[80:83], v[224:231], v7
    ds_read_b128 v[84:87], v46 offset:1024
    buffer_load_dwordx4 v1, s[36:39], s63 offen offset:1024 sc1 lds
    v_smfmac_f32_16x16x64_bf16 v[24:27], v[80:83], v[232:239], v7
    s_waitcnt lgkmcnt(6)
    ds_read_b128 v[92:95], v47 offset:1024
    v_smfmac_f32_16x16x64_bf16 v[16:19], v[88:91], v[240:247], v7
    s_and_b32 s66, s53, 1
    v_smfmac_f32_16x16x64_bf16 v[20:23], v[88:91], v[248:255], v7
    s_mov_b32 s57, 0
    ds_read_b128 v[112:115], v1 offset:40960
    v_smfmac_f32_16x16x64_bf16 v[24:27], v[88:91], a[0:7], v7
    s_waitcnt lgkmcnt(3)
    ds_read_b128 v[116:119], v1 offset:41984
    v_smfmac_f32_16x16x64_bf16 v[16:19], v[76:79], a[8:15], v7
    s_mov_b32 m0, 161024
    ds_read_b128 v[120:123], v1 offset:57344
    buffer_load_dword v44, s[36:39], 0 offen sc1 lds
    v_smfmac_f32_16x16x64_bf16 v[20:23], v[76:79], a[16:23], v7
    s_xor_b32 s60, s60, 24576
    ds_read_b128 v[124:127], v1 offset:58368
    v_smfmac_f32_16x16x64_bf16 v[24:27], v[76:79], a[24:31], v7
    s_waitcnt lgkmcnt(4)
    v_add_u32 v11, s60, v0
    v_smfmac_f32_16x16x64_bf16 v[16:19], v[84:87], v[96:103], v7
    s_add_u32 s56, s53, 3
    v_smfmac_f32_16x16x64_bf16 v[20:23], v[84:87], v[104:111], v7
    s_waitcnt lgkmcnt(2)
    ds_read_b128 v[96:99], v2 offset:0
    v_smfmac_f32_16x16x64_bf16 v[16:19], v[92:95], v[112:119], v7
    s_waitcnt lgkmcnt(1)
    ds_read_b128 v[100:103], v2 offset:1024
    v_smfmac_f32_16x16x64_bf16 v[20:23], v[92:95], v[120:127], v7
    ds_read_b128 v[104:107], v2 offset:16384
    v_smfmac_f32_16x16x64_bf16 v[24:27], v[84:87], a[32:39], v7
    s_and_b32 s56, s56, 3
    ds_read_b128 v[108:111], v2 offset:17408
    v_add_f32 v16, v16, v18
    v_smfmac_f32_16x16x64_bf16 v[24:27], v[92:95], a[40:47], v7
    s_lshl_b32 s54, s56, 13
    ds_read_b128 v[112:115], v2 offset:32768
    v_add_f32 v17, v17, v19
    v_smfmac_f32_16x16x64_bf16 v[28:31], v[72:75], a[48:55], v7
    s_add_u32 s67, s54, s61
    ds_read_b128 v[116:119], v2 offset:33792
    v_cvt_pk_bf16_f32 v16, v16, v17
    v_smfmac_f32_16x16x64_bf16 v[28:31], v[80:83], a[56:63], v7
    s_xor_b32 s54, s54, 16384
    ds_read_b128 v[120:123], v2 offset:49152
    v_add_f32 v20, v20, v22
    v_smfmac_f32_16x16x64_bf16 v[28:31], v[88:91], a[64:71], v7
    s_add_u32 s62, s54, s90
    ds_read_b128 v[124:127], v2 offset:50176
    v_add_f32 v21, v21, v23
    v_smfmac_f32_16x16x64_bf16 v[28:31], v[76:79], a[72:79], v7
    s_add_u32 s91, s62, 3072
    s_lshl_b32 s65, s53, 13
    v_cvt_pk_bf16_f32 v17, v20, v21
    v_smfmac_f32_16x16x64_bf16 v[28:31], v[84:87], a[80:87], v7
    ds_write_b64 v4, v[16:17]
    v_add_f32 v24, v24, v26
    v_smfmac_f32_16x16x64_bf16 v[28:31], v[92:95], a[88:95], v7
    s_add_u32 s65, s65, 36708352
    v_add_f32 v25, v25, v27
    v_smfmac_f32_16x16x64_bf16 v[32:35], v[72:75], a[96:103], v7
    s_waitcnt lgkmcnt(1)
    v_cvt_pk_bf16_f32 v24, v24, v25
    v_smfmac_f32_16x16x64_bf16 v[36:39], v[72:75], a[104:111], v7
    v_add_f32 v28, v28, v30
    v_add_f32 v29, v29, v31
    v_cvt_pk_bf16_f32 v25, v28, v29
    v_smfmac_f32_16x16x64_bf16 v[32:35], v[76:79], v[96:103], v7
    ds_write_b64 v4, v[24:25] offset:128
    v_smfmac_f32_16x16x64_bf16 v[36:39], v[76:79], v[104:111], v7
    v_smfmac_f32_16x16x64_bf16 v[32:35], v[80:83], v[112:119], v7
    v_smfmac_f32_16x16x64_bf16 v[36:39], v[80:83], v[120:127], v7
    v_smfmac_f32_16x16x64_bf16 v[32:35], v[84:87], a[112:119], v7
    s_waitcnt lgkmcnt(0)
    s_barrier
    v_smfmac_f32_16x16x64_bf16 v[36:39], v[84:87], a[120:127], v7
    ds_read_b64_tr_b16 v[40:41], v5 offset:0
    ds_read_b64_tr_b16 v[42:43], v5 offset:64
    v_smfmac_f32_16x16x64_bf16 v[32:35], v[88:91], a[128:135], v7
    ds_read_b64_tr_b16 v[44:45], v5 offset:256
    ds_read_b64_tr_b16 v[46:47], v5 offset:320
    v_smfmac_f32_16x16x64_bf16 v[36:39], v[88:91], a[136:143], v7
    ds_read_b64_tr_b16 v[48:49], v5 offset:512
    ds_read_b64_tr_b16 v[50:51], v5 offset:576
    v_smfmac_f32_16x16x64_bf16 v[32:35], v[92:95], a[144:151], v7
    ds_read_b64_tr_b16 v[52:53], v5 offset:768
    ds_read_b64_tr_b16 v[54:55], v5 offset:832
    v_smfmac_f32_16x16x64_bf16 v[36:39], v[92:95], a[152:159], v7
    ds_read_b128 v[96:99], v11 offset:0
    s_waitcnt lgkmcnt(7)
    v_mfma_f32_16x16x32_bf16 v[24:27], v[40:43], v[40:43], 0
    s_waitcnt lgkmcnt(5)
    ds_read_b128 v[100:103], v11 offset:1024
    ds_read_b128 v[104:107], v11 offset:2048
    v_mfma_f32_16x16x32_bf16 v[24:27], v[44:47], v[44:47], v[24:27]
    s_waitcnt lgkmcnt(5)
    ds_read_b128 v[108:111], v11 offset:3072
    ds_read_b128 v[112:115], v11 offset:4096
    v_mfma_f32_16x16x32_bf16 v[24:27], v[48:51], v[48:51], v[24:27]
    s_waitcnt lgkmcnt(5)
    ds_read_b128 v[116:119], v11 offset:5120
    ds_read_b128 v[120:123], v11 offset:6144
    v_mfma_f32_16x16x32_bf16 v[24:27], v[52:55], v[52:55], v[24:27]
    s_waitcnt lgkmcnt(6)
    ds_read_b128 v[124:127], v11 offset:7168
    v_mfma_f32_16x16x32_bf16 v[16:19], v[96:99], v[40:43], 0
    s_waitcnt lgkmcnt(6)
    v_mov_b64 v[80:81], s[50:51]
    v_mov_b64 v[82:83], s[50:51]
    v_mfma_f32_16x16x32_bf16 v[16:19], v[100:103], v[44:47], v[16:19]
    s_waitcnt lgkmcnt(5)
    v_mov_b64 v[64:65], 0
    v_mov_b64 v[66:67], 0
    v_mfma_f32_16x16x32_bf16 v[16:19], v[104:107], v[48:51], v[16:19]
    s_waitcnt lgkmcnt(4)
    v_mov_b64 v[68:69], 0
    v_mov_b64 v[70:71], 0
    v_mfma_f32_16x16x32_bf16 v[16:19], v[108:111], v[52:55], v[16:19]
    s_waitcnt lgkmcnt(3)
    v_mov_b64 v[72:73], 0
    v_mov_b64 v[74:75], 0
    v_mfma_f32_16x16x32_bf16 v[20:23], v[112:115], v[40:43], 0
    s_waitcnt lgkmcnt(2)
    v_mov_b64 v[76:77], 0
    v_mov_b64 v[78:79], 0
    v_mfma_f32_16x16x32_bf16 v[20:23], v[116:119], v[44:47], v[20:23]
    s_waitcnt lgkmcnt(1)
    v_add_f32 v32, v32, v34
    v_add_f32 v33, v33, v35
    v_mfma_f32_16x16x32_bf16 v[20:23], v[120:123], v[48:51], v[20:23]
    s_waitcnt lgkmcnt(0)
    v_max3_f32 v28, v26, v27, v16
    v_max3_f32 v28, v28, v17, v18
    v_mfma_f32_16x16x32_bf16 v[20:23], v[124:127], v[52:55], v[20:23]
    v_max_f32 v28, v28, v19
    v_cvt_pk_bf16_f32 v32, v32, v33
    v_add_f32 v36, v36, v38
    v_add_f32 v37, v37, v39
    v_cvt_pk_bf16_f32 v33, v36, v37
    s_nop 1
    v_max3_f32 v28, v28, v20, v21
    v_max3_f32 v30, v28, v22, v23
    v_max3_f32 v28, v28, v22, v23
    s_nop 1
    v_permlane16_swap_b32 v28, v30
    v_max_f32 v31, v28, v30
    v_max_f32 v28, v28, v30
    s_nop 1
    v_permlane32_swap_b32 v28, v31
    v_max_f32 v28, v28, v31
    v_mul_f32 v28, s48, v28
    v_pk_fma_f32 v[26:27], v[26:27], s[48:49], v[28:29] op_sel_hi:[1,1,0] neg_lo:[0,0,1] neg_hi:[0,0,1]
    v_pk_fma_f32 v[16:17], v[16:17], s[48:49], v[28:29] op_sel_hi:[1,1,0] neg_lo:[0,0,1] neg_hi:[0,0,1]
    v_pk_fma_f32 v[18:19], v[18:19], s[48:49], v[28:29] op_sel_hi:[1,1,0] neg_lo:[0,0,1] neg_hi:[0,0,1]
    v_pk_fma_f32 v[20:21], v[20:21], s[48:49], v[28:29] op_sel_hi:[1,1,0] neg_lo:[0,0,1] neg_hi:[0,0,1]
    v_pk_fma_f32 v[22:23], v[22:23], s[48:49], v[28:29] op_sel_hi:[1,1,0] neg_lo:[0,0,1] neg_hi:[0,0,1]
    v_exp_f32 v26, v26
    v_exp_f32 v27, v27
    v_exp_f32 v16, v16
    v_cvt_pk_bf16_f32 v12, v26, v27
    v_cvt_pk_bf16_f32 v15, v26, v27
    v_exp_f32 v17, v17
    v_mfma_f32_16x16x16_bf16 v[44:47], v[80:81], v[12:13], 0
    v_exp_f32 v18, v18
    v_mfma_f32_16x16x16_bf16 v[48:51], v[32:33], v[12:13], 0
    v_exp_f32 v19, v19
    v_mfma_f32_16x16x16_bf16 v[52:55], v[32:33], v[14:15], 0
    v_exp_f32 v20, v20
    v_exp_f32 v21, v21
    v_exp_f32 v22, v22
    v_exp_f32 v23, v23
    v_cvt_pk_bf16_f32 v40, v16, v17
    v_cvt_pk_bf16_f32 v41, v18, v19
    v_cvt_pk_bf16_f32 v42, v20, v21
    v_cvt_pk_bf16_f32 v43, v22, v23
    s_nop 1
    v_mfma_f32_16x16x32_bf16 v[44:47], v[80:83], v[40:43], v[44:47]
    s_waitcnt vmcnt(4)
    v_xor_b32 v21, 512, v6
    v_xor_b32 v22, 1024, v6
    v_mfma_f32_16x16x32_bf16 v[48:51], v[56:59], v[40:43], v[48:51]
    v_xor_b32 v23, 1536, v6
    v_lshlrev_b32 v25, 5, v10
    v_mfma_f32_16x16x32_bf16 v[52:55], v[60:63], v[40:43], v[52:55]
    v_rcp_f32_dpp v30, v44 quad_perm:[0,1,0,1] row_mask:0xf bank_mask:0xf
    v_mov_b32 v24, s53
    s_nop 0
    v_mul_f32_dpp v48, v48, v30 quad_perm:[0,1,0,1] row_mask:0xf bank_mask:0xf
    v_mul_f32_dpp v49, v49, v30 quad_perm:[0,1,0,1] row_mask:0xf bank_mask:0xf
    v_mul_f32_dpp v50, v50, v30 quad_perm:[0,1,0,1] row_mask:0xf bank_mask:0xf
    v_mul_f32_dpp v51, v51, v30 quad_perm:[0,1,0,1] row_mask:0xf bank_mask:0xf
    v_cvt_pk_bf16_f32 v80, v48, v49
    v_cvt_pk_bf16_f32 v81, v50, v51
    v_mul_f32_dpp v52, v52, v30 quad_perm:[0,1,0,1] row_mask:0xf bank_mask:0xf
    v_mul_f32_dpp v53, v53, v30 quad_perm:[0,1,0,1] row_mask:0xf bank_mask:0xf
    v_mul_f32_dpp v54, v54, v30 quad_perm:[0,1,0,1] row_mask:0xf bank_mask:0xf
    v_mul_f32_dpp v55, v55, v30 quad_perm:[0,1,0,1] row_mask:0xf bank_mask:0xf
    v_cvt_pk_bf16_f32 v82, v52, v53
    v_cvt_pk_bf16_f32 v83, v54, v55
    ds_write_b128 v6, v[80:83]
    s_nop 0
    v_smfmac_f32_16x16x64_bf16 v[64:67], v[80:83], a[160:167], v7
    ds_read_b128 v[96:99], v2 offset:8192
    v_smfmac_f32_16x16x64_bf16 v[68:71], v[80:83], a[168:175], v7
    ds_read_b128 v[100:103], v2 offset:9216
    v_smfmac_f32_16x16x64_bf16 v[72:75], v[80:83], a[176:183], v7
    ds_read_b128 v[104:107], v2 offset:24576
    v_lshlrev_b32 v25, 5, v10
    s_waitcnt lgkmcnt(3)
    s_barrier
    ds_read_b128 v[84:87], v21
    ds_read_b128 v[88:91], v22
    ds_read_b128 v[92:95], v23
    v_smfmac_f32_16x16x64_bf16 v[76:79], v[80:83], a[184:191], v7
    v_lshlrev_b32 v25, 5, v10
    s_waitcnt lgkmcnt(2)
    v_smfmac_f32_16x16x64_bf16 v[64:67], v[84:87], a[192:199], v7
    ds_read_b128 v[108:111], v2 offset:25600
    s_waitcnt lgkmcnt(2)
    v_smfmac_f32_16x16x64_bf16 v[64:67], v[88:91], a[200:207], v7
    ds_read_b128 v[112:115], v2 offset:40960
    s_waitcnt lgkmcnt(2)
    v_smfmac_f32_16x16x64_bf16 v[64:67], v[92:95], a[208:215], v7
    ds_read_b128 v[116:119], v2 offset:41984
    v_smfmac_f32_16x16x64_bf16 v[68:71], v[84:87], a[216:223], v7
    ds_read_b128 v[120:123], v2 offset:57344
    v_smfmac_f32_16x16x64_bf16 v[68:71], v[88:91], a[224:231], v7
    ds_read_b128 v[124:127], v2 offset:58368
    v_cvt_pk_bf16_f32 v44, v64, v65
    v_cvt_pk_bf16_f32 v45, v66, v67
    v_bfi_b32 v44, 1, s66, v44
    v_smfmac_f32_16x16x64_bf16 v[68:71], v[92:95], a[232:239], v7
    ds_read_b32 v26, v0 offset:31232
    buffer_store_dwordx2 v[44:45], v8, s[36:39], s98 offen sc1
    v_smfmac_f32_16x16x64_bf16 v[72:75], v[84:87], a[240:247], v7
    v_smfmac_f32_16x16x64_bf16 v[72:75], v[88:91], a[248:255], v7
    s_waitcnt lgkmcnt(10)
    v_cvt_pk_bf16_f32 v46, v68, v69
    v_cvt_pk_bf16_f32 v47, v70, v71
    v_smfmac_f32_16x16x64_bf16 v[72:75], v[92:95], v[96:103], v7
    s_waitcnt lgkmcnt(5)
    v_bfi_b32 v46, 1, s66, v46
    v_smfmac_f32_16x16x64_bf16 v[76:79], v[84:87], v[104:111], v7
    s_waitcnt lgkmcnt(3)
    buffer_store_dwordx2 v[46:47], v8, s[36:39], s99 offen sc1
    v_smfmac_f32_16x16x64_bf16 v[76:79], v[88:91], v[112:119], v7
    s_waitcnt lgkmcnt(1)
    v_cvt_pk_bf16_f32 v48, v72, v73
    v_smfmac_f32_16x16x64_bf16 v[76:79], v[92:95], v[120:127], v7
    s_cmp_lg_u32 s44, 0
    v_cvt_pk_bf16_f32 v49, v74, v75
    v_bfi_b32 v48, 1, s66, v48
    buffer_store_dwordx2 v[48:49], v8, s[36:39], s100 offen sc1
    s_nop 0
    v_cvt_pk_bf16_f32 v50, v76, v77
    v_cvt_pk_bf16_f32 v51, v78, v79
    v_bfi_b32 v50, 1, s66, v50
    buffer_store_dwordx2 v[50:51], v8, s[36:39], s101 offen sc1
    s_cbranch_scc1 CH_HK_slow
    s_waitcnt lgkmcnt(0)
    v_readfirstlane_b32 s54, v26
    s_nop 0
    s_cmp_eq_u32 s54, s53
    s_cbranch_scc1 CH_LW0_slow_L
CH_LW0_slow:
    s_nop 6
    s_nop 6
    s_nop 6
    s_nop 7
CH_SW_slow:
    buffer_load_dwordx4 v[64:67], v1, s[36:39], s58 offen offset:0 sc1
    buffer_load_dwordx4 v[68:71], v1, s[36:39], s58 offen offset:1024 sc1
    s_nop 9
    buffer_load_dwordx4 v[72:75], v1, s[36:39], s58 offen offset:2048 sc1
    buffer_load_dwordx4 v[76:79], v1, s[36:39], s58 offen offset:3072 sc1
    s_nop 9
    buffer_load_dwordx4 v[80:83], v1, s[36:39], s59 offen offset:0 sc1
    buffer_load_dwordx4 v[84:87], v1, s[36:39], s59 offen offset:1024 sc1
    s_nop 9
    buffer_load_dwordx4 v[88:91], v1, s[36:39], s59 offen offset:2048 sc1
    buffer_load_dwordx4 v[92:95], v1, s[36:39], s59 offen offset:3072 sc1
    s_mov_b64 exec, 0xff
    buffer_store_dword v24, v25, s[36:39], s4 offen offset:0 sc1
    s_mov_b64 exec, -1
    s_barrier
    ds_read_b128 v[16:19], v0 offset:28928
    ds_read_b128 v[20:23], v0 offset:30208
    s_cmp_lg_u32 s66, 0
    s_waitcnt lgkmcnt(0)
    s_cbranch_scc1 CH_ODD_slow
    s_waitcnt vmcnt(8)
    v_mfma_f32_16x16x32_bf16 v[40:43], v[16:19], v[64:67], 0
    v_bitop3_b32 v11, v64, v64, v66 bitop3:0xfe
    s_waitcnt vmcnt(7)
    v_mfma_f32_16x16x32_bf16 v[40:43], v[16:19], v[68:71], v[40:43]
    v_bitop3_b32 v11, v11, v68, v70 bitop3:0xfe
    s_waitcnt vmcnt(6)
    v_mfma_f32_16x16x32_bf16 v[40:43], v[20:23], v[72:75], v[40:43]
    v_bitop3_b32 v11, v11, v72, v74 bitop3:0xfe
    s_waitcnt vmcnt(5)
    v_mfma_f32_16x16x32_bf16 v[40:43], v[20:23], v[76:79], v[40:43]
    v_bitop3_b32 v11, v11, v76, v78 bitop3:0xfe
    s_waitcnt vmcnt(4)
    v_mfma_f32_16x16x32_bf16 v[52:55], v[16:19], v[80:83], 0
    v_bitop3_b32 v11, v11, v80, v82 bitop3:0xfe
    s_waitcnt vmcnt(3)
    v_mfma_f32_16x16x32_bf16 v[52:55], v[16:19], v[84:87], v[52:55]
    v_bitop3_b32 v11, v11, v84, v86 bitop3:0xfe
    v_add_f32_dpp v40, v40, v40 row_ror:8 row_mask:0xf bank_mask:0x3
    v_add_f32_dpp v40, v41, v41 row_ror:8 row_mask:0xf bank_mask:0xc
    v_add_f32_dpp v42, v42, v42 row_ror:8 row_mask:0xf bank_mask:0x3
    v_add_f32_dpp v42, v43, v43 row_ror:8 row_mask:0xf bank_mask:0xc
    s_waitcnt vmcnt(2)
    v_mfma_f32_16x16x32_bf16 v[52:55], v[20:23], v[88:91], v[52:55]
    v_bitop3_b32 v11, v11, v88, v90 bitop3:0xfe
    s_waitcnt vmcnt(1)
    v_mfma_f32_16x16x32_bf16 v[52:55], v[20:23], v[92:95], v[52:55]
    v_bitop3_b32 v11, v11, v92, v94 bitop3:0xfe
    v_and_b32 v11, 1, v11
    v_cmp_ne_u32 vcc, 0, v11
    v_add_f32_dpp v41, v40, v40 row_ror:12 row_mask:0xf bank_mask:0x5
    v_add_f32_dpp v41, v42, v42 row_ror:4 row_mask:0xf bank_mask:0xa
    s_nop 1
    v_add_f32_dpp v52, v52, v52 row_ror:8 row_mask:0xf bank_mask:0x3
    v_add_f32_dpp v52, v53, v53 row_ror:8 row_mask:0xf bank_mask:0xc
    v_add_f32_dpp v54, v54, v54 row_ror:8 row_mask:0xf bank_mask:0x3
    v_add_f32_dpp v54, v55, v55 row_ror:8 row_mask:0xf bank_mask:0xc
    v_add_f32_dpp v53, v52, v52 row_ror:12 row_mask:0xf bank_mask:0x5
    s_cbranch_vccnz CH_RED2_slow
    v_add_f32_dpp v53, v54, v54 row_ror:4 row_mask:0xf bank_mask:0xa
    v_cvt_pk_bf16_f32 v40, v41, v53
    buffer_store_dword v40, v9, s[36:39], s62 offen sc1
CH_MST_slow:
    s_cmp_eq_u32 s53, 62
    s_cbranch_scc0 CH_ON_slow
    buffer_store_dword v40, v9, s[36:39], s65 offen sc1
    s_branch CH_LAST
CH_ON_slow:
    ds_read_b128 v[96:99], v1 offset:0
    ds_read_b128 v[100:103], v1 offset:1024
    ds_read_b128 v[104:107], v1 offset:16384
    ds_read_b128 v[108:111], v1 offset:17408
    ds_read_b128 v[112:115], v1 offset:32768
    ds_read_b128 v[116:119], v1 offset:33792
    ds_read_b128 v[120:123], v1 offset:49152
    ds_read_b128 v[124:127], v1 offset:50176
    s_branch CH_POLL_slow
.p2align 6
CH_ODD_slow:
    s_waitcnt vmcnt(8)
    v_mfma_f32_16x16x32_bf16 v[40:43], v[16:19], v[64:67], 0
    v_bitop3_b32 v11, v64, v64, v66 bitop3:0x80
    s_waitcnt vmcnt(7)
    v_mfma_f32_16x16x32_bf16 v[40:43], v[16:19], v[68:71], v[40:43]
    v_bitop3_b32 v11, v11, v68, v70 bitop3:0x80
    s_waitcnt vmcnt(6)
    v_mfma_f32_16x16x32_bf16 v[40:43], v[20:23], v[72:75], v[40:43]
    v_bitop3_b32 v11, v11, v72, v74 bitop3:0x80
    s_waitcnt vmcnt(5)
    v_mfma_f32_16x16x32_bf16 v[40:43], v[20:23], v[76:79], v[40:43]
    v_bitop3_b32 v11, v11, v76, v78 bitop3:0x80
    s_waitcnt vmcnt(4)
    v_mfma_f32_16x16x32_bf16 v[52:55], v[16:19], v[80:83], 0
    v_bitop3_b32 v11, v11, v80, v82 bitop3:0x80
    s_waitcnt vmcnt(3)
    v_mfma_f32_16x16x32_bf16 v[52:55], v[16:19], v[84:87], v[52:55]
    v_bitop3_b32 v11, v11, v84, v86 bitop3:0x80
    v_add_f32_dpp v40, v40, v40 row_ror:8 row_mask:0xf bank_mask:0x3
    v_add_f32_dpp v40, v41, v41 row_ror:8 row_mask:0xf bank_mask:0xc
    v_add_f32_dpp v42, v42, v42 row_ror:8 row_mask:0xf bank_mask:0x3
    v_add_f32_dpp v42, v43, v43 row_ror:8 row_mask:0xf bank_mask:0xc
    s_waitcnt vmcnt(2)
    v_mfma_f32_16x16x32_bf16 v[52:55], v[20:23], v[88:91], v[52:55]
    v_bitop3_b32 v11, v11, v88, v90 bitop3:0x80
    s_waitcnt vmcnt(1)
    v_mfma_f32_16x16x32_bf16 v[52:55], v[20:23], v[92:95], v[52:55]
    v_bitop3_b32 v11, v11, v92, v94 bitop3:0x80
    v_and_b32 v11, 1, v11
    v_cmp_ne_u32 vcc, 1, v11
    v_add_f32_dpp v41, v40, v40 row_ror:12 row_mask:0xf bank_mask:0x5
    v_add_f32_dpp v41, v42, v42 row_ror:4 row_mask:0xf bank_mask:0xa
    s_nop 1
    v_add_f32_dpp v52, v52, v52 row_ror:8 row_mask:0xf bank_mask:0x3
    v_add_f32_dpp v52, v53, v53 row_ror:8 row_mask:0xf bank_mask:0xc
    v_add_f32_dpp v54, v54, v54 row_ror:8 row_mask:0xf bank_mask:0x3
    v_add_f32_dpp v54, v55, v55 row_ror:8 row_mask:0xf bank_mask:0xc
    v_add_f32_dpp v53, v52, v52 row_ror:12 row_mask:0xf bank_mask:0x5
    s_cbranch_vccnz CH_RED2_slow
    v_add_f32_dpp v53, v54, v54 row_ror:4 row_mask:0xf bank_mask:0xa
    v_cvt_pk_bf16_f32 v40, v41, v53
    buffer_store_dword v40, v9, s[36:39], s62 offen sc1
    s_branch CH_MST_slow
.p2align 6
CH_RED2_slow:
    buffer_load_dwordx4 v[64:67], v1, s[36:39], s58 offen offset:0 sc1
    buffer_load_dwordx4 v[68:71], v1, s[36:39], s58 offen offset:1024 sc1
    buffer_load_dwordx4 v[72:75], v1, s[36:39], s58 offen offset:2048 sc1
    buffer_load_dwordx4 v[76:79], v1, s[36:39], s58 offen offset:3072 sc1
    buffer_load_dwordx4 v[80:83], v1, s[36:39], s59 offen offset:0 sc1
    buffer_load_dwordx4 v[84:87], v1, s[36:39], s59 offen offset:1024 sc1
    buffer_load_dwordx4 v[88:91], v1, s[36:39], s59 offen offset:2048 sc1
    buffer_load_dwordx4 v[92:95], v1, s[36:39], s59 offen offset:3072 sc1
    s_add_u32 s54, s53, 1
    v_mov_b32 v11, s54
    ds_write_b32 v0, v11 offset:31232
    s_add_u32 s57, s57, 1
    s_cmp_gt_u32 s57, 65536
    s_cbranch_scc1 CH_DONE
    s_cmp_lg_u32 s66, 0
    s_cbranch_scc1 CH_ODD2_slow
    s_waitcnt vmcnt(7)
    v_mfma_f32_16x16x32_bf16 v[40:43], v[16:19], v[64:67], 0
    v_bitop3_b32 v11, v64, v64, v66 bitop3:0xfe
    s_waitcnt vmcnt(6)
    v_mfma_f32_16x16x32_bf16 v[40:43], v[16:19], v[68:71], v[40:43]
    v_bitop3_b32 v11, v11, v68, v70 bitop3:0xfe
    s_waitcnt vmcnt(5)
    v_mfma_f32_16x16x32_bf16 v[40:43], v[20:23], v[72:75], v[40:43]
    v_bitop3_b32 v11, v11, v72, v74 bitop3:0xfe
    s_waitcnt vmcnt(4)
    v_mfma_f32_16x16x32_bf16 v[40:43], v[20:23], v[76:79], v[40:43]
    v_bitop3_b32 v11, v11, v76, v78 bitop3:0xfe
    s_waitcnt vmcnt(3)
    v_mfma_f32_16x16x32_bf16 v[52:55], v[16:19], v[80:83], 0
    v_bitop3_b32 v11, v11, v80, v82 bitop3:0xfe
    s_waitcnt vmcnt(2)
    v_mfma_f32_16x16x32_bf16 v[52:55], v[16:19], v[84:87], v[52:55]
    v_bitop3_b32 v11, v11, v84, v86 bitop3:0xfe
    v_add_f32_dpp v40, v40, v40 row_ror:8 row_mask:0xf bank_mask:0x3
    v_add_f32_dpp v40, v41, v41 row_ror:8 row_mask:0xf bank_mask:0xc
    v_add_f32_dpp v42, v42, v42 row_ror:8 row_mask:0xf bank_mask:0x3
    v_add_f32_dpp v42, v43, v43 row_ror:8 row_mask:0xf bank_mask:0xc
    s_waitcnt vmcnt(1)
    v_mfma_f32_16x16x32_bf16 v[52:55], v[20:23], v[88:91], v[52:55]
    v_bitop3_b32 v11, v11, v88, v90 bitop3:0xfe
    s_waitcnt vmcnt(0)
    v_mfma_f32_16x16x32_bf16 v[52:55], v[20:23], v[92:95], v[52:55]
    v_bitop3_b32 v11, v11, v92, v94 bitop3:0xfe
    v_and_b32 v11, 1, v11
    v_cmp_ne_u32 vcc, 0, v11
    v_add_f32_dpp v41, v40, v40 row_ror:12 row_mask:0xf bank_mask:0x5
    v_add_f32_dpp v41, v42, v42 row_ror:4 row_mask:0xf bank_mask:0xa
    s_nop 1
    v_add_f32_dpp v52, v52, v52 row_ror:8 row_mask:0xf bank_mask:0x3
    v_add_f32_dpp v52, v53, v53 row_ror:8 row_mask:0xf bank_mask:0xc
    v_add_f32_dpp v54, v54, v54 row_ror:8 row_mask:0xf bank_mask:0x3
    v_add_f32_dpp v54, v55, v55 row_ror:8 row_mask:0xf bank_mask:0xc
    v_add_f32_dpp v53, v52, v52 row_ror:12 row_mask:0xf bank_mask:0x5
    s_cbranch_vccnz CH_RED2_slow
    v_add_f32_dpp v53, v54, v54 row_ror:4 row_mask:0xf bank_mask:0xa
    v_cvt_pk_bf16_f32 v40, v41, v53
    buffer_store_dword v40, v9, s[36:39], s62 offen sc1
    s_branch CH_MST_slow
CH_ODD2_slow:
    s_waitcnt vmcnt(7)
    v_mfma_f32_16x16x32_bf16 v[40:43], v[16:19], v[64:67], 0
    v_bitop3_b32 v11, v64, v64, v66 bitop3:0x80
    s_waitcnt vmcnt(6)
    v_mfma_f32_16x16x32_bf16 v[40:43], v[16:19], v[68:71], v[40:43]
    v_bitop3_b32 v11, v11, v68, v70 bitop3:0x80
    s_waitcnt vmcnt(5)
    v_mfma_f32_16x16x32_bf16 v[40:43], v[20:23], v[72:75], v[40:43]
    v_bitop3_b32 v11, v11, v72, v74 bitop3:0x80
    s_waitcnt vmcnt(4)
    v_mfma_f32_16x16x32_bf16 v[40:43], v[20:23], v[76:79], v[40:43]
    v_bitop3_b32 v11, v11, v76, v78 bitop3:0x80
    s_waitcnt vmcnt(3)
    v_mfma_f32_16x16x32_bf16 v[52:55], v[16:19], v[80:83], 0
    v_bitop3_b32 v11, v11, v80, v82 bitop3:0x80
    s_waitcnt vmcnt(2)
    v_mfma_f32_16x16x32_bf16 v[52:55], v[16:19], v[84:87], v[52:55]
    v_bitop3_b32 v11, v11, v84, v86 bitop3:0x80
    v_add_f32_dpp v40, v40, v40 row_ror:8 row_mask:0xf bank_mask:0x3
    v_add_f32_dpp v40, v41, v41 row_ror:8 row_mask:0xf bank_mask:0xc
    v_add_f32_dpp v42, v42, v42 row_ror:8 row_mask:0xf bank_mask:0x3
    v_add_f32_dpp v42, v43, v43 row_ror:8 row_mask:0xf bank_mask:0xc
    s_waitcnt vmcnt(1)
    v_mfma_f32_16x16x32_bf16 v[52:55], v[20:23], v[88:91], v[52:55]
    v_bitop3_b32 v11, v11, v88, v90 bitop3:0x80
    s_waitcnt vmcnt(0)
    v_mfma_f32_16x16x32_bf16 v[52:55], v[20:23], v[92:95], v[52:55]
    v_bitop3_b32 v11, v11, v92, v94 bitop3:0x80
    v_and_b32 v11, 1, v11
    v_cmp_ne_u32 vcc, 1, v11
    v_add_f32_dpp v41, v40, v40 row_ror:12 row_mask:0xf bank_mask:0x5
    v_add_f32_dpp v41, v42, v42 row_ror:4 row_mask:0xf bank_mask:0xa
    s_nop 1
    v_add_f32_dpp v52, v52, v52 row_ror:8 row_mask:0xf bank_mask:0x3
    v_add_f32_dpp v52, v53, v53 row_ror:8 row_mask:0xf bank_mask:0xc
    v_add_f32_dpp v54, v54, v54 row_ror:8 row_mask:0xf bank_mask:0x3
    v_add_f32_dpp v54, v55, v55 row_ror:8 row_mask:0xf bank_mask:0xc
    v_add_f32_dpp v53, v52, v52 row_ror:12 row_mask:0xf bank_mask:0x5
    s_cbranch_vccnz CH_RED2_slow
    v_add_f32_dpp v53, v54, v54 row_ror:4 row_mask:0xf bank_mask:0xa
    v_cvt_pk_bf16_f32 v40, v41, v53
    buffer_store_dword v40, v9, s[36:39], s62 offen sc1
    s_branch CH_MST_slow
.p2align 6
CH_RETRY_slow:
    s_mov_b64 exec, vcc
    buffer_load_dwordx4 v[64:67], v1, s[36:39], s62 offen sc1
    buffer_load_dwordx4 v[68:71], v1, s[36:39], s91 offen offset:1024 sc1
    s_mov_b64 exec, -1
    s_waitcnt vmcnt(4)
    ds_read_b128 v[72:75], v3
    ds_read_b128 v[76:79], v3 offset:1024
    v_mov_b64 v[16:17], 0
    v_mov_b64 v[18:19], 0
    v_mov_b64 v[20:21], 0
    v_mov_b64 v[22:23], 0
    v_mov_b64 v[24:25], 0
    v_mov_b64 v[26:27], 0
    v_mov_b64 v[28:29], 0
    v_mov_b64 v[30:31], 0
    v_mov_b64 v[32:33], 0
    v_mov_b64 v[34:35], 0
    v_mov_b64 v[36:37], 0
    v_mov_b64 v[38:39], 0
    s_mov_b64 exec, vcc
    s_waitcnt lgkmcnt(0)
    v_mov_b64 v[64:65], v[72:73]
    v_mov_b64 v[66:67], v[74:75]
    v_mov_b64 v[68:69], v[76:77]
    v_mov_b64 v[70:71], v[78:79]
    v_max3_u32 v11, v64, v65, v66
    v_max3_u32 v11, v11, v67, v68
    v_max3_u32 v11, v11, v69, v70
    v_max_u32 v11, v11, v71
    v_cmp_eq_u32 vcc, -1, v11
    buffer_load_dwordx4 v[64:67], v1, s[36:39], s62 offen sc1
    buffer_load_dwordx4 v[68:71], v1, s[36:39], s91 offen offset:1024 sc1
    s_mov_b64 exec, -1
    s_cbranch_vccnz CH_RETRY2_slow
CH_FIN_slow:
    s_add_u32 s54, s53, 1
    v_mov_b32 v11, s54
    ds_write_b32 v0, v11 offset:31232
    ds_write_b128 v3, v[64:67]
    ds_write_b128 v3, v[68:71] offset:1024
    v_smfmac_f32_16x16x64_bf16 v[16:19], v[64:67], v[96:103], v7
    v_smfmac_f32_16x16x64_bf16 v[20:23], v[64:67], v[104:111], v7
    v_smfmac_f32_16x16x64_bf16 v[24:27], v[64:67], v[112:119], v7
    v_smfmac_f32_16x16x64_bf16 v[28:31], v[64:67], v[120:127], v7
    v_smfmac_f32_16x16x64_bf16 v[32:35], v[64:67], v[128:135], v7
    v_smfmac_f32_16x16x64_bf16 v[36:39], v[64:67], v[136:143], v7
    v_smfmac_f32_16x16x64_bf16 v[16:19], v[68:71], v[144:151], v7
    v_smfmac_f32_16x16x64_bf16 v[20:23], v[68:71], v[152:159], v7
    s_waitcnt vmcnt(0) lgkmcnt(0)
    s_branch CH_JOIN_slow
CH_RETRY2_slow:
    s_mov_b64 exec, vcc
    buffer_load_dwordx4 v[64:67], v1, s[36:39], s62 offen sc1
    buffer_load_dwordx4 v[68:71], v1, s[36:39], s91 offen offset:1024 sc1
    s_add_u32 s57, s57, 1
    s_waitcnt vmcnt(4)
    v_max3_u32 v11, v64, v65, v66
    v_max3_u32 v11, v11, v67, v68
    v_max3_u32 v11, v11, v69, v70
    v_max_u32 v11, v11, v71
    v_cmp_eq_u32 vcc, -1, v11
    s_cmp_gt_u32 s57, 65536
    s_cbranch_scc1 CH_DONE
    s_mov_b64 exec, -1
    s_cbranch_vccz CH_FIN_slow
    s_branch CH_RETRY2_slow
.p2align 6
CH_HK_slow:
    ds_read_b128 v[96:99], v1 offset:0
    ds_read_b128 v[100:103], v1 offset:1024
    ds_read_b128 v[104:107], v1 offset:16384
    ds_read_b128 v[108:111], v1 offset:17408
    ds_read_b128 v[112:115], v1 offset:32768
    ds_read_b128 v[116:119], v1 offset:33792
    ds_read_b128 v[120:123], v1 offset:49152
    ds_read_b128 v[124:127], v1 offset:50176
    s_waitcnt lgkmcnt(0)
    s_cmp_eq_u32 s53, 62
    s_cselect_b32 s54, 4, s44
    s_cmp_eq_u32 s54, 1
    s_barrier
    s_cbranch_scc0 CH_HK23_slow
    s_nop 5
    s_nop 5
    s_nop 5
    s_nop 5
    s_mov_b64 vcc, -1
    buffer_load_dword v74, v10, s[36:39], s5 offen sc1
    s_nop 6
    buffer_load_dword v75, v10, s[36:39], s5 offen sc1
    s_nop 6
    buffer_load_dword v76, v10, s[36:39], s5 offen sc1
    s_nop 6
    buffer_load_dword v77, v10, s[36:39], s5 offen sc1
    s_nop 6
    buffer_load_dword v78, v10, s[36:39], s5 offen sc1
    s_nop 6
    buffer_load_dword v79, v10, s[36:39], s5 offen sc1
    s_nop 6
    buffer_load_dword v80, v10, s[36:39], s5 offen sc1
    s_nop 13
CH_PROBE_slow:
    buffer_load_dword v81, v10, s[36:39], s5 offen sc1
    s_waitcnt vmcnt(7)
    s_cbranch_vccz CH_POLL_slow
    v_cmp_gt_i32 vcc, s53, v74
    s_nop 1
    buffer_load_dword v74, v10, s[36:39], s5 offen sc1
    s_waitcnt vmcnt(7)
    s_cbranch_vccz CH_POLL_slow
    v_cmp_gt_i32 vcc, s53, v75
    s_nop 1
    buffer_load_dword v75, v10, s[36:39], s5 offen sc1
    s_waitcnt vmcnt(7)
    s_cbranch_vccz CH_POLL_slow
    v_cmp_gt_i32 vcc, s53, v76
    s_nop 1
    buffer_load_dword v76, v10, s[36:39], s5 offen sc1
    s_waitcnt vmcnt(7)
    s_cbranch_vccz CH_POLL_slow
    v_cmp_gt_i32 vcc, s53, v77
    s_nop 1
    buffer_load_dword v77, v10, s[36:39], s5 offen sc1
    s_waitcnt vmcnt(7)
    s_cbranch_vccz CH_POLL_slow
    v_cmp_gt_i32 vcc, s53, v78
    s_nop 1
    buffer_load_dword v78, v10, s[36:39], s5 offen sc1
    s_waitcnt vmcnt(7)
    s_cbranch_vccz CH_POLL_slow
    v_cmp_gt_i32 vcc, s53, v79
    s_nop 1
    buffer_load_dword v79, v10, s[36:39], s5 offen sc1
    s_waitcnt vmcnt(7)
    s_cbranch_vccz CH_POLL_slow
    v_cmp_gt_i32 vcc, s53, v80
    s_nop 1
    buffer_load_dword v80, v10, s[36:39], s5 offen sc1
    s_waitcnt vmcnt(7)
    s_cbranch_vccz CH_POLL_slow
    v_cmp_gt_i32 vcc, s53, v81
    s_nop 1
    s_add_u32 s57, s57, 1
    s_cmp_gt_u32 s57, 65536
    s_cbranch_scc0 CH_PROBE_slow
    s_branch CH_DONE
.p2align 6
CH_HK23_slow:
    s_waitcnt vmcnt(0)
    s_cmp_eq_u32 s54, 2
    s_cbranch_scc1 CH_POLL_slow
    s_cmp_eq_u32 s54, 3
    s_cbranch_scc1 CH_HK3_slow
    s_endpgm
CH_HK3_slow:
    v_mov_b32 v40, -1
    v_lshrrev_b32 v41, 2, v0
    s_waitcnt vmcnt(0)
    buffer_store_dword v40, v41, s[36:39], s67 offen sc1
    v_add_u32 v11, 161024, v10
    ds_read_b32 v11, v11
    s_waitcnt lgkmcnt(0)
    v_readlane_b32 s8, v11, 3
    v_readlane_b32 s9, v11, 7
    v_readlane_b32 s10, v11, 11
    v_readlane_b32 s11, v11, 15
    s_lshl_b32 s8, s8, 2
    s_lshl_b32 s9, s9, 2
    s_add_u32 s9, s9, 1
    s_min_u32 s8, s8, s9
    s_lshl_b32 s10, s10, 2
    s_add_u32 s10, s10, 2
    s_min_u32 s8, s8, s10
    s_lshl_b32 s11, s11, 2
    s_add_u32 s11, s11, 3
    s_min_u32 s8, s8, s11
    s_max_u32 s7, s7, s8
    s_add_u32 s55, s53, 3
    s_min_u32 s55, s55, 64
CH_KV_slow:
    s_cmp_ge_u32 s7, s55
    s_cbranch_scc1 CH_KV_slow_OK
    s_load_dwordx4 s[8:11], s[0:1], 0 glc
    s_add_u32 s57, s57, 1
    s_cmp_gt_u32 s57, 65536
    s_cbranch_scc1 CH_DONE
    s_waitcnt lgkmcnt(0)
    s_lshl_b32 s8, s8, 2
    s_lshl_b32 s9, s9, 2
    s_add_u32 s9, s9, 1
    s_min_u32 s8, s8, s9
    s_lshl_b32 s10, s10, 2
    s_add_u32 s10, s10, 2
    s_min_u32 s8, s8, s10
    s_lshl_b32 s11, s11, 2
    s_add_u32 s11, s11, 3
    s_min_u32 s8, s8, s11
    s_mov_b32 s7, s8
    s_branch CH_KV_slow
CH_KV_slow_OK:
    s_branch CH_POLL_slow
CH_LW0_slow_L:
    s_nop 15
    s_nop 15
    s_nop 15
    s_nop 7
    s_branch CH_LW0_slow
CH_LAST:
    s_cmp_lg_u32 s52, 0
    s_cbranch_scc1 CH_NOWB
    s_waitcnt vmcnt(0)
    buffer_wbl2 sc1
CH_NOWB:
CH_DONE:
    s_waitcnt vmcnt(0)
    s_endpgm
QA:
    s_sub_u32 s51, s45, 32
    s_lshr_b32 s48, s51, 2
    s_and_b32 s49, s51, 3
    v_and_b32 v16, 63, v0
    v_mov_b32 v7, 0
    s_lshl_b32 s61, s48, 7
    s_lshl_b32 s51, s49, 2
    s_add_u32 s59, s61, s51
    s_add_u32 s59, s59, 0
    s_add_u32 s61, s61, 8192
    s_lshl_b32 s60, s49, 7
    s_lshl_b32 s51, s48, 2
    s_add_u32 s60, s60, s51
    s_add_u32 s60, s60, 4096
    v_lshrrev_b32 v19, 4, v16
    v_lshlrev_b32 v20, 2, v19
    v_and_b32 v21, 15, v16
    v_xor_b32 v20, v20, v21
    v_lshlrev_b32 v20, 4, v20
    s_lshl_b32 s51, s44, 2
    v_add_u32 v21, s51, v19
    v_lshl_add_u32 v17, v21, 13, v20
    v_bfe_u32 v20, v16, 2, 2
    v_and_b32 v21, 1, v19
    v_lshl_add_u32 v21, v20, 1, v21
    v_lshlrev_b32 v21, 5, v21
    v_lshl_add_u32 v21, v20, 8, v21
    v_and_b32 v20, 3, v16
    v_lshl_add_u32 v21, v20, 3, v21
    v_lshrrev_b32 v19, 1, v19
    v_lshl_add_u32 v18, v19, 11, v21
    s_lshl_b32 s51, s48, 8
    v_add_u32 v17, s51, v17
    s_lshl_b32 s51, s44, 6
    v_xor_b32 v18, s51, v18
    v_add_u32 v22, 0x10000, v18
    s_lshl_b32 s53, s44, 10
    s_mov_b32 s40, s20
    s_mov_b32 s41, s21
    s_mov_b32 s42, 4194304
    s_mov_b32 s43, 0x20000
    s_add_u32 m0, s53, 0
    s_mov_b32 s51, 0
    buffer_load_dwordx4 v17, s[40:43], s51 offen lds
    s_add_u32 m0, s53, 4096
    s_mov_b32 s51, 131072
    buffer_load_dwordx4 v17, s[40:43], s51 offen lds
    s_add_u32 m0, s53, 8192
    s_mov_b32 s51, 262144
    buffer_load_dwordx4 v17, s[40:43], s51 offen lds
    s_add_u32 m0, s53, 12288
    s_mov_b32 s51, 393216
    buffer_load_dwordx4 v17, s[40:43], s51 offen lds
    s_add_u32 m0, s53, 16384
    s_mov_b32 s51, 524288
    buffer_load_dwordx4 v17, s[40:43], s51 offen lds
    s_add_u32 m0, s53, 20480
    s_mov_b32 s51, 655360
    buffer_load_dwordx4 v17, s[40:43], s51 offen lds
    s_add_u32 m0, s53, 24576
    s_mov_b32 s51, 786432
    buffer_load_dwordx4 v17, s[40:43], s51 offen lds
    s_add_u32 m0, s53, 28672
    s_mov_b32 s51, 917504
    buffer_load_dwordx4 v17, s[40:43], s51 offen lds
    s_add_u32 m0, s53, 32768
    s_mov_b32 s51, 1048576
    buffer_load_dwordx4 v17, s[40:43], s51 offen lds
    s_add_u32 m0, s53, 36864
    s_mov_b32 s51, 1179648
    buffer_load_dwordx4 v17, s[40:43], s51 offen lds
    s_add_u32 m0, s53, 40960
    s_mov_b32 s51, 1310720
    buffer_load_dwordx4 v17, s[40:43], s51 offen lds
    s_add_u32 m0, s53, 45056
    s_mov_b32 s51, 1441792
    buffer_load_dwordx4 v17, s[40:43], s51 offen lds
    s_add_u32 m0, s53, 49152
    s_mov_b32 s51, 1572864
    buffer_load_dwordx4 v17, s[40:43], s51 offen lds
    s_add_u32 m0, s53, 53248
    s_mov_b32 s51, 1703936
    buffer_load_dwordx4 v17, s[40:43], s51 offen lds
    s_add_u32 m0, s53, 57344
    s_mov_b32 s51, 1835008
    buffer_load_dwordx4 v17, s[40:43], s51 offen lds
    s_add_u32 m0, s53, 61440
    s_mov_b32 s51, 1966080
    buffer_load_dwordx4 v17, s[40:43], s51 offen lds
    s_add_u32 m0, s53, 65536
    s_mov_b32 s51, 2097152
    buffer_load_dwordx4 v17, s[40:43], s51 offen lds
    s_add_u32 m0, s53, 69632
    s_mov_b32 s51, 2228224
    buffer_load_dwordx4 v17, s[40:43], s51 offen lds
    s_add_u32 m0, s53, 73728
    s_mov_b32 s51, 2359296
    buffer_load_dwordx4 v17, s[40:43], s51 offen lds
    s_add_u32 m0, s53, 77824
    s_mov_b32 s51, 2490368
    buffer_load_dwordx4 v17, s[40:43], s51 offen lds
    s_add_u32 m0, s53, 81920
    s_mov_b32 s51, 2621440
    buffer_load_dwordx4 v17, s[40:43], s51 offen lds
    s_add_u32 m0, s53, 86016
    s_mov_b32 s51, 2752512
    buffer_load_dwordx4 v17, s[40:43], s51 offen lds
    s_add_u32 m0, s53, 90112
    s_mov_b32 s51, 2883584
    buffer_load_dwordx4 v17, s[40:43], s51 offen lds
    s_add_u32 m0, s53, 94208
    s_mov_b32 s51, 3014656
    buffer_load_dwordx4 v17, s[40:43], s51 offen lds
    s_add_u32 m0, s53, 98304
    s_mov_b32 s51, 3145728
    buffer_load_dwordx4 v17, s[40:43], s51 offen lds
    s_add_u32 m0, s53, 102400
    s_mov_b32 s51, 3276800
    buffer_load_dwordx4 v17, s[40:43], s51 offen lds
    s_add_u32 m0, s53, 106496
    s_mov_b32 s51, 3407872
    buffer_load_dwordx4 v17, s[40:43], s51 offen lds
    s_add_u32 m0, s53, 110592
    s_mov_b32 s51, 3538944
    buffer_load_dwordx4 v17, s[40:43], s51 offen lds
    s_add_u32 m0, s53, 114688
    s_mov_b32 s51, 3670016
    buffer_load_dwordx4 v17, s[40:43], s51 offen lds
    s_add_u32 m0, s53, 118784
    s_mov_b32 s51, 3801088
    buffer_load_dwordx4 v17, s[40:43], s51 offen lds
    s_add_u32 m0, s53, 122880
    s_mov_b32 s51, 3932160
    buffer_load_dwordx4 v17, s[40:43], s51 offen lds
    s_add_u32 m0, s53, 126976
    s_mov_b32 s51, 4063232
    buffer_load_dwordx4 v17, s[40:43], s51 offen lds
    s_and_b32 s51, s44, 1
    s_lshl_b32 s51, s51, 3
    v_xor_b32 v1, s51, v16
    v_lshlrev_b32 v1, 4, v1
    v_and_b32 v19, 15, v16
    v_lshrrev_b32 v20, 5, v16
    v_xor_b32 v19, v19, v20
    v_lshlrev_b32 v19, 4, v19
    v_and_b32 v20, 31, v16
    v_lshl_add_u32 v8, v20, 10, v19
    v_xor_b32 v9, 32, v8
    v_xor_b32 v10, 64, v8
    v_xor_b32 v11, 96, v8
    v_xor_b32 v12, 128, v8
    v_xor_b32 v13, 160, v8
    v_xor_b32 v14, 192, v8
    v_xor_b32 v15, 224, v8
    v_lshlrev_b32 v0, 4, v16
    v_and_b32 v19, 15, v16
    v_lshrrev_b32 v20, 5, v16
    v_lshlrev_b32 v19, 4, v19
    v_lshl_add_u32 v19, v20, 8, v19
    v_bfe_u32 v21, v16, 4, 1
    v_lshl_add_u32 v2, v21, 12, v19
    v_add_u32 v2, s53, v2
    v_lshl_add_u32 v3, v21, 10, v19
    s_lshl_b32 s51, s44, 11
    s_add_u32 s56, s51, 65536
    s_mov_b32 s57, s56
    s_add_u32 s51, s51, 16777216
    v_add_u32 v3, s51, v3
    v_and_b32 v19, 7, v16
    v_mul_u32_u24 v19, 1056, v19
    v_lshl_add_u32 v4, v20, 5, v19
    v_bfe_u32 v19, v16, 3, 1
    v_lshl_add_u32 v4, v19, 4, v4
    v_add_u32 v4, 139264, v4
    v_and_b32 v19, 31, v16
    v_mul_u32_u24 v5, 1088, v20
    v_lshl_add_u32 v5, v19, 3, v5
    s_lshl_b32 s51, s44, 8
    s_add_u32 s51, s51, 147712
    v_add_u32 v5, s51, v5
    v_and_b32 v19, 7, v16
    v_lshlrev_b32 v19, 4, v19
    v_lshl_add_u32 v19, v20, 8, v19
    v_bfe_u32 v6, v16, 3, 2
    v_lshl_add_u32 v6, v6, 16, v19
    s_lshr_b32 s51, s44, 1
    s_lshl_b32 s51, s51, 10
    s_and_b32 s52, s44, 1
    s_lshl_b32 s52, s52, 7
    s_add_u32 s51, s51, s52
    v_add_u32 v6, s51, v6
    v_and_b32 v19, 31, v16
    v_lshlrev_b32 v20, 2, v20
    v_sub_u32 v19, v19, v20
    v_cmp_le_i32 s[66:67], 0, v19
    v_cmp_le_i32 s[68:69], 1, v19
    v_cmp_le_i32 s[70:71], 2, v19
    v_cmp_le_i32 s[72:73], 3, v19
    v_cmp_le_i32 s[74:75], 8, v19
    v_cmp_le_i32 s[76:77], 9, v19
    v_cmp_le_i32 s[78:79], 10, v19
    v_cmp_le_i32 s[80:81], 11, v19
    v_cmp_le_i32 s[82:83], 16, v19
    v_cmp_le_i32 s[84:85], 17, v19
    v_cmp_le_i32 s[86:87], 18, v19
    v_cmp_le_i32 s[88:89], 19, v19
    v_cmp_le_i32 s[90:91], 24, v19
    v_cmp_le_i32 s[92:93], 25, v19
    v_cmp_le_i32 s[94:95], 26, v19
    v_cmp_le_i32 s[96:97], 27, v19
    s_lshl_b32 s51, s49, 5
    s_add_u32 s51, s51, s48
    s_lshl_b32 s62, s51, 13
    s_add_u32 s62, s62, 2097152
    s_lshl_b32 s63, s49, 3
    s_add_u32 s63, s63, s44
    s_lshl_b32 s63, s63, 10
    s_add_u32 s63, s63, 36700160
    s_lshl_b32 s64, s49, 18
    s_lshl_b32 s51, s48, 11
    s_add_u32 s64, s64, s51
    s_add_u32 s64, s64, 45088768
    s_mov_b32 s58, 0x3e0293ee
    s_lshl_b32 s65, s44, 13
    s_lshl_b32 s55, s49, 15
    s_add_u32 s55, s55, s65
    s_mov_b32 s50, 0
    s_waitcnt vmcnt(24)
    s_barrier
    ds_read_b64_tr_b16 a[0:1], v18 offset:0
    ds_read_b64_tr_b16 a[2:3], v18 offset:1024
    ds_read_b64_tr_b16 a[4:5], v18 offset:4096
    ds_read_b64_tr_b16 a[6:7], v18 offset:5120
    ds_read_b64_tr_b16 a[8:9], v18 offset:8192
    ds_read_b64_tr_b16 a[10:11], v18 offset:9216
    ds_read_b64_tr_b16 a[12:13], v18 offset:12288
    ds_read_b64_tr_b16 a[14:15], v18 offset:13312
    ds_read_b64_tr_b16 a[16:17], v18 offset:16384
    ds_read_b64_tr_b16 a[18:19], v18 offset:17408
    ds_read_b64_tr_b16 a[20:21], v18 offset:20480
    ds_read_b64_tr_b16 a[22:23], v18 offset:21504
    ds_read_b64_tr_b16 a[24:25], v18 offset:24576
    ds_read_b64_tr_b16 a[26:27], v18 offset:25600
    ds_read_b64_tr_b16 a[28:29], v18 offset:28672
    ds_read_b64_tr_b16 a[30:31], v18 offset:29696
    s_waitcnt lgkmcnt(0)
    s_barrier
    s_mov_b32 s40, s22
    s_mov_b32 s41, s23
    s_mov_b32 s42, 4194304
    s_mov_b32 s43, 0x20000
    s_add_u32 m0, s53, 0
    s_mov_b32 s51, 0
    buffer_load_dwordx4 v17, s[40:43], s51 offen lds
    s_add_u32 m0, s53, 4096
    s_mov_b32 s51, 131072
    buffer_load_dwordx4 v17, s[40:43], s51 offen lds
    s_add_u32 m0, s53, 8192
    s_mov_b32 s51, 262144
    buffer_load_dwordx4 v17, s[40:43], s51 offen lds
    s_add_u32 m0, s53, 12288
    s_mov_b32 s51, 393216
    buffer_load_dwordx4 v17, s[40:43], s51 offen lds
    s_add_u32 m0, s53, 16384
    s_mov_b32 s51, 524288
    buffer_load_dwordx4 v17, s[40:43], s51 offen lds
    s_add_u32 m0, s53, 20480
    s_mov_b32 s51, 655360
    buffer_load_dwordx4 v17, s[40:43], s51 offen lds
    s_add_u32 m0, s53, 24576
    s_mov_b32 s51, 786432
    buffer_load_dwordx4 v17, s[40:43], s51 offen lds
    s_add_u32 m0, s53, 28672
    s_mov_b32 s51, 917504
    buffer_load_dwordx4 v17, s[40:43], s51 offen lds
    s_waitcnt vmcnt(24)
    s_barrier
    ds_read_b64_tr_b16 a[32:33], v18 offset:32768
    ds_read_b64_tr_b16 a[34:35], v18 offset:33792
    ds_read_b64_tr_b16 a[36:37], v18 offset:36864
    ds_read_b64_tr_b16 a[38:39], v18 offset:37888
    ds_read_b64_tr_b16 a[40:41], v18 offset:40960
    ds_read_b64_tr_b16 a[42:43], v18 offset:41984
    ds_read_b64_tr_b16 a[44:45], v18 offset:45056
    ds_read_b64_tr_b16 a[46:47], v18 offset:46080
    ds_read_b64_tr_b16 a[48:49], v18 offset:49152
    ds_read_b64_tr_b16 a[50:51], v18 offset:50176
    ds_read_b64_tr_b16 a[52:53], v18 offset:53248
    ds_read_b64_tr_b16 a[54:55], v18 offset:54272
    ds_read_b64_tr_b16 a[56:57], v18 offset:57344
    ds_read_b64_tr_b16 a[58:59], v18 offset:58368
    ds_read_b64_tr_b16 a[60:61], v18 offset:61440
    ds_read_b64_tr_b16 a[62:63], v18 offset:62464
    s_waitcnt lgkmcnt(0)
    s_barrier
    s_add_u32 m0, s53, 32768
    s_mov_b32 s51, 1048576
    buffer_load_dwordx4 v17, s[40:43], s51 offen lds
    s_add_u32 m0, s53, 36864
    s_mov_b32 s51, 1179648
    buffer_load_dwordx4 v17, s[40:43], s51 offen lds
    s_add_u32 m0, s53, 40960
    s_mov_b32 s51, 1310720
    buffer_load_dwordx4 v17, s[40:43], s51 offen lds
    s_add_u32 m0, s53, 45056
    s_mov_b32 s51, 1441792
    buffer_load_dwordx4 v17, s[40:43], s51 offen lds
    s_add_u32 m0, s53, 49152
    s_mov_b32 s51, 1572864
    buffer_load_dwordx4 v17, s[40:43], s51 offen lds
    s_add_u32 m0, s53, 53248
    s_mov_b32 s51, 1703936
    buffer_load_dwordx4 v17, s[40:43], s51 offen lds
    s_add_u32 m0, s53, 57344
    s_mov_b32 s51, 1835008
    buffer_load_dwordx4 v17, s[40:43], s51 offen lds
    s_add_u32 m0, s53, 61440
    s_mov_b32 s51, 1966080
    buffer_load_dwordx4 v17, s[40:43], s51 offen lds
    s_waitcnt vmcnt(24)
    s_barrier
    ds_read_b64_tr_b16 a[64:65], v22 offset:0
    ds_read_b64_tr_b16 a[66:67], v22 offset:1024
    ds_read_b64_tr_b16 a[68:69], v22 offset:4096
    ds_read_b64_tr_b16 a[70:71], v22 offset:5120
    ds_read_b64_tr_b16 a[72:73], v22 offset:8192
    ds_read_b64_tr_b16 a[74:75], v22 offset:9216
    ds_read_b64_tr_b16 a[76:77], v22 offset:12288
    ds_read_b64_tr_b16 a[78:79], v22 offset:13312
    ds_read_b64_tr_b16 a[80:81], v22 offset:16384
    ds_read_b64_tr_b16 a[82:83], v22 offset:17408
    ds_read_b64_tr_b16 a[84:85], v22 offset:20480
    ds_read_b64_tr_b16 a[86:87], v22 offset:21504
    ds_read_b64_tr_b16 a[88:89], v22 offset:24576
    ds_read_b64_tr_b16 a[90:91], v22 offset:25600
    ds_read_b64_tr_b16 a[92:93], v22 offset:28672
    ds_read_b64_tr_b16 a[94:95], v22 offset:29696
    s_waitcnt lgkmcnt(0)
    s_barrier
    s_add_u32 m0, s53, 65536
    s_mov_b32 s51, 2097152
    buffer_load_dwordx4 v17, s[40:43], s51 offen lds
    s_add_u32 m0, s53, 69632
    s_mov_b32 s51, 2228224
    buffer_load_dwordx4 v17, s[40:43], s51 offen lds
    s_add_u32 m0, s53, 73728
    s_mov_b32 s51, 2359296
    buffer_load_dwordx4 v17, s[40:43], s51 offen lds
    s_add_u32 m0, s53, 77824
    s_mov_b32 s51, 2490368
    buffer_load_dwordx4 v17, s[40:43], s51 offen lds
    s_add_u32 m0, s53, 81920
    s_mov_b32 s51, 2621440
    buffer_load_dwordx4 v17, s[40:43], s51 offen lds
    s_add_u32 m0, s53, 86016
    s_mov_b32 s51, 2752512
    buffer_load_dwordx4 v17, s[40:43], s51 offen lds
    s_add_u32 m0, s53, 90112
    s_mov_b32 s51, 2883584
    buffer_load_dwordx4 v17, s[40:43], s51 offen lds
    s_add_u32 m0, s53, 94208
    s_mov_b32 s51, 3014656
    buffer_load_dwordx4 v17, s[40:43], s51 offen lds
    s_waitcnt vmcnt(24)
    s_barrier
    ds_read_b64_tr_b16 a[96:97], v22 offset:32768
    ds_read_b64_tr_b16 a[98:99], v22 offset:33792
    ds_read_b64_tr_b16 a[100:101], v22 offset:36864
    ds_read_b64_tr_b16 a[102:103], v22 offset:37888
    ds_read_b64_tr_b16 a[104:105], v22 offset:40960
    ds_read_b64_tr_b16 a[106:107], v22 offset:41984
    ds_read_b64_tr_b16 a[108:109], v22 offset:45056
    ds_read_b64_tr_b16 a[110:111], v22 offset:46080
    ds_read_b64_tr_b16 a[112:113], v22 offset:49152
    ds_read_b64_tr_b16 a[114:115], v22 offset:50176
    ds_read_b64_tr_b16 a[116:117], v22 offset:53248
    ds_read_b64_tr_b16 a[118:119], v22 offset:54272
    ds_read_b64_tr_b16 a[120:121], v22 offset:57344
    ds_read_b64_tr_b16 a[122:123], v22 offset:58368
    ds_read_b64_tr_b16 a[124:125], v22 offset:61440
    ds_read_b64_tr_b16 a[126:127], v22 offset:62464
    s_waitcnt lgkmcnt(0)
    s_barrier
    s_add_u32 m0, s53, 98304
    s_mov_b32 s51, 3145728
    buffer_load_dwordx4 v17, s[40:43], s51 offen lds
    s_add_u32 m0, s53, 102400
    s_mov_b32 s51, 3276800
    buffer_load_dwordx4 v17, s[40:43], s51 offen lds
    s_add_u32 m0, s53, 106496
    s_mov_b32 s51, 3407872
    buffer_load_dwordx4 v17, s[40:43], s51 offen lds
    s_add_u32 m0, s53, 110592
    s_mov_b32 s51, 3538944
    buffer_load_dwordx4 v17, s[40:43], s51 offen lds
    s_add_u32 m0, s53, 114688
    s_mov_b32 s51, 3670016
    buffer_load_dwordx4 v17, s[40:43], s51 offen lds
    s_add_u32 m0, s53, 118784
    s_mov_b32 s51, 3801088
    buffer_load_dwordx4 v17, s[40:43], s51 offen lds
    s_add_u32 m0, s53, 122880
    s_mov_b32 s51, 3932160
    buffer_load_dwordx4 v17, s[40:43], s51 offen lds
    s_add_u32 m0, s53, 126976
    s_mov_b32 s51, 4063232
    buffer_load_dwordx4 v17, s[40:43], s51 offen lds
    s_waitcnt vmcnt(24)
    s_barrier
    ds_read_b64_tr_b16 a[128:129], v18 offset:0
    ds_read_b64_tr_b16 a[130:131], v18 offset:1024
    ds_read_b64_tr_b16 a[132:133], v18 offset:4096
    ds_read_b64_tr_b16 a[134:135], v18 offset:5120
    ds_read_b64_tr_b16 a[136:137], v18 offset:8192
    ds_read_b64_tr_b16 a[138:139], v18 offset:9216
    ds_read_b64_tr_b16 a[140:141], v18 offset:12288
    ds_read_b64_tr_b16 a[142:143], v18 offset:13312
    ds_read_b64_tr_b16 a[144:145], v18 offset:16384
    ds_read_b64_tr_b16 a[146:147], v18 offset:17408
    ds_read_b64_tr_b16 a[148:149], v18 offset:20480
    ds_read_b64_tr_b16 a[150:151], v18 offset:21504
    ds_read_b64_tr_b16 a[152:153], v18 offset:24576
    ds_read_b64_tr_b16 a[154:155], v18 offset:25600
    ds_read_b64_tr_b16 a[156:157], v18 offset:28672
    ds_read_b64_tr_b16 a[158:159], v18 offset:29696
    s_waitcnt lgkmcnt(0)
    s_barrier
    s_mov_b32 s40, s18
    s_mov_b32 s41, s19
    s_mov_b32 s42, 4194304
    s_mov_b32 s43, 0x20000
    s_add_u32 m0, s53, 0
    s_mov_b32 s51, 0
    buffer_load_dwordx4 v17, s[40:43], s51 offen lds
    s_add_u32 m0, s53, 4096
    s_mov_b32 s51, 131072
    buffer_load_dwordx4 v17, s[40:43], s51 offen lds
    s_add_u32 m0, s53, 8192
    s_mov_b32 s51, 262144
    buffer_load_dwordx4 v17, s[40:43], s51 offen lds
    s_add_u32 m0, s53, 12288
    s_mov_b32 s51, 393216
    buffer_load_dwordx4 v17, s[40:43], s51 offen lds
    s_add_u32 m0, s53, 16384
    s_mov_b32 s51, 524288
    buffer_load_dwordx4 v17, s[40:43], s51 offen lds
    s_add_u32 m0, s53, 20480
    s_mov_b32 s51, 655360
    buffer_load_dwordx4 v17, s[40:43], s51 offen lds
    s_add_u32 m0, s53, 24576
    s_mov_b32 s51, 786432
    buffer_load_dwordx4 v17, s[40:43], s51 offen lds
    s_add_u32 m0, s53, 28672
    s_mov_b32 s51, 917504
    buffer_load_dwordx4 v17, s[40:43], s51 offen lds
    s_waitcnt vmcnt(24)
    s_barrier
    ds_read_b64_tr_b16 a[160:161], v18 offset:32768
    ds_read_b64_tr_b16 a[162:163], v18 offset:33792
    ds_read_b64_tr_b16 a[164:165], v18 offset:36864
    ds_read_b64_tr_b16 a[166:167], v18 offset:37888
    ds_read_b64_tr_b16 a[168:169], v18 offset:40960
    ds_read_b64_tr_b16 a[170:171], v18 offset:41984
    ds_read_b64_tr_b16 a[172:173], v18 offset:45056
    ds_read_b64_tr_b16 a[174:175], v18 offset:46080
    ds_read_b64_tr_b16 a[176:177], v18 offset:49152
    ds_read_b64_tr_b16 a[178:179], v18 offset:50176
    ds_read_b64_tr_b16 a[180:181], v18 offset:53248
    ds_read_b64_tr_b16 a[182:183], v18 offset:54272
    ds_read_b64_tr_b16 a[184:185], v18 offset:57344
    ds_read_b64_tr_b16 a[186:187], v18 offset:58368
    ds_read_b64_tr_b16 a[188:189], v18 offset:61440
    ds_read_b64_tr_b16 a[190:191], v18 offset:62464
    s_waitcnt lgkmcnt(0)
    s_barrier
    s_add_u32 m0, s53, 32768
    s_mov_b32 s51, 1048576
    buffer_load_dwordx4 v17, s[40:43], s51 offen lds
    s_add_u32 m0, s53, 36864
    s_mov_b32 s51, 1179648
    buffer_load_dwordx4 v17, s[40:43], s51 offen lds
    s_add_u32 m0, s53, 40960
    s_mov_b32 s51, 1310720
    buffer_load_dwordx4 v17, s[40:43], s51 offen lds
    s_add_u32 m0, s53, 45056
    s_mov_b32 s51, 1441792
    buffer_load_dwordx4 v17, s[40:43], s51 offen lds
    s_add_u32 m0, s53, 49152
    s_mov_b32 s51, 1572864
    buffer_load_dwordx4 v17, s[40:43], s51 offen lds
    s_add_u32 m0, s53, 53248
    s_mov_b32 s51, 1703936
    buffer_load_dwordx4 v17, s[40:43], s51 offen lds
    s_add_u32 m0, s53, 57344
    s_mov_b32 s51, 1835008
    buffer_load_dwordx4 v17, s[40:43], s51 offen lds
    s_add_u32 m0, s53, 61440
    s_mov_b32 s51, 1966080
    buffer_load_dwordx4 v17, s[40:43], s51 offen lds
    s_waitcnt vmcnt(24)
    s_barrier
    ds_read_b64_tr_b16 a[192:193], v22 offset:0
    ds_read_b64_tr_b16 a[194:195], v22 offset:1024
    ds_read_b64_tr_b16 a[196:197], v22 offset:4096
    ds_read_b64_tr_b16 a[198:199], v22 offset:5120
    ds_read_b64_tr_b16 a[200:201], v22 offset:8192
    ds_read_b64_tr_b16 a[202:203], v22 offset:9216
    ds_read_b64_tr_b16 a[204:205], v22 offset:12288
    ds_read_b64_tr_b16 a[206:207], v22 offset:13312
    ds_read_b64_tr_b16 a[208:209], v22 offset:16384
    ds_read_b64_tr_b16 a[210:211], v22 offset:17408
    ds_read_b64_tr_b16 a[212:213], v22 offset:20480
    ds_read_b64_tr_b16 a[214:215], v22 offset:21504
    ds_read_b64_tr_b16 a[216:217], v22 offset:24576
    ds_read_b64_tr_b16 a[218:219], v22 offset:25600
    ds_read_b64_tr_b16 a[220:221], v22 offset:28672
    ds_read_b64_tr_b16 a[222:223], v22 offset:29696
    s_waitcnt lgkmcnt(0)
    s_barrier
    s_add_u32 m0, s53, 65536
    s_mov_b32 s51, 2097152
    buffer_load_dwordx4 v17, s[40:43], s51 offen lds
    s_add_u32 m0, s53, 69632
    s_mov_b32 s51, 2228224
    buffer_load_dwordx4 v17, s[40:43], s51 offen lds
    s_add_u32 m0, s53, 73728
    s_mov_b32 s51, 2359296
    buffer_load_dwordx4 v17, s[40:43], s51 offen lds
    s_add_u32 m0, s53, 77824
    s_mov_b32 s51, 2490368
    buffer_load_dwordx4 v17, s[40:43], s51 offen lds
    s_add_u32 m0, s53, 81920
    s_mov_b32 s51, 2621440
    buffer_load_dwordx4 v17, s[40:43], s51 offen lds
    s_add_u32 m0, s53, 86016
    s_mov_b32 s51, 2752512
    buffer_load_dwordx4 v17, s[40:43], s51 offen lds
    s_add_u32 m0, s53, 90112
    s_mov_b32 s51, 2883584
    buffer_load_dwordx4 v17, s[40:43], s51 offen lds
    s_add_u32 m0, s53, 94208
    s_mov_b32 s51, 3014656
    buffer_load_dwordx4 v17, s[40:43], s51 offen lds
    s_waitcnt vmcnt(24)
    s_barrier
    ds_read_b64_tr_b16 a[224:225], v22 offset:32768
    ds_read_b64_tr_b16 a[226:227], v22 offset:33792
    ds_read_b64_tr_b16 a[228:229], v22 offset:36864
    ds_read_b64_tr_b16 a[230:231], v22 offset:37888
    ds_read_b64_tr_b16 a[232:233], v22 offset:40960
    ds_read_b64_tr_b16 a[234:235], v22 offset:41984
    ds_read_b64_tr_b16 a[236:237], v22 offset:45056
    ds_read_b64_tr_b16 a[238:239], v22 offset:46080
    ds_read_b64_tr_b16 a[240:241], v22 offset:49152
    ds_read_b64_tr_b16 a[242:243], v22 offset:50176
    ds_read_b64_tr_b16 a[244:245], v22 offset:53248
    ds_read_b64_tr_b16 a[246:247], v22 offset:54272
    ds_read_b64_tr_b16 a[248:249], v22 offset:57344
    ds_read_b64_tr_b16 a[250:251], v22 offset:58368
    ds_read_b64_tr_b16 a[252:253], v22 offset:61440
    ds_read_b64_tr_b16 a[254:255], v22 offset:62464
    s_waitcnt lgkmcnt(0)
    s_barrier
    global_load_dword v21, v7, s[30:31] offset:4 sc1
    s_add_u32 m0, s53, 98304
    s_mov_b32 s51, 3145728
    buffer_load_dwordx4 v17, s[40:43], s51 offen lds
    s_add_u32 m0, s53, 102400
    s_mov_b32 s51, 3276800
    buffer_load_dwordx4 v17, s[40:43], s51 offen lds
    s_add_u32 m0, s53, 106496
    s_mov_b32 s51, 3407872
    buffer_load_dwordx4 v17, s[40:43], s51 offen lds
    s_add_u32 m0, s53, 110592
    s_mov_b32 s51, 3538944
    buffer_load_dwordx4 v17, s[40:43], s51 offen lds
    s_add_u32 m0, s53, 114688
    s_mov_b32 s51, 3670016
    buffer_load_dwordx4 v17, s[40:43], s51 offen lds
    s_add_u32 m0, s53, 118784
    s_mov_b32 s51, 3801088
    buffer_load_dwordx4 v17, s[40:43], s51 offen lds
    s_add_u32 m0, s53, 122880
    s_mov_b32 s51, 3932160
    buffer_load_dwordx4 v17, s[40:43], s51 offen lds
    s_add_u32 m0, s53, 126976
    s_mov_b32 s51, 4063232
    buffer_load_dwordx4 v17, s[40:43], s51 offen lds
    s_waitcnt vmcnt(24)
    s_barrier
    ds_read_b64_tr_b16 v[128:129], v18 offset:0
    ds_read_b64_tr_b16 v[130:131], v18 offset:1024
    ds_read_b64_tr_b16 v[132:133], v18 offset:4096
    ds_read_b64_tr_b16 v[134:135], v18 offset:5120
    ds_read_b64_tr_b16 v[136:137], v18 offset:8192
    ds_read_b64_tr_b16 v[138:139], v18 offset:9216
    ds_read_b64_tr_b16 v[140:141], v18 offset:12288
    ds_read_b64_tr_b16 v[142:143], v18 offset:13312
    ds_read_b64_tr_b16 v[144:145], v18 offset:16384
    ds_read_b64_tr_b16 v[146:147], v18 offset:17408
    ds_read_b64_tr_b16 v[148:149], v18 offset:20480
    ds_read_b64_tr_b16 v[150:151], v18 offset:21504
    ds_read_b64_tr_b16 v[152:153], v18 offset:24576
    ds_read_b64_tr_b16 v[154:155], v18 offset:25600
    ds_read_b64_tr_b16 v[156:157], v18 offset:28672
    ds_read_b64_tr_b16 v[158:159], v18 offset:29696
    s_waitcnt lgkmcnt(0)
    s_barrier
    s_mov_b32 s40, s14
    s_mov_b32 s41, s15
    s_mov_b32 s42, 2097152
    s_mov_b32 s43, 0x20000
    v_xor_b32 v19, 0, v1
    s_add_u32 m0, s65, 0
    s_add_u32 s52, s55, 0
    buffer_load_dwordx4 v19, s[40:43], s52 offen lds
    v_xor_b32 v20, 16, v1
    s_add_u32 m0, s65, 1024
    s_add_u32 s52, s55, 1024
    buffer_load_dwordx4 v20, s[40:43], s52 offen lds
    v_xor_b32 v19, 32, v1
    s_add_u32 m0, s65, 2048
    s_add_u32 s52, s55, 2048
    buffer_load_dwordx4 v19, s[40:43], s52 offen lds
    v_xor_b32 v20, 48, v1
    s_add_u32 m0, s65, 3072
    s_add_u32 s52, s55, 3072
    buffer_load_dwordx4 v20, s[40:43], s52 offen lds
    v_xor_b32 v19, 64, v1
    s_add_u32 m0, s65, 4096
    s_add_u32 s52, s55, 4096
    buffer_load_dwordx4 v19, s[40:43], s52 offen lds
    v_xor_b32 v20, 80, v1
    s_add_u32 m0, s65, 5120
    s_add_u32 s52, s55, 5120
    buffer_load_dwordx4 v20, s[40:43], s52 offen lds
    v_xor_b32 v19, 96, v1
    s_add_u32 m0, s65, 6144
    s_add_u32 s52, s55, 6144
    buffer_load_dwordx4 v19, s[40:43], s52 offen lds
    v_xor_b32 v20, 112, v1
    s_add_u32 m0, s65, 7168
    s_add_u32 s52, s55, 7168
    buffer_load_dwordx4 v20, s[40:43], s52 offen lds
    s_waitcnt vmcnt(24)
    s_barrier
    ds_read_b64_tr_b16 v[160:161], v18 offset:32768
    ds_read_b64_tr_b16 v[162:163], v18 offset:33792
    ds_read_b64_tr_b16 v[164:165], v18 offset:36864
    ds_read_b64_tr_b16 v[166:167], v18 offset:37888
    ds_read_b64_tr_b16 v[168:169], v18 offset:40960
    ds_read_b64_tr_b16 v[170:171], v18 offset:41984
    ds_read_b64_tr_b16 v[172:173], v18 offset:45056
    ds_read_b64_tr_b16 v[174:175], v18 offset:46080
    ds_read_b64_tr_b16 v[176:177], v18 offset:49152
    ds_read_b64_tr_b16 v[178:179], v18 offset:50176
    ds_read_b64_tr_b16 v[180:181], v18 offset:53248
    ds_read_b64_tr_b16 v[182:183], v18 offset:54272
    ds_read_b64_tr_b16 v[184:185], v18 offset:57344
    ds_read_b64_tr_b16 v[186:187], v18 offset:58368
    ds_read_b64_tr_b16 v[188:189], v18 offset:61440
    ds_read_b64_tr_b16 v[190:191], v18 offset:62464
    s_waitcnt lgkmcnt(0)
    s_barrier
    s_waitcnt vmcnt(16)
    s_barrier
    ds_read_b64_tr_b16 v[192:193], v22 offset:0
    ds_read_b64_tr_b16 v[194:195], v22 offset:1024
    ds_read_b64_tr_b16 v[196:197], v22 offset:4096
    ds_read_b64_tr_b16 v[198:199], v22 offset:5120
    ds_read_b64_tr_b16 v[200:201], v22 offset:8192
    ds_read_b64_tr_b16 v[202:203], v22 offset:9216
    ds_read_b64_tr_b16 v[204:205], v22 offset:12288
    ds_read_b64_tr_b16 v[206:207], v22 offset:13312
    ds_read_b64_tr_b16 v[208:209], v22 offset:16384
    ds_read_b64_tr_b16 v[210:211], v22 offset:17408
    ds_read_b64_tr_b16 v[212:213], v22 offset:20480
    ds_read_b64_tr_b16 v[214:215], v22 offset:21504
    ds_read_b64_tr_b16 v[216:217], v22 offset:24576
    ds_read_b64_tr_b16 v[218:219], v22 offset:25600
    ds_read_b64_tr_b16 v[220:221], v22 offset:28672
    ds_read_b64_tr_b16 v[222:223], v22 offset:29696
    s_waitcnt lgkmcnt(0)
    s_barrier
    s_waitcnt vmcnt(8)
    s_barrier
    ds_read_b64_tr_b16 v[224:225], v22 offset:32768
    ds_read_b64_tr_b16 v[226:227], v22 offset:33792
    ds_read_b64_tr_b16 v[228:229], v22 offset:36864
    ds_read_b64_tr_b16 v[230:231], v22 offset:37888
    ds_read_b64_tr_b16 v[232:233], v22 offset:40960
    ds_read_b64_tr_b16 v[234:235], v22 offset:41984
    ds_read_b64_tr_b16 v[236:237], v22 offset:45056
    ds_read_b64_tr_b16 v[238:239], v22 offset:46080
    ds_read_b64_tr_b16 v[240:241], v22 offset:49152
    ds_read_b64_tr_b16 v[242:243], v22 offset:50176
    ds_read_b64_tr_b16 v[244:245], v22 offset:53248
    ds_read_b64_tr_b16 v[246:247], v22 offset:54272
    ds_read_b64_tr_b16 v[248:249], v22 offset:57344
    ds_read_b64_tr_b16 v[250:251], v22 offset:58368
    ds_read_b64_tr_b16 v[252:253], v22 offset:61440
    ds_read_b64_tr_b16 v[254:255], v22 offset:62464
    s_waitcnt lgkmcnt(0)
    s_barrier
    v_readfirstlane_b32 s51, v21
    s_nop 0
    s_cmp_ge_u32 s51, 128
    s_cbranch_scc1 QA_INIT_OK
    s_mov_b32 s54, 0
    v_mov_b32 v19, 4
QA_INIT:
    global_load_dword v20, v19, s[30:31] sc1
    s_add_u32 s54, s54, 1
    s_cmp_gt_u32 s54, 65536
    s_cbranch_scc1 EXIT
    s_waitcnt vmcnt(0)
    v_readfirstlane_b32 s51, v20
    s_nop 0
    s_cmp_ge_u32 s51, 128
    s_cbranch_scc1 QA_INIT_OK
    s_sleep 4
    s_branch QA_INIT
QA_INIT_OK:
    s_mov_b32 s53, 0
QA_LOOP:
    s_cmp_ge_u32 s50, 16
    s_cbranch_scc1 QA_B
    s_waitcnt vmcnt(0)
    s_barrier
    s_cmp_ge_u32 s50, 15
    s_cbranch_scc1 QA_NOX_l
    s_add_u32 s55, s55, 131072
    s_xor_b32 s65, s65, 32768
    v_xor_b32 v96, 0, v1
    s_add_u32 m0, s65, 0
    s_add_u32 s52, s55, 0
    buffer_load_dwordx4 v96, s[40:43], s52 offen lds
    v_xor_b32 v97, 16, v1
    s_add_u32 m0, s65, 1024
    s_add_u32 s52, s55, 1024
    buffer_load_dwordx4 v97, s[40:43], s52 offen lds
    v_xor_b32 v96, 32, v1
    s_add_u32 m0, s65, 2048
    s_add_u32 s52, s55, 2048
    buffer_load_dwordx4 v96, s[40:43], s52 offen lds
    v_xor_b32 v97, 48, v1
    s_add_u32 m0, s65, 3072
    s_add_u32 s52, s55, 3072
    buffer_load_dwordx4 v97, s[40:43], s52 offen lds
    v_xor_b32 v96, 64, v1
    s_add_u32 m0, s65, 4096
    s_add_u32 s52, s55, 4096
    buffer_load_dwordx4 v96, s[40:43], s52 offen lds
    v_xor_b32 v97, 80, v1
    s_add_u32 m0, s65, 5120
    s_add_u32 s52, s55, 5120
    buffer_load_dwordx4 v97, s[40:43], s52 offen lds
    v_xor_b32 v96, 96, v1
    s_add_u32 m0, s65, 6144
    s_add_u32 s52, s55, 6144
    buffer_load_dwordx4 v96, s[40:43], s52 offen lds
    v_xor_b32 v97, 112, v1
    s_add_u32 m0, s65, 7168
    s_add_u32 s52, s55, 7168
    buffer_load_dwordx4 v97, s[40:43], s52 offen lds
QA_NOX_l:
    ds_read_b128 v[64:67], v8 offset:0
    ds_read_b128 v[68:71], v9 offset:0
    ds_read_b128 v[72:75], v10 offset:0
    ds_read_b128 v[76:79], v11 offset:0
    ds_read_b128 v[80:83], v12 offset:0
    ds_read_b128 v[84:87], v13 offset:0
    s_waitcnt lgkmcnt(5)
    v_mfma_f32_32x32x16_bf16 v[16:31], v[128:131], v[64:67], 0
    ds_read_b128 v[88:91], v14 offset:0
    v_mfma_f32_32x32x16_bf16 v[32:47], a[0:3], v[64:67], 0
    v_mfma_f32_32x32x16_bf16 v[48:63], v[64:67], a[128:131], 0
    s_waitcnt lgkmcnt(5)
    v_mfma_f32_32x32x16_bf16 v[16:31], v[132:135], v[68:71], v[16:31]
    ds_read_b128 v[92:95], v15 offset:0
    v_mfma_f32_32x32x16_bf16 v[32:47], a[4:7], v[68:71], v[32:47]
    v_mfma_f32_32x32x16_bf16 v[48:63], v[68:71], a[132:135], v[48:63]
    s_waitcnt lgkmcnt(5)
    v_mfma_f32_32x32x16_bf16 v[16:31], v[136:139], v[72:75], v[16:31]
    ds_read_b128 v[64:67], v8 offset:256
    v_mfma_f32_32x32x16_bf16 v[32:47], a[8:11], v[72:75], v[32:47]
    v_mfma_f32_32x32x16_bf16 v[48:63], v[72:75], a[136:139], v[48:63]
    s_waitcnt lgkmcnt(5)
    v_mfma_f32_32x32x16_bf16 v[16:31], v[140:143], v[76:79], v[16:31]
    ds_read_b128 v[68:71], v9 offset:256
    v_mfma_f32_32x32x16_bf16 v[32:47], a[12:15], v[76:79], v[32:47]
    v_mfma_f32_32x32x16_bf16 v[48:63], v[76:79], a[140:143], v[48:63]
    s_waitcnt lgkmcnt(5)
    v_mfma_f32_32x32x16_bf16 v[16:31], v[144:147], v[80:83], v[16:31]
    ds_read_b128 v[72:75], v10 offset:256
    v_mfma_f32_32x32x16_bf16 v[32:47], a[16:19], v[80:83], v[32:47]
    v_mfma_f32_32x32x16_bf16 v[48:63], v[80:83], a[144:147], v[48:63]
    s_waitcnt lgkmcnt(5)
    v_mfma_f32_32x32x16_bf16 v[16:31], v[148:151], v[84:87], v[16:31]
    ds_read_b128 v[76:79], v11 offset:256
    v_mfma_f32_32x32x16_bf16 v[32:47], a[20:23], v[84:87], v[32:47]
    v_mfma_f32_32x32x16_bf16 v[48:63], v[84:87], a[148:151], v[48:63]
    s_waitcnt lgkmcnt(5)
    v_mfma_f32_32x32x16_bf16 v[16:31], v[152:155], v[88:91], v[16:31]
    ds_read_b128 v[80:83], v12 offset:256
    v_mfma_f32_32x32x16_bf16 v[32:47], a[24:27], v[88:91], v[32:47]
    v_mfma_f32_32x32x16_bf16 v[48:63], v[88:91], a[152:155], v[48:63]
    s_waitcnt lgkmcnt(5)
    v_mfma_f32_32x32x16_bf16 v[16:31], v[156:159], v[92:95], v[16:31]
    ds_read_b128 v[84:87], v13 offset:256
    v_mfma_f32_32x32x16_bf16 v[32:47], a[28:31], v[92:95], v[32:47]
    v_mfma_f32_32x32x16_bf16 v[48:63], v[92:95], a[156:159], v[48:63]
    s_waitcnt lgkmcnt(5)
    v_mfma_f32_32x32x16_bf16 v[16:31], v[160:163], v[64:67], v[16:31]
    ds_read_b128 v[88:91], v14 offset:256
    v_mfma_f32_32x32x16_bf16 v[32:47], a[32:35], v[64:67], v[32:47]
    v_mfma_f32_32x32x16_bf16 v[48:63], v[64:67], a[160:163], v[48:63]
    s_waitcnt lgkmcnt(5)
    v_mfma_f32_32x32x16_bf16 v[16:31], v[164:167], v[68:71], v[16:31]
    ds_read_b128 v[92:95], v15 offset:256
    v_mfma_f32_32x32x16_bf16 v[32:47], a[36:39], v[68:71], v[32:47]
    v_mfma_f32_32x32x16_bf16 v[48:63], v[68:71], a[164:167], v[48:63]
    s_waitcnt lgkmcnt(5)
    v_mfma_f32_32x32x16_bf16 v[16:31], v[168:171], v[72:75], v[16:31]
    ds_read_b128 v[64:67], v8 offset:512
    v_mfma_f32_32x32x16_bf16 v[32:47], a[40:43], v[72:75], v[32:47]
    v_mfma_f32_32x32x16_bf16 v[48:63], v[72:75], a[168:171], v[48:63]
    s_waitcnt lgkmcnt(5)
    v_mfma_f32_32x32x16_bf16 v[16:31], v[172:175], v[76:79], v[16:31]
    ds_read_b128 v[68:71], v9 offset:512
    v_mfma_f32_32x32x16_bf16 v[32:47], a[44:47], v[76:79], v[32:47]
    v_mfma_f32_32x32x16_bf16 v[48:63], v[76:79], a[172:175], v[48:63]
    s_waitcnt lgkmcnt(5)
    v_mfma_f32_32x32x16_bf16 v[16:31], v[176:179], v[80:83], v[16:31]
    ds_read_b128 v[72:75], v10 offset:512
    v_mfma_f32_32x32x16_bf16 v[32:47], a[48:51], v[80:83], v[32:47]
    v_mfma_f32_32x32x16_bf16 v[48:63], v[80:83], a[176:179], v[48:63]
    s_waitcnt lgkmcnt(5)
    v_mfma_f32_32x32x16_bf16 v[16:31], v[180:183], v[84:87], v[16:31]
    ds_read_b128 v[76:79], v11 offset:512
    v_mfma_f32_32x32x16_bf16 v[32:47], a[52:55], v[84:87], v[32:47]
    v_mfma_f32_32x32x16_bf16 v[48:63], v[84:87], a[180:183], v[48:63]
    s_waitcnt lgkmcnt(5)
    v_mfma_f32_32x32x16_bf16 v[16:31], v[184:187], v[88:91], v[16:31]
    ds_read_b128 v[80:83], v12 offset:512
    v_mfma_f32_32x32x16_bf16 v[32:47], a[56:59], v[88:91], v[32:47]
    v_mfma_f32_32x32x16_bf16 v[48:63], v[88:91], a[184:187], v[48:63]
    s_waitcnt lgkmcnt(5)
    v_mfma_f32_32x32x16_bf16 v[16:31], v[188:191], v[92:95], v[16:31]
    ds_read_b128 v[84:87], v13 offset:512
    v_mfma_f32_32x32x16_bf16 v[32:47], a[60:63], v[92:95], v[32:47]
    v_mfma_f32_32x32x16_bf16 v[48:63], v[92:95], a[188:191], v[48:63]
    s_waitcnt lgkmcnt(5)
    v_mfma_f32_32x32x16_bf16 v[16:31], v[192:195], v[64:67], v[16:31]
    ds_read_b128 v[88:91], v14 offset:512
    v_mfma_f32_32x32x16_bf16 v[32:47], a[64:67], v[64:67], v[32:47]
    v_mfma_f32_32x32x16_bf16 v[48:63], v[64:67], a[192:195], v[48:63]
    s_waitcnt lgkmcnt(5)
    v_mfma_f32_32x32x16_bf16 v[16:31], v[196:199], v[68:71], v[16:31]
    ds_read_b128 v[92:95], v15 offset:512
    v_mfma_f32_32x32x16_bf16 v[32:47], a[68:71], v[68:71], v[32:47]
    v_mfma_f32_32x32x16_bf16 v[48:63], v[68:71], a[196:199], v[48:63]
    s_waitcnt lgkmcnt(5)
    v_mfma_f32_32x32x16_bf16 v[16:31], v[200:203], v[72:75], v[16:31]
    ds_read_b128 v[64:67], v8 offset:768
    v_mfma_f32_32x32x16_bf16 v[32:47], a[72:75], v[72:75], v[32:47]
    v_mfma_f32_32x32x16_bf16 v[48:63], v[72:75], a[200:203], v[48:63]
    s_waitcnt lgkmcnt(5)
    v_mfma_f32_32x32x16_bf16 v[16:31], v[204:207], v[76:79], v[16:31]
    ds_read_b128 v[68:71], v9 offset:768
    v_mfma_f32_32x32x16_bf16 v[32:47], a[76:79], v[76:79], v[32:47]
    v_mfma_f32_32x32x16_bf16 v[48:63], v[76:79], a[204:207], v[48:63]
    s_waitcnt lgkmcnt(5)
    v_mfma_f32_32x32x16_bf16 v[16:31], v[208:211], v[80:83], v[16:31]
    ds_read_b128 v[72:75], v10 offset:768
    v_mfma_f32_32x32x16_bf16 v[32:47], a[80:83], v[80:83], v[32:47]
    v_mfma_f32_32x32x16_bf16 v[48:63], v[80:83], a[208:211], v[48:63]
    s_waitcnt lgkmcnt(5)
    v_mfma_f32_32x32x16_bf16 v[16:31], v[212:215], v[84:87], v[16:31]
    ds_read_b128 v[76:79], v11 offset:768
    v_mfma_f32_32x32x16_bf16 v[32:47], a[84:87], v[84:87], v[32:47]
    v_mfma_f32_32x32x16_bf16 v[48:63], v[84:87], a[212:215], v[48:63]
    s_waitcnt lgkmcnt(5)
    v_mfma_f32_32x32x16_bf16 v[16:31], v[216:219], v[88:91], v[16:31]
    ds_read_b128 v[80:83], v12 offset:768
    v_mfma_f32_32x32x16_bf16 v[32:47], a[88:91], v[88:91], v[32:47]
    v_mfma_f32_32x32x16_bf16 v[48:63], v[88:91], a[216:219], v[48:63]
    s_waitcnt lgkmcnt(5)
    v_mfma_f32_32x32x16_bf16 v[16:31], v[220:223], v[92:95], v[16:31]
    ds_read_b128 v[84:87], v13 offset:768
    v_mfma_f32_32x32x16_bf16 v[32:47], a[92:95], v[92:95], v[32:47]
    v_mfma_f32_32x32x16_bf16 v[48:63], v[92:95], a[220:223], v[48:63]
    s_waitcnt lgkmcnt(5)
    v_mfma_f32_32x32x16_bf16 v[16:31], v[224:227], v[64:67], v[16:31]
    ds_read_b128 v[88:91], v14 offset:768
    v_mfma_f32_32x32x16_bf16 v[32:47], a[96:99], v[64:67], v[32:47]
    v_mfma_f32_32x32x16_bf16 v[48:63], v[64:67], a[224:227], v[48:63]
    s_waitcnt lgkmcnt(5)
    v_mfma_f32_32x32x16_bf16 v[16:31], v[228:231], v[68:71], v[16:31]
    ds_read_b128 v[92:95], v15 offset:768
    v_mfma_f32_32x32x16_bf16 v[32:47], a[100:103], v[68:71], v[32:47]
    v_mfma_f32_32x32x16_bf16 v[48:63], v[68:71], a[228:231], v[48:63]
    s_waitcnt lgkmcnt(5)
    v_mfma_f32_32x32x16_bf16 v[16:31], v[232:235], v[72:75], v[16:31]
    v_mfma_f32_32x32x16_bf16 v[32:47], a[104:107], v[72:75], v[32:47]
    v_mfma_f32_32x32x16_bf16 v[48:63], v[72:75], a[232:235], v[48:63]
    s_waitcnt lgkmcnt(4)
    v_mfma_f32_32x32x16_bf16 v[16:31], v[236:239], v[76:79], v[16:31]
    v_mfma_f32_32x32x16_bf16 v[32:47], a[108:111], v[76:79], v[32:47]
    v_mfma_f32_32x32x16_bf16 v[48:63], v[76:79], a[236:239], v[48:63]
    s_waitcnt lgkmcnt(3)
    v_mfma_f32_32x32x16_bf16 v[16:31], v[240:243], v[80:83], v[16:31]
    v_mfma_f32_32x32x16_bf16 v[32:47], a[112:115], v[80:83], v[32:47]
    v_mfma_f32_32x32x16_bf16 v[48:63], v[80:83], a[240:243], v[48:63]
    s_waitcnt lgkmcnt(2)
    v_mfma_f32_32x32x16_bf16 v[16:31], v[244:247], v[84:87], v[16:31]
    v_mfma_f32_32x32x16_bf16 v[32:47], a[116:119], v[84:87], v[32:47]
    v_mfma_f32_32x32x16_bf16 v[48:63], v[84:87], a[244:247], v[48:63]
    s_waitcnt lgkmcnt(1)
    v_mfma_f32_32x32x16_bf16 v[16:31], v[248:251], v[88:91], v[16:31]
    v_mfma_f32_32x32x16_bf16 v[32:47], a[120:123], v[88:91], v[32:47]
    v_mfma_f32_32x32x16_bf16 v[48:63], v[88:91], a[248:251], v[48:63]
    s_waitcnt lgkmcnt(0)
    v_mfma_f32_32x32x16_bf16 v[16:31], v[252:255], v[92:95], v[16:31]
    v_mfma_f32_32x32x16_bf16 v[32:47], a[124:127], v[92:95], v[32:47]
    v_mfma_f32_32x32x16_bf16 v[48:63], v[92:95], a[252:255], v[48:63]
    v_xor_b32 v8, 0x8000, v8
    v_xor_b32 v9, 0x8000, v9
    v_xor_b32 v10, 0x8000, v10
    v_xor_b32 v11, 0x8000, v11
    v_xor_b32 v12, 0x8000, v12
    v_xor_b32 v13, 0x8000, v13
    v_xor_b32 v14, 0x8000, v14
    v_xor_b32 v15, 0x8000, v15
    v_add_u32 v64, s56, v0
    v_cvt_pk_bf16_f32 v96, v16, v17
    v_cvt_pk_bf16_f32 v97, v18, v19
    v_cvt_pk_bf16_f32 v98, v20, v21
    v_cvt_pk_bf16_f32 v99, v22, v23
    v_cvt_pk_bf16_f32 v100, v24, v25
    v_cvt_pk_bf16_f32 v101, v26, v27
    v_cvt_pk_bf16_f32 v102, v28, v29
    v_cvt_pk_bf16_f32 v103, v30, v31
    ds_write_b128 v64, v[96:99] offset:0
    ds_write_b128 v64, v[100:103] offset:1024
    v_cvt_pk_bf16_f32 v104, v32, v33
    v_cvt_pk_bf16_f32 v105, v34, v35
    v_cvt_pk_bf16_f32 v106, v36, v37
    v_cvt_pk_bf16_f32 v107, v38, v39
    v_cvt_pk_bf16_f32 v108, v40, v41
    v_cvt_pk_bf16_f32 v109, v42, v43
    v_cvt_pk_bf16_f32 v110, v44, v45
    v_cvt_pk_bf16_f32 v111, v46, v47
    buffer_store_dwordx4 v[104:107], v2, s[36:39], s62 offen offset:0 sc1
    ds_write_b128 v64, v[104:107] offset:8192
    buffer_store_dwordx4 v[108:111], v2, s[36:39], s62 offen offset:512 sc1
    ds_write_b128 v64, v[108:111] offset:9216
    v_cvt_pk_bf16_f32 v112, v48, v49
    v_cvt_pk_bf16_f32 v113, v50, v51
    v_cvt_pk_bf16_f32 v114, v56, v57
    v_cvt_pk_bf16_f32 v115, v58, v59
    v_cvt_pk_bf16_f32 v116, v52, v53
    v_cvt_pk_bf16_f32 v117, v54, v55
    v_cvt_pk_bf16_f32 v118, v60, v61
    v_cvt_pk_bf16_f32 v119, v62, v63
    buffer_store_dwordx4 v[112:115], v3, s[36:39], s62 offen offset:0 sc1
    ds_write_b128 v64, v[112:115] offset:16384
    buffer_store_dwordx4 v[116:119], v3, s[36:39], s62 offen offset:512 sc1
    ds_write_b128 v64, v[116:119] offset:17408
    s_add_u32 s62, s62, 1048576
    s_add_u32 s56, s56, 24576
    s_cmp_ge_u32 s56, 139264
    s_cbranch_scc0 QA_PA_l
    s_sub_u32 s56, s56, 73728
QA_PA_l:
    s_add_u32 s50, s50, 1
    s_waitcnt vmcnt(0) lgkmcnt(0)
    s_barrier
    s_cmp_lg_u32 s44, 0
    s_cbranch_scc1 QA_FA_l
    v_mov_b32 v96, s50
    s_mov_b64 exec, 1
    buffer_store_dword v96, v7, s[36:39], s59 offen sc1
    s_mov_b64 exec, -1
QA_FA_l:
    s_cmp_lt_u32 s50, 3
    s_cbranch_scc1 QA_LOOP
QA_B:
    s_lshl_b32 s51, s44, 11
    s_sub_u32 s51, s57, s51
    v_add_u32 v48, s51, v0
    v_add_u32 v49, s57, v0
    ds_read_b128 v[64:67], v48 offset:0
    ds_read_b128 v[96:99], v48 offset:8192
    ds_read_b128 v[68:71], v48 offset:1024
    ds_read_b128 v[100:103], v48 offset:9216
    ds_read_b128 v[72:75], v48 offset:2048
    ds_read_b128 v[104:107], v48 offset:10240
    ds_read_b128 v[76:79], v48 offset:3072
    ds_read_b128 v[108:111], v48 offset:11264
    ds_read_b128 v[80:83], v48 offset:4096
    ds_read_b128 v[112:115], v48 offset:12288
    ds_read_b128 v[84:87], v48 offset:5120
    ds_read_b128 v[116:119], v48 offset:13312
    s_waitcnt lgkmcnt(10)
    v_mfma_f32_32x32x16_bf16 v[16:31], v[96:99], v[64:67], 0
    s_waitcnt lgkmcnt(8)
    v_mfma_f32_32x32x16_bf16 v[16:31], v[100:103], v[68:71], v[16:31]
    s_waitcnt lgkmcnt(6)
    v_mfma_f32_32x32x16_bf16 v[16:31], v[104:107], v[72:75], v[16:31]
    ds_read_b128 v[88:91], v48 offset:6144
    ds_read_b128 v[120:123], v48 offset:14336
    ds_read_b128 v[92:95], v48 offset:7168
    ds_read_b128 v[124:127], v48 offset:15360
    s_waitcnt lgkmcnt(8)
    v_mfma_f32_32x32x16_bf16 v[16:31], v[108:111], v[76:79], v[16:31]
    s_waitcnt lgkmcnt(6)
    v_mfma_f32_32x32x16_bf16 v[16:31], v[112:115], v[80:83], v[16:31]
    s_waitcnt lgkmcnt(4)
    v_mfma_f32_32x32x16_bf16 v[16:31], v[116:119], v[84:87], v[16:31]
    s_waitcnt lgkmcnt(2)
    v_mfma_f32_32x32x16_bf16 v[16:31], v[120:123], v[88:91], v[16:31]
    s_waitcnt lgkmcnt(0)
    v_mfma_f32_32x32x16_bf16 v[16:31], v[124:127], v[92:95], v[16:31]
    v_mov_b32 v124, v49
    v_mov_b32 v125, 0xff800000
    s_nop 8
    v_cndmask_b32 v16, v125, v16, s[66:67]
    v_cndmask_b32 v17, v125, v17, s[68:69]
    v_cndmask_b32 v18, v125, v18, s[70:71]
    v_cndmask_b32 v19, v125, v19, s[72:73]
    v_cndmask_b32 v20, v125, v20, s[74:75]
    v_cndmask_b32 v21, v125, v21, s[76:77]
    v_cndmask_b32 v22, v125, v22, s[78:79]
    v_cndmask_b32 v23, v125, v23, s[80:81]
    v_cndmask_b32 v24, v125, v24, s[82:83]
    v_cndmask_b32 v25, v125, v25, s[84:85]
    v_cndmask_b32 v26, v125, v26, s[86:87]
    v_cndmask_b32 v27, v125, v27, s[88:89]
    v_cndmask_b32 v28, v125, v28, s[90:91]
    v_cndmask_b32 v29, v125, v29, s[92:93]
    v_cndmask_b32 v30, v125, v30, s[94:95]
    v_cndmask_b32 v31, v125, v31, s[96:97]
    v_max3_f32 v126, v16, v17, v18
    v_max3_f32 v126, v126, v19, v20
    v_max3_f32 v126, v126, v21, v22
    v_max3_f32 v126, v126, v23, v24
    v_max3_f32 v126, v126, v25, v26
    v_max3_f32 v126, v126, v27, v28
    v_max3_f32 v126, v126, v29, v30
    v_max_f32 v126, v126, v31
    v_bfe_u32 v120, v0, 6, 2
    v_bfe_u32 v127, v0, 4, 1
    v_lshl_add_u32 v120, v120, 1, v127
    v_mul_u32_u24 v120, 1056, v120
    v_bfe_u32 v127, v0, 9, 1
    v_lshl_add_u32 v120, v127, 6, v120
    v_bfe_u32 v127, v0, 8, 1
    v_lshl_add_u32 v120, v127, 2, v120
    v_and_b32 v127, 32, v0
    s_lshl_b32 s51, s44, 8
    s_add_u32 s51, s51, 139264
    v_add3_u32 v120, v120, v127, s51
    v_mov_b32 v121, 0x4444
    v_mov_b32 v122, 0xeeee
    v_and_b32 v127, 128, v0
    v_cmp_ne_u32 vcc, 0, v127
    s_nop 1
    v_cndmask_b32 v121, v121, v122, vcc
    v_bfe_u32 v122, v0, 4, 1
    v_mul_u32_u24 v122, 1088, v122
    v_bfe_u32 v127, v0, 6, 2
    v_lshl_add_u32 v122, v127, 3, v122
    v_bfe_u32 v127, v0, 9, 1
    v_lshl_add_u32 v122, v127, 5, v122
    v_add_u32 v122, 147712, v122
    v_mov_b64 v[32:33], 0
    v_mov_b64 v[48:49], 0
    v_mov_b64 v[34:35], 0
    v_mov_b64 v[50:51], 0
    v_mov_b64 v[36:37], 0
    v_mov_b64 v[52:53], 0
    v_mov_b64 v[38:39], 0
    v_mov_b64 v[54:55], 0
    s_mov_b32 s54, 0
    s_add_u32 s52, s63, 4096
QA_W1_l:
    buffer_load_dwordx4 v[96:99], v0, s[36:39], s63 offen sc1
    buffer_load_dwordx4 v[100:103], v0, s[36:39], s52 offen sc1
    s_add_u32 s54, s54, 1
    s_cmp_gt_u32 s54, 65536
    s_cbranch_scc1 EXIT
    s_waitcnt vmcnt(0)
    v_max3_u32 v127, v96, v97, v98
    v_max3_u32 v127, v127, v99, v100
    v_max3_u32 v127, v127, v101, v102
    v_max_u32 v127, v127, v103
    v_cmp_eq_u32 vcc, -1, v127
    s_cbranch_vccz QA_W2_l
    s_cmp_eq_u32 s53, 15
    s_cbranch_scc1 QA_W1_l
    s_sleep 4
    s_branch QA_W1_l
QA_W2_l:
    s_mov_b32 s51, 0x05040100
    s_mov_b32 s52, 0x07060302
    v_perm_b32 v104, v97, v96, s51
    v_perm_b32 v105, v99, v98, s51
    ds_write2_b32 v120, v104, v105 offset0:0 offset1:4
    v_perm_b32 v106, v97, v96, s52
    v_perm_b32 v107, v99, v98, s52
    ds_write2_b32 v120, v106, v107 offset0:32 offset1:36
    v_perm_b32 v108, v101, v100, s51
    v_perm_b32 v109, v103, v102, s51
    ds_write2_b32 v120, v108, v109 offset0:2 offset1:6
    v_perm_b32 v110, v101, v100, s52
    v_perm_b32 v111, v103, v102, s52
    ds_write2_b32 v120, v110, v111 offset0:34 offset1:38
    s_waitcnt lgkmcnt(0)
    s_barrier
    ds_read_b128 v[96:99], v4 offset:0
    ds_read_b128 v[100:103], v4 offset:64
    ds_read_b128 v[104:107], v4 offset:128
    s_waitcnt lgkmcnt(2)
    v_smfmac_f32_32x32x32_bf16 v[32:47], v[96:99], a[0:7], v121
    ds_read_b128 v[108:111], v4 offset:192
    s_waitcnt lgkmcnt(2)
    v_smfmac_f32_32x32x32_bf16 v[32:47], v[100:103], a[8:15], v121
    ds_read_b128 v[96:99], v4 offset:256
    s_waitcnt lgkmcnt(2)
    v_smfmac_f32_32x32x32_bf16 v[32:47], v[104:107], a[16:23], v121
    ds_read_b128 v[100:103], v4 offset:320
    s_waitcnt lgkmcnt(2)
    v_smfmac_f32_32x32x32_bf16 v[32:47], v[108:111], a[24:31], v121
    ds_read_b128 v[104:107], v4 offset:384
    s_waitcnt lgkmcnt(2)
    v_smfmac_f32_32x32x32_bf16 v[32:47], v[96:99], a[32:39], v121
    ds_read_b128 v[108:111], v4 offset:448
    s_waitcnt lgkmcnt(2)
    v_smfmac_f32_32x32x32_bf16 v[32:47], v[100:103], a[40:47], v121
    ds_read_b128 v[96:99], v4 offset:512
    s_waitcnt lgkmcnt(2)
    v_smfmac_f32_32x32x32_bf16 v[32:47], v[104:107], a[48:55], v121
    ds_read_b128 v[100:103], v4 offset:576
    s_waitcnt lgkmcnt(2)
    v_smfmac_f32_32x32x32_bf16 v[32:47], v[108:111], a[56:63], v121
    ds_read_b128 v[104:107], v4 offset:640
    s_waitcnt lgkmcnt(2)
    v_smfmac_f32_32x32x32_bf16 v[32:47], v[96:99], a[64:71], v121
    ds_read_b128 v[108:111], v4 offset:704
    s_waitcnt lgkmcnt(2)
    v_smfmac_f32_32x32x32_bf16 v[32:47], v[100:103], a[72:79], v121
    ds_read_b128 v[96:99], v4 offset:768
    s_waitcnt lgkmcnt(2)
    v_smfmac_f32_32x32x32_bf16 v[32:47], v[104:107], a[80:87], v121
    ds_read_b128 v[100:103], v4 offset:832
    s_waitcnt lgkmcnt(2)
    v_smfmac_f32_32x32x32_bf16 v[32:47], v[108:111], a[88:95], v121
    ds_read_b128 v[104:107], v4 offset:896
    s_waitcnt lgkmcnt(2)
    v_smfmac_f32_32x32x32_bf16 v[32:47], v[96:99], a[96:103], v121
    ds_read_b128 v[108:111], v4 offset:960
    s_waitcnt lgkmcnt(2)
    v_smfmac_f32_32x32x32_bf16 v[32:47], v[100:103], a[104:111], v121
    ds_read_b128 v[96:99], v4 offset:0
    s_waitcnt lgkmcnt(2)
    v_smfmac_f32_32x32x32_bf16 v[32:47], v[104:107], a[112:119], v121
    ds_read_b128 v[100:103], v4 offset:64
    s_waitcnt lgkmcnt(2)
    v_smfmac_f32_32x32x32_bf16 v[32:47], v[108:111], a[120:127], v121
    ds_read_b128 v[104:107], v4 offset:128
    s_waitcnt lgkmcnt(2)
    v_smfmac_f32_32x32x32_bf16 v[48:63], v[96:99], a[128:135], v121
    ds_read_b128 v[108:111], v4 offset:192
    s_waitcnt lgkmcnt(2)
    v_smfmac_f32_32x32x32_bf16 v[48:63], v[100:103], a[136:143], v121
    ds_read_b128 v[96:99], v4 offset:256
    v_add_f32 v32, v32, v36
    v_add_f32 v33, v33, v37
    v_add_f32 v34, v34, v38
    v_add_f32 v35, v35, v39
    v_cvt_pk_bf16_f32 v112, v32, v33
    v_cvt_pk_bf16_f32 v113, v34, v35
    ds_write_b64 v5, v[112:113]
    s_waitcnt lgkmcnt(3)
    v_smfmac_f32_32x32x32_bf16 v[48:63], v[104:107], a[144:151], v121
    ds_read_b128 v[100:103], v4 offset:320
    s_waitcnt lgkmcnt(3)
    v_smfmac_f32_32x32x32_bf16 v[48:63], v[108:111], a[152:159], v121
    ds_read_b128 v[104:107], v4 offset:384
    s_waitcnt lgkmcnt(3)
    v_smfmac_f32_32x32x32_bf16 v[48:63], v[96:99], a[160:167], v121
    ds_read_b128 v[108:111], v4 offset:448
    s_waitcnt lgkmcnt(3)
    s_barrier
    ds_read_b64_tr_b16 v[112:113], v122 offset:0
    ds_read_b64_tr_b16 v[114:115], v122 offset:64
    ds_read_b64_tr_b16 v[116:117], v122 offset:128
    ds_read_b64_tr_b16 v[118:119], v122 offset:192
    s_waitcnt lgkmcnt(6)
    v_smfmac_f32_32x32x32_bf16 v[48:63], v[100:103], a[168:175], v121
    ds_read_b128 v[96:99], v4 offset:512
    s_waitcnt lgkmcnt(6)
    v_smfmac_f32_32x32x32_bf16 v[48:63], v[104:107], a[176:183], v121
    ds_read_b128 v[100:103], v4 offset:576
    s_waitcnt lgkmcnt(4)
    v_mfma_f32_32x32x16_bf16 v[32:47], v[112:115], v[64:67], 0
    ds_read_b64_tr_b16 v[112:113], v122 offset:256
    ds_read_b64_tr_b16 v[114:115], v122 offset:320
    s_waitcnt lgkmcnt(4)
    v_mfma_f32_32x32x16_bf16 v[32:47], v[116:119], v[68:71], v[32:47]
    ds_read_b64_tr_b16 v[116:117], v122 offset:384
    ds_read_b64_tr_b16 v[118:119], v122 offset:448
    s_waitcnt lgkmcnt(2)
    v_mfma_f32_32x32x16_bf16 v[32:47], v[112:115], v[72:75], v[32:47]
    ds_read_b64_tr_b16 v[112:113], v122 offset:512
    ds_read_b64_tr_b16 v[114:115], v122 offset:576
    s_waitcnt lgkmcnt(2)
    v_mfma_f32_32x32x16_bf16 v[32:47], v[116:119], v[76:79], v[32:47]
    ds_read_b64_tr_b16 v[116:117], v122 offset:640
    ds_read_b64_tr_b16 v[118:119], v122 offset:704
    s_waitcnt lgkmcnt(2)
    v_mfma_f32_32x32x16_bf16 v[32:47], v[112:115], v[80:83], v[32:47]
    ds_read_b64_tr_b16 v[112:113], v122 offset:768
    ds_read_b64_tr_b16 v[114:115], v122 offset:832
    s_waitcnt lgkmcnt(2)
    v_mfma_f32_32x32x16_bf16 v[32:47], v[116:119], v[84:87], v[32:47]
    ds_read_b64_tr_b16 v[116:117], v122 offset:896
    ds_read_b64_tr_b16 v[118:119], v122 offset:960
    s_waitcnt lgkmcnt(2)
    v_mfma_f32_32x32x16_bf16 v[32:47], v[112:115], v[88:91], v[32:47]
    s_waitcnt lgkmcnt(0)
    v_mfma_f32_32x32x16_bf16 v[32:47], v[116:119], v[92:95], v[32:47]
    s_waitcnt lgkmcnt(15)
    v_smfmac_f32_32x32x32_bf16 v[48:63], v[108:111], a[184:191], v121
    ds_read_b128 v[104:107], v4 offset:640
    ds_read_b128 v[64:67], v124 offset:16384
    ds_read_b128 v[68:71], v124 offset:17408
    s_waitcnt lgkmcnt(15)
    v_smfmac_f32_32x32x32_bf16 v[48:63], v[96:99], a[192:199], v121
    ds_read_b128 v[108:111], v4 offset:704
    v_max3_f32 v126, v126, v32, v33
    v_max3_f32 v126, v126, v34, v35
    v_mov_b32 v127, v126
    v_mov_b64 v[86:87], 0
    v_mov_b64 v[74:75], 0
    v_permlane32_swap_b32 v126, v127
    v_max_f32 v126, v126, v127
    v_mul_f32 v126, s58, v126
    s_waitcnt lgkmcnt(15)
    v_smfmac_f32_32x32x32_bf16 v[48:63], v[100:103], a[200:207], v121
    ds_read_b128 v[96:99], v4 offset:768
    v_fma_f32 v16, v16, s58, -v126
    v_fma_f32 v17, v17, s58, -v126
    v_fma_f32 v18, v18, s58, -v126
    v_fma_f32 v19, v19, s58, -v126
    v_fma_f32 v20, v20, s58, -v126
    v_fma_f32 v21, v21, s58, -v126
    v_fma_f32 v22, v22, s58, -v126
    v_fma_f32 v23, v23, s58, -v126
    v_fma_f32 v24, v24, s58, -v126
    s_waitcnt lgkmcnt(4)
    v_smfmac_f32_32x32x32_bf16 v[48:63], v[104:107], a[208:215], v121
    ds_read_b128 v[100:103], v4 offset:832
    v_fma_f32 v25, v25, s58, -v126
    v_fma_f32 v26, v26, s58, -v126
    v_fma_f32 v27, v27, s58, -v126
    v_fma_f32 v28, v28, s58, -v126
    v_fma_f32 v29, v29, s58, -v126
    v_fma_f32 v30, v30, s58, -v126
    v_fma_f32 v31, v31, s58, -v126
    v_fma_f32 v32, v32, s58, -v126
    v_fma_f32 v33, v33, s58, -v126
    s_waitcnt lgkmcnt(2)
    v_smfmac_f32_32x32x32_bf16 v[48:63], v[108:111], a[216:223], v121
    ds_read_b128 v[104:107], v4 offset:896
    v_fma_f32 v34, v34, s58, -v126
    v_fma_f32 v35, v35, s58, -v126
    v_exp_f32 v16, v16
    v_exp_f32 v17, v17
    v_exp_f32 v18, v18
    v_exp_f32 v19, v19
    s_waitcnt lgkmcnt(2)
    v_smfmac_f32_32x32x32_bf16 v[48:63], v[96:99], a[224:231], v121
    ds_read_b128 v[108:111], v4 offset:960
    v_exp_f32 v20, v20
    v_exp_f32 v21, v21
    v_exp_f32 v22, v22
    v_exp_f32 v23, v23
    v_exp_f32 v24, v24
    s_waitcnt lgkmcnt(2)
    v_smfmac_f32_32x32x32_bf16 v[48:63], v[100:103], a[232:239], v121
    v_exp_f32 v25, v25
    v_exp_f32 v26, v26
    v_exp_f32 v27, v27
    v_exp_f32 v28, v28
    v_exp_f32 v29, v29
    s_waitcnt lgkmcnt(1)
    v_smfmac_f32_32x32x32_bf16 v[48:63], v[104:107], a[240:247], v121
    v_exp_f32 v30, v30
    v_exp_f32 v31, v31
    v_exp_f32 v32, v32
    v_exp_f32 v33, v33
    v_exp_f32 v34, v34
    s_waitcnt lgkmcnt(0)
    v_smfmac_f32_32x32x32_bf16 v[48:63], v[108:111], a[248:255], v121
    v_exp_f32 v35, v35
    v_cvt_pk_bf16_f32 v76, v16, v17
    v_cvt_pk_bf16_f32 v77, v18, v19
    v_cvt_pk_bf16_f32 v78, v24, v25
    v_cvt_pk_bf16_f32 v79, v26, v27
    v_cvt_pk_bf16_f32 v80, v20, v21
    v_cvt_pk_bf16_f32 v81, v22, v23
    v_cvt_pk_bf16_f32 v82, v28, v29
    v_cvt_pk_bf16_f32 v83, v30, v31
    v_cvt_pk_bf16_f32 v84, v32, v33
    v_cvt_pk_bf16_f32 v85, v34, v35
    s_waitcnt lgkmcnt(0)
    v_mfma_f32_32x32x16_bf16 v[96:111], v[64:67], v[76:79], 0
    v_add_f32 v36, v16, v17
    v_add_f32 v36, v36, v18
    v_add_f32 v36, v36, v19
    v_add_f32 v36, v36, v20
    v_add_f32 v36, v36, v21
    v_add_f32 v36, v36, v22
    v_mfma_f32_32x32x16_bf16 v[96:111], v[68:71], v[80:83], v[96:111]
    v_add_f32 v48, v48, v52
    v_add_f32 v49, v49, v53
    v_add_f32 v50, v50, v54
    v_add_f32 v51, v51, v55
    v_cvt_pk_bf16_f32 v72, v48, v49
    v_cvt_pk_bf16_f32 v73, v50, v51
    v_add_f32 v36, v36, v23
    v_add_f32 v36, v36, v24
    v_mfma_f32_32x32x16_bf16 v[96:111], v[72:75], v[84:87], v[96:111]
    v_add_f32 v36, v36, v25
    v_add_f32 v36, v36, v26
    v_add_f32 v36, v36, v27
    v_add_f32 v36, v36, v28
    v_add_f32 v36, v36, v29
    v_add_f32 v36, v36, v30
    v_add_f32 v36, v36, v31
    v_add_f32 v36, v36, v32
    v_add_f32 v36, v36, v33
    v_add_f32 v36, v36, v34
    v_add_f32 v36, v36, v35
    v_mov_b32 v37, v36
    s_nop 1
    v_permlane32_swap_b32 v36, v37
    v_add_f32 v36, v36, v37
    v_rcp_f32 v36, v36
    s_nop 0
    v_mul_f32 v96, v96, v36
    v_mul_f32 v97, v97, v36
    v_mul_f32 v98, v98, v36
    v_mul_f32 v99, v99, v36
    v_mul_f32 v100, v100, v36
    v_mul_f32 v101, v101, v36
    v_mul_f32 v102, v102, v36
    v_mul_f32 v103, v103, v36
    v_mul_f32 v104, v104, v36
    v_mul_f32 v105, v105, v36
    v_mul_f32 v106, v106, v36
    v_mul_f32 v107, v107, v36
    v_mul_f32 v108, v108, v36
    v_mul_f32 v109, v109, v36
    v_mul_f32 v110, v110, v36
    v_mul_f32 v111, v111, v36
    v_cvt_pk_bf16_f32 v16, v96, v97
    v_cvt_pk_bf16_f32 v17, v98, v99
    v_cvt_pk_bf16_f32 v18, v100, v101
    v_cvt_pk_bf16_f32 v19, v102, v103
    v_cvt_pk_bf16_f32 v20, v104, v105
    v_cvt_pk_bf16_f32 v21, v106, v107
    v_cvt_pk_bf16_f32 v22, v108, v109
    v_cvt_pk_bf16_f32 v23, v110, v111
    buffer_store_dwordx4 v[16:19], v6, s[36:39], s64 offen sc1
    buffer_store_dwordx4 v[20:23], v6, s[36:39], s64 offen offset:512 sc1
    s_add_u32 s64, s64, 1048576
    s_add_u32 s63, s63, 32768
    s_add_u32 s57, s57, 24576
    s_cmp_ge_u32 s57, 139264
    s_cbranch_scc0 QA_PB_l
    s_sub_u32 s57, s57, 73728
QA_PB_l:
    s_add_u32 s53, s53, 1
    s_waitcnt vmcnt(0)
    s_barrier
    s_cmp_lg_u32 s44, 0
    s_cbranch_scc1 QA_FB_l
    v_mov_b32 v96, s53
    s_mov_b64 exec, 1
    buffer_store_dword v96, v7, s[36:39], s60 offen sc1
    s_mov_b64 exec, -1
QA_FB_l:
    s_cmp_lt_u32 s53, 16
    s_cbranch_scc1 QA_LOOP
    s_waitcnt vmcnt(0)
    s_endpgm
REST:
    s_cmp_ge_u32 s45, 224
    s_cbranch_scc1 INIT
PA:
    s_sub_u32 s48, s45, 160
    v_and_b32 v2, 63, v0
    s_lshl_b32 s49, s48, 2
    s_add_u32 s49, s49, s44
    s_cmp_lt_u32 s48, 64
    s_cbranch_scc1 PA1
    s_mov_b32 s64, s10
    s_mov_b32 s65, s11
    s_mov_b32 s66, 1052672
    s_mov_b32 s67, 0x20000
    s_mov_b32 s60, s12
    s_mov_b32 s61, s13
    s_mov_b32 s62, 1052672
    s_mov_b32 s63, 0x20000
    v_and_b32 v4, 31, v2
    v_lshrrev_b32 v5, 5, v2
    v_lshl_add_u32 v6, v5, 7, v4
    v_mul_u32_u24 v6, 514, v6
    s_lshl_b32 s57, s48, 2
    s_min_u32 s57, s57, 253
    s_mul_i32 s52, s44, 263168
    s_add_u32 s52, s52, s57
    s_add_u32 s52, s52, s57
    s_and_b32 s51, s45, 31
    s_lshl_b32 s51, s51, 2
    s_add_u32 s51, s51, s44
    s_lshl_b32 s51, s51, 13
    v_lshlrev_b32 v4, 7, v2
    buffer_load_dword a96, v4, s[64:67], s51 offen
    buffer_load_dword a97, v4, s[60:63], s51 offen
    s_mul_i32 s52, s44, 263168
    s_add_u32 s52, s52, s57
    s_add_u32 s52, s52, s57
    s_add_u32 s51, s52, 0
    buffer_load_dwordx2 a[64:65], v6, s[64:67], s51 offen
    buffer_load_dwordx2 a[66:67], v6, s[60:63], s51 offen
    s_add_u32 s51, s52, 16448
    buffer_load_dwordx2 a[68:69], v6, s[64:67], s51 offen
    buffer_load_dwordx2 a[70:71], v6, s[60:63], s51 offen
    s_add_u32 s51, s52, 32896
    buffer_load_dwordx2 a[72:73], v6, s[64:67], s51 offen
    buffer_load_dwordx2 a[74:75], v6, s[60:63], s51 offen
    s_add_u32 s51, s52, 49344
    buffer_load_dwordx2 a[76:77], v6, s[64:67], s51 offen
    buffer_load_dwordx2 a[78:79], v6, s[60:63], s51 offen
    s_add_u32 s51, s52, 131584
    buffer_load_dwordx2 a[80:81], v6, s[64:67], s51 offen
    buffer_load_dwordx2 a[82:83], v6, s[60:63], s51 offen
    s_add_u32 s51, s52, 148032
    buffer_load_dwordx2 a[84:85], v6, s[64:67], s51 offen
    buffer_load_dwordx2 a[86:87], v6, s[60:63], s51 offen
    s_add_u32 s51, s52, 164480
    buffer_load_dwordx2 a[88:89], v6, s[64:67], s51 offen
    buffer_load_dwordx2 a[90:91], v6, s[60:63], s51 offen
    s_add_u32 s51, s52, 180928
    buffer_load_dwordx2 a[92:93], v6, s[64:67], s51 offen
    buffer_load_dwordx2 a[94:95], v6, s[60:63], s51 offen
    s_waitcnt vmcnt(0)
    s_lshl_b32 s51, s44, 12
    s_add_u32 s51, s51, 131072
    v_lshlrev_b32 v4, 3, v2
    v_add_u32 v4, s51, v4
    ds_write_b64 v4, a[64:65] offset:0
    ds_write_b64 v4, a[66:67] offset:16384
    ds_write_b64 v4, a[68:69] offset:512
    ds_write_b64 v4, a[70:71] offset:16896
    ds_write_b64 v4, a[72:73] offset:1024
    ds_write_b64 v4, a[74:75] offset:17408
    ds_write_b64 v4, a[76:77] offset:1536
    ds_write_b64 v4, a[78:79] offset:17920
    ds_write_b64 v4, a[80:81] offset:2048
    ds_write_b64 v4, a[82:83] offset:18432
    ds_write_b64 v4, a[84:85] offset:2560
    ds_write_b64 v4, a[86:87] offset:18944
    ds_write_b64 v4, a[88:89] offset:3072
    ds_write_b64 v4, a[90:91] offset:19456
    ds_write_b64 v4, a[92:93] offset:3584
    ds_write_b64 v4, a[94:95] offset:19968
    s_waitcnt lgkmcnt(0)
    s_barrier
    s_cmp_gt_u32 s49, 256
    s_cbranch_scc1 PA2_END
    s_branch PA2
PA1:
    s_and_b32 s51, s44, 1
    s_lshl_b32 s51, s51, 3
    v_xor_b32 v1, s51, v2
    v_lshlrev_b32 v1, 4, v1
    v_and_b32 v112, 15, v2
    v_lshrrev_b32 v113, 5, v2
    v_xor_b32 v112, v112, v113
    v_lshlrev_b32 v112, 4, v112
    v_and_b32 v113, 31, v2
    v_lshl_add_u32 v8, v113, 10, v112
    v_xor_b32 v9, 32, v8
    v_xor_b32 v10, 64, v8
    v_xor_b32 v11, 96, v8
    v_xor_b32 v12, 128, v8
    v_xor_b32 v13, 160, v8
    v_xor_b32 v14, 192, v8
    v_xor_b32 v15, 224, v8
    s_mov_b32 s40, s8
    s_mov_b32 s41, s9
    s_mov_b32 s42, 2097152
    s_mov_b32 s43, 0x20000
    s_lshr_b32 s58, s48, 2
    s_lshl_b32 s58, s58, 2
    s_lshl_b32 s53, s44, 19
    s_lshl_b32 s51, s58, 10
    s_add_u32 s53, s53, s51
    s_lshl_b32 s59, s44, 13
    v_xor_b32 v112, 0, v1
    s_add_u32 m0, s59, 0
    s_add_u32 s52, s53, 0
    buffer_load_dwordx4 v112, s[40:43], s52 offen lds
    v_xor_b32 v113, 16, v1
    s_add_u32 m0, s59, 1024
    s_add_u32 s52, s53, 65536
    buffer_load_dwordx4 v113, s[40:43], s52 offen lds
    v_xor_b32 v112, 32, v1
    s_add_u32 m0, s59, 2048
    s_add_u32 s52, s53, 131072
    buffer_load_dwordx4 v112, s[40:43], s52 offen lds
    v_xor_b32 v113, 48, v1
    s_add_u32 m0, s59, 3072
    s_add_u32 s52, s53, 196608
    buffer_load_dwordx4 v113, s[40:43], s52 offen lds
    v_xor_b32 v112, 64, v1
    s_add_u32 m0, s59, 4096
    s_add_u32 s52, s53, 262144
    buffer_load_dwordx4 v112, s[40:43], s52 offen lds
    v_xor_b32 v113, 80, v1
    s_add_u32 m0, s59, 5120
    s_add_u32 s52, s53, 327680
    buffer_load_dwordx4 v113, s[40:43], s52 offen lds
    v_xor_b32 v112, 96, v1
    s_add_u32 m0, s59, 6144
    s_add_u32 s52, s53, 393216
    buffer_load_dwordx4 v112, s[40:43], s52 offen lds
    v_xor_b32 v113, 112, v1
    s_add_u32 m0, s59, 7168
    s_add_u32 s52, s53, 458752
    buffer_load_dwordx4 v113, s[40:43], s52 offen lds
    s_add_u32 s53, s53, 1024
    s_add_u32 s59, s59, 32768
    v_xor_b32 v112, 0, v1
    s_add_u32 m0, s59, 0
    s_add_u32 s52, s53, 0
    buffer_load_dwordx4 v112, s[40:43], s52 offen lds
    v_xor_b32 v113, 16, v1
    s_add_u32 m0, s59, 1024
    s_add_u32 s52, s53, 65536
    buffer_load_dwordx4 v113, s[40:43], s52 offen lds
    v_xor_b32 v112, 32, v1
    s_add_u32 m0, s59, 2048
    s_add_u32 s52, s53, 131072
    buffer_load_dwordx4 v112, s[40:43], s52 offen lds
    v_xor_b32 v113, 48, v1
    s_add_u32 m0, s59, 3072
    s_add_u32 s52, s53, 196608
    buffer_load_dwordx4 v113, s[40:43], s52 offen lds
    v_xor_b32 v112, 64, v1
    s_add_u32 m0, s59, 4096
    s_add_u32 s52, s53, 262144
    buffer_load_dwordx4 v112, s[40:43], s52 offen lds
    v_xor_b32 v113, 80, v1
    s_add_u32 m0, s59, 5120
    s_add_u32 s52, s53, 327680
    buffer_load_dwordx4 v113, s[40:43], s52 offen lds
    v_xor_b32 v112, 96, v1
    s_add_u32 m0, s59, 6144
    s_add_u32 s52, s53, 393216
    buffer_load_dwordx4 v112, s[40:43], s52 offen lds
    v_xor_b32 v113, 112, v1
    s_add_u32 m0, s59, 7168
    s_add_u32 s52, s53, 458752
    buffer_load_dwordx4 v113, s[40:43], s52 offen lds
    s_add_u32 s53, s53, 1024
    s_add_u32 s59, s59, 32768
    v_xor_b32 v112, 0, v1
    s_add_u32 m0, s59, 0
    s_add_u32 s52, s53, 0
    buffer_load_dwordx4 v112, s[40:43], s52 offen lds
    v_xor_b32 v113, 16, v1
    s_add_u32 m0, s59, 1024
    s_add_u32 s52, s53, 65536
    buffer_load_dwordx4 v113, s[40:43], s52 offen lds
    v_xor_b32 v112, 32, v1
    s_add_u32 m0, s59, 2048
    s_add_u32 s52, s53, 131072
    buffer_load_dwordx4 v112, s[40:43], s52 offen lds
    v_xor_b32 v113, 48, v1
    s_add_u32 m0, s59, 3072
    s_add_u32 s52, s53, 196608
    buffer_load_dwordx4 v113, s[40:43], s52 offen lds
    v_xor_b32 v112, 64, v1
    s_add_u32 m0, s59, 4096
    s_add_u32 s52, s53, 262144
    buffer_load_dwordx4 v112, s[40:43], s52 offen lds
    v_xor_b32 v113, 80, v1
    s_add_u32 m0, s59, 5120
    s_add_u32 s52, s53, 327680
    buffer_load_dwordx4 v113, s[40:43], s52 offen lds
    v_xor_b32 v112, 96, v1
    s_add_u32 m0, s59, 6144
    s_add_u32 s52, s53, 393216
    buffer_load_dwordx4 v112, s[40:43], s52 offen lds
    v_xor_b32 v113, 112, v1
    s_add_u32 m0, s59, 7168
    s_add_u32 s52, s53, 458752
    buffer_load_dwordx4 v113, s[40:43], s52 offen lds
    s_add_u32 s53, s53, 1024
    s_add_u32 s59, s59, 32768
    v_xor_b32 v112, 0, v1
    s_add_u32 m0, s59, 0
    s_add_u32 s52, s53, 0
    buffer_load_dwordx4 v112, s[40:43], s52 offen lds
    v_xor_b32 v113, 16, v1
    s_add_u32 m0, s59, 1024
    s_add_u32 s52, s53, 65536
    buffer_load_dwordx4 v113, s[40:43], s52 offen lds
    v_xor_b32 v112, 32, v1
    s_add_u32 m0, s59, 2048
    s_add_u32 s52, s53, 131072
    buffer_load_dwordx4 v112, s[40:43], s52 offen lds
    v_xor_b32 v113, 48, v1
    s_add_u32 m0, s59, 3072
    s_add_u32 s52, s53, 196608
    buffer_load_dwordx4 v113, s[40:43], s52 offen lds
    v_xor_b32 v112, 64, v1
    s_add_u32 m0, s59, 4096
    s_add_u32 s52, s53, 262144
    buffer_load_dwordx4 v112, s[40:43], s52 offen lds
    v_xor_b32 v113, 80, v1
    s_add_u32 m0, s59, 5120
    s_add_u32 s52, s53, 327680
    buffer_load_dwordx4 v113, s[40:43], s52 offen lds
    v_xor_b32 v112, 96, v1
    s_add_u32 m0, s59, 6144
    s_add_u32 s52, s53, 393216
    buffer_load_dwordx4 v112, s[40:43], s52 offen lds
    v_xor_b32 v113, 112, v1
    s_add_u32 m0, s59, 7168
    s_add_u32 s52, s53, 458752
    buffer_load_dwordx4 v113, s[40:43], s52 offen lds
    s_add_u32 s53, s53, 1024
    s_add_u32 s59, s59, 32768
    s_mov_b32 s64, s10
    s_mov_b32 s65, s11
    s_mov_b32 s66, 1052672
    s_mov_b32 s67, 0x20000
    s_mov_b32 s60, s12
    s_mov_b32 s61, s13
    s_mov_b32 s62, 1052672
    s_mov_b32 s63, 0x20000
    v_and_b32 v4, 31, v2
    v_lshrrev_b32 v5, 5, v2
    v_lshl_add_u32 v6, v5, 7, v4
    v_mul_u32_u24 v6, 514, v6
    s_lshl_b32 s57, s48, 2
    s_min_u32 s57, s57, 253
    s_mul_i32 s52, s44, 263168
    s_add_u32 s52, s52, s57
    s_add_u32 s52, s52, s57
    s_and_b32 s51, s45, 31
    s_lshl_b32 s51, s51, 2
    s_add_u32 s51, s51, s44
    s_lshl_b32 s51, s51, 13
    v_lshlrev_b32 v4, 7, v2
    buffer_load_dword a96, v4, s[64:67], s51 offen
    buffer_load_dword a97, v4, s[60:63], s51 offen
    s_and_b32 s51, s48, 3
    s_lshl_b32 s51, s51, 2
    s_add_u32 s51, s51, s44
    s_lshl_b32 s51, s51, 5
    v_and_b32 v112, 31, v2
    v_add_u32 v112, s51, v112
    v_lshrrev_b32 v113, 5, v2
    v_lshlrev_b32 v3, 12, v112
    v_lshl_add_u32 v3, v113, 10, v3
    v_lshrrev_b32 v115, 1, v112
    v_and_b32 v116, 1, v112
    v_lshlrev_b32 v116, 7, v116
    v_cmp_eq_u32 vcc, 1, v112
    v_mov_b32 v114, 256
    s_nop 0
    v_cndmask_b32 v115, v115, v114, vcc
    v_cndmask_b32 v116, v116, 0, vcc
    v_lshlrev_b32 v113, 3, v113
    v_mad_u32_u24 v116, v115, v113, v116
    v_cvt_f32_u32 v115, v115
    v_cvt_f32_u32 v116, v116
    v_mul_f32 v115, 0x3b000000, v115
    v_mul_f32 v116, 0x3b000000, v116
    v_mul_f32 v114, 0x41800000, v115
    v_fract_f32 v120, v116
    v_add_f32 v121, v120, v115
    v_add_f32 v122, v121, v115
    v_add_f32 v123, v122, v115
    v_add_f32 v124, v123, v115
    v_add_f32 v125, v124, v115
    v_add_f32 v126, v125, v115
    v_add_f32 v127, v126, v115
    v_add_f32 v116, v120, v114
    v_cos_f32 v120, v120
    v_cos_f32 v121, v121
    v_cos_f32 v122, v122
    v_cos_f32 v123, v123
    v_cos_f32 v124, v124
    v_cos_f32 v125, v125
    v_cos_f32 v126, v126
    v_cos_f32 v127, v127
    v_cvt_pk_bf16_f32 v128, v120, v121
    v_cvt_pk_bf16_f32 v129, v122, v123
    v_cvt_pk_bf16_f32 v130, v124, v125
    v_cvt_pk_bf16_f32 v131, v126, v127
    v_fract_f32 v120, v116
    v_add_f32 v121, v120, v115
    v_add_f32 v122, v121, v115
    v_add_f32 v123, v122, v115
    v_add_f32 v124, v123, v115
    v_add_f32 v125, v124, v115
    v_add_f32 v126, v125, v115
    v_add_f32 v127, v126, v115
    v_add_f32 v116, v120, v114
    v_cos_f32 v120, v120
    v_cos_f32 v121, v121
    v_cos_f32 v122, v122
    v_cos_f32 v123, v123
    v_cos_f32 v124, v124
    v_cos_f32 v125, v125
    v_cos_f32 v126, v126
    v_cos_f32 v127, v127
    v_cvt_pk_bf16_f32 v132, v120, v121
    v_cvt_pk_bf16_f32 v133, v122, v123
    v_cvt_pk_bf16_f32 v134, v124, v125
    v_cvt_pk_bf16_f32 v135, v126, v127
    v_fract_f32 v120, v116
    v_add_f32 v121, v120, v115
    v_add_f32 v122, v121, v115
    v_add_f32 v123, v122, v115
    v_add_f32 v124, v123, v115
    v_add_f32 v125, v124, v115
    v_add_f32 v126, v125, v115
    v_add_f32 v127, v126, v115
    v_add_f32 v116, v120, v114
    v_cos_f32 v120, v120
    v_cos_f32 v121, v121
    v_cos_f32 v122, v122
    v_cos_f32 v123, v123
    v_cos_f32 v124, v124
    v_cos_f32 v125, v125
    v_cos_f32 v126, v126
    v_cos_f32 v127, v127
    v_cvt_pk_bf16_f32 v136, v120, v121
    v_cvt_pk_bf16_f32 v137, v122, v123
    v_cvt_pk_bf16_f32 v138, v124, v125
    v_cvt_pk_bf16_f32 v139, v126, v127
    v_fract_f32 v120, v116
    v_add_f32 v121, v120, v115
    v_add_f32 v122, v121, v115
    v_add_f32 v123, v122, v115
    v_add_f32 v124, v123, v115
    v_add_f32 v125, v124, v115
    v_add_f32 v126, v125, v115
    v_add_f32 v127, v126, v115
    v_add_f32 v116, v120, v114
    v_cos_f32 v120, v120
    v_cos_f32 v121, v121
    v_cos_f32 v122, v122
    v_cos_f32 v123, v123
    v_cos_f32 v124, v124
    v_cos_f32 v125, v125
    v_cos_f32 v126, v126
    v_cos_f32 v127, v127
    v_cvt_pk_bf16_f32 v140, v120, v121
    v_cvt_pk_bf16_f32 v141, v122, v123
    v_cvt_pk_bf16_f32 v142, v124, v125
    v_cvt_pk_bf16_f32 v143, v126, v127
    v_fract_f32 v120, v116
    v_add_f32 v121, v120, v115
    v_add_f32 v122, v121, v115
    v_add_f32 v123, v122, v115
    v_add_f32 v124, v123, v115
    v_add_f32 v125, v124, v115
    v_add_f32 v126, v125, v115
    v_add_f32 v127, v126, v115
    v_add_f32 v116, v120, v114
    v_cos_f32 v120, v120
    v_cos_f32 v121, v121
    v_cos_f32 v122, v122
    v_cos_f32 v123, v123
    v_cos_f32 v124, v124
    v_cos_f32 v125, v125
    v_cos_f32 v126, v126
    v_cos_f32 v127, v127
    v_cvt_pk_bf16_f32 v144, v120, v121
    v_cvt_pk_bf16_f32 v145, v122, v123
    v_cvt_pk_bf16_f32 v146, v124, v125
    v_cvt_pk_bf16_f32 v147, v126, v127
    v_fract_f32 v120, v116
    v_add_f32 v121, v120, v115
    v_add_f32 v122, v121, v115
    v_add_f32 v123, v122, v115
    v_add_f32 v124, v123, v115
    v_add_f32 v125, v124, v115
    v_add_f32 v126, v125, v115
    v_add_f32 v127, v126, v115
    v_add_f32 v116, v120, v114
    v_cos_f32 v120, v120
    v_cos_f32 v121, v121
    v_cos_f32 v122, v122
    v_cos_f32 v123, v123
    v_cos_f32 v124, v124
    v_cos_f32 v125, v125
    v_cos_f32 v126, v126
    v_cos_f32 v127, v127
    v_cvt_pk_bf16_f32 v148, v120, v121
    v_cvt_pk_bf16_f32 v149, v122, v123
    v_cvt_pk_bf16_f32 v150, v124, v125
    v_cvt_pk_bf16_f32 v151, v126, v127
    v_fract_f32 v120, v116
    v_add_f32 v121, v120, v115
    v_add_f32 v122, v121, v115
    v_add_f32 v123, v122, v115
    v_add_f32 v124, v123, v115
    v_add_f32 v125, v124, v115
    v_add_f32 v126, v125, v115
    v_add_f32 v127, v126, v115
    v_add_f32 v116, v120, v114
    v_cos_f32 v120, v120
    v_cos_f32 v121, v121
    v_cos_f32 v122, v122
    v_cos_f32 v123, v123
    v_cos_f32 v124, v124
    v_cos_f32 v125, v125
    v_cos_f32 v126, v126
    v_cos_f32 v127, v127
    v_cvt_pk_bf16_f32 v152, v120, v121
    v_cvt_pk_bf16_f32 v153, v122, v123
    v_cvt_pk_bf16_f32 v154, v124, v125
    v_cvt_pk_bf16_f32 v155, v126, v127
    v_fract_f32 v120, v116
    v_add_f32 v121, v120, v115
    v_add_f32 v122, v121, v115
    v_add_f32 v123, v122, v115
    v_add_f32 v124, v123, v115
    v_add_f32 v125, v124, v115
    v_add_f32 v126, v125, v115
    v_add_f32 v127, v126, v115
    v_add_f32 v116, v120, v114
    v_cos_f32 v120, v120
    v_cos_f32 v121, v121
    v_cos_f32 v122, v122
    v_cos_f32 v123, v123
    v_cos_f32 v124, v124
    v_cos_f32 v125, v125
    v_cos_f32 v126, v126
    v_cos_f32 v127, v127
    v_cvt_pk_bf16_f32 v156, v120, v121
    v_cvt_pk_bf16_f32 v157, v122, v123
    v_cvt_pk_bf16_f32 v158, v124, v125
    v_cvt_pk_bf16_f32 v159, v126, v127
    v_fract_f32 v120, v116
    v_add_f32 v121, v120, v115
    v_add_f32 v122, v121, v115
    v_add_f32 v123, v122, v115
    v_add_f32 v124, v123, v115
    v_add_f32 v125, v124, v115
    v_add_f32 v126, v125, v115
    v_add_f32 v127, v126, v115
    v_add_f32 v116, v120, v114
    v_cos_f32 v120, v120
    v_cos_f32 v121, v121
    v_cos_f32 v122, v122
    v_cos_f32 v123, v123
    v_cos_f32 v124, v124
    v_cos_f32 v125, v125
    v_cos_f32 v126, v126
    v_cos_f32 v127, v127
    v_cvt_pk_bf16_f32 v160, v120, v121
    v_cvt_pk_bf16_f32 v161, v122, v123
    v_cvt_pk_bf16_f32 v162, v124, v125
    v_cvt_pk_bf16_f32 v163, v126, v127
    v_fract_f32 v120, v116
    v_add_f32 v121, v120, v115
    v_add_f32 v122, v121, v115
    v_add_f32 v123, v122, v115
    v_add_f32 v124, v123, v115
    v_add_f32 v125, v124, v115
    v_add_f32 v126, v125, v115
    v_add_f32 v127, v126, v115
    v_add_f32 v116, v120, v114
    v_cos_f32 v120, v120
    v_cos_f32 v121, v121
    v_cos_f32 v122, v122
    v_cos_f32 v123, v123
    v_cos_f32 v124, v124
    v_cos_f32 v125, v125
    v_cos_f32 v126, v126
    v_cos_f32 v127, v127
    v_cvt_pk_bf16_f32 v164, v120, v121
    v_cvt_pk_bf16_f32 v165, v122, v123
    v_cvt_pk_bf16_f32 v166, v124, v125
    v_cvt_pk_bf16_f32 v167, v126, v127
    v_fract_f32 v120, v116
    v_add_f32 v121, v120, v115
    v_add_f32 v122, v121, v115
    v_add_f32 v123, v122, v115
    v_add_f32 v124, v123, v115
    v_add_f32 v125, v124, v115
    v_add_f32 v126, v125, v115
    v_add_f32 v127, v126, v115
    v_add_f32 v116, v120, v114
    v_cos_f32 v120, v120
    v_cos_f32 v121, v121
    v_cos_f32 v122, v122
    v_cos_f32 v123, v123
    v_cos_f32 v124, v124
    v_cos_f32 v125, v125
    v_cos_f32 v126, v126
    v_cos_f32 v127, v127
    v_cvt_pk_bf16_f32 v168, v120, v121
    v_cvt_pk_bf16_f32 v169, v122, v123
    v_cvt_pk_bf16_f32 v170, v124, v125
    v_cvt_pk_bf16_f32 v171, v126, v127
    v_fract_f32 v120, v116
    v_add_f32 v121, v120, v115
    v_add_f32 v122, v121, v115
    v_add_f32 v123, v122, v115
    v_add_f32 v124, v123, v115
    v_add_f32 v125, v124, v115
    v_add_f32 v126, v125, v115
    v_add_f32 v127, v126, v115
    v_add_f32 v116, v120, v114
    v_cos_f32 v120, v120
    v_cos_f32 v121, v121
    v_cos_f32 v122, v122
    v_cos_f32 v123, v123
    v_cos_f32 v124, v124
    v_cos_f32 v125, v125
    v_cos_f32 v126, v126
    v_cos_f32 v127, v127
    v_cvt_pk_bf16_f32 v172, v120, v121
    v_cvt_pk_bf16_f32 v173, v122, v123
    v_cvt_pk_bf16_f32 v174, v124, v125
    v_cvt_pk_bf16_f32 v175, v126, v127
    v_fract_f32 v120, v116
    v_add_f32 v121, v120, v115
    v_add_f32 v122, v121, v115
    v_add_f32 v123, v122, v115
    v_add_f32 v124, v123, v115
    v_add_f32 v125, v124, v115
    v_add_f32 v126, v125, v115
    v_add_f32 v127, v126, v115
    v_add_f32 v116, v120, v114
    v_cos_f32 v120, v120
    v_cos_f32 v121, v121
    v_cos_f32 v122, v122
    v_cos_f32 v123, v123
    v_cos_f32 v124, v124
    v_cos_f32 v125, v125
    v_cos_f32 v126, v126
    v_cos_f32 v127, v127
    v_cvt_pk_bf16_f32 v176, v120, v121
    v_cvt_pk_bf16_f32 v177, v122, v123
    v_cvt_pk_bf16_f32 v178, v124, v125
    v_cvt_pk_bf16_f32 v179, v126, v127
    v_fract_f32 v120, v116
    v_add_f32 v121, v120, v115
    v_add_f32 v122, v121, v115
    v_add_f32 v123, v122, v115
    v_add_f32 v124, v123, v115
    v_add_f32 v125, v124, v115
    v_add_f32 v126, v125, v115
    v_add_f32 v127, v126, v115
    v_add_f32 v116, v120, v114
    v_cos_f32 v120, v120
    v_cos_f32 v121, v121
    v_cos_f32 v122, v122
    v_cos_f32 v123, v123
    v_cos_f32 v124, v124
    v_cos_f32 v125, v125
    v_cos_f32 v126, v126
    v_cos_f32 v127, v127
    v_cvt_pk_bf16_f32 v180, v120, v121
    v_cvt_pk_bf16_f32 v181, v122, v123
    v_cvt_pk_bf16_f32 v182, v124, v125
    v_cvt_pk_bf16_f32 v183, v126, v127
    v_fract_f32 v120, v116
    v_add_f32 v121, v120, v115
    v_add_f32 v122, v121, v115
    v_add_f32 v123, v122, v115
    v_add_f32 v124, v123, v115
    v_add_f32 v125, v124, v115
    v_add_f32 v126, v125, v115
    v_add_f32 v127, v126, v115
    v_add_f32 v116, v120, v114
    v_cos_f32 v120, v120
    v_cos_f32 v121, v121
    v_cos_f32 v122, v122
    v_cos_f32 v123, v123
    v_cos_f32 v124, v124
    v_cos_f32 v125, v125
    v_cos_f32 v126, v126
    v_cos_f32 v127, v127
    v_cvt_pk_bf16_f32 v184, v120, v121
    v_cvt_pk_bf16_f32 v185, v122, v123
    v_cvt_pk_bf16_f32 v186, v124, v125
    v_cvt_pk_bf16_f32 v187, v126, v127
    v_fract_f32 v120, v116
    v_add_f32 v121, v120, v115
    v_add_f32 v122, v121, v115
    v_add_f32 v123, v122, v115
    v_add_f32 v124, v123, v115
    v_add_f32 v125, v124, v115
    v_add_f32 v126, v125, v115
    v_add_f32 v127, v126, v115
    v_add_f32 v116, v120, v114
    v_cos_f32 v120, v120
    v_cos_f32 v121, v121
    v_cos_f32 v122, v122
    v_cos_f32 v123, v123
    v_cos_f32 v124, v124
    v_cos_f32 v125, v125
    v_cos_f32 v126, v126
    v_cos_f32 v127, v127
    v_cvt_pk_bf16_f32 v188, v120, v121
    v_cvt_pk_bf16_f32 v189, v122, v123
    v_cvt_pk_bf16_f32 v190, v124, v125
    v_cvt_pk_bf16_f32 v191, v126, v127
    v_fract_f32 v120, v116
    v_add_f32 v121, v120, v115
    v_add_f32 v122, v121, v115
    v_add_f32 v123, v122, v115
    v_add_f32 v124, v123, v115
    v_add_f32 v125, v124, v115
    v_add_f32 v126, v125, v115
    v_add_f32 v127, v126, v115
    v_add_f32 v116, v120, v114
    v_cos_f32 v120, v120
    v_cos_f32 v121, v121
    v_cos_f32 v122, v122
    v_cos_f32 v123, v123
    v_cos_f32 v124, v124
    v_cos_f32 v125, v125
    v_cos_f32 v126, v126
    v_cos_f32 v127, v127
    v_cvt_pk_bf16_f32 v192, v120, v121
    v_cvt_pk_bf16_f32 v193, v122, v123
    v_cvt_pk_bf16_f32 v194, v124, v125
    v_cvt_pk_bf16_f32 v195, v126, v127
    v_fract_f32 v120, v116
    v_add_f32 v121, v120, v115
    v_add_f32 v122, v121, v115
    v_add_f32 v123, v122, v115
    v_add_f32 v124, v123, v115
    v_add_f32 v125, v124, v115
    v_add_f32 v126, v125, v115
    v_add_f32 v127, v126, v115
    v_add_f32 v116, v120, v114
    v_cos_f32 v120, v120
    v_cos_f32 v121, v121
    v_cos_f32 v122, v122
    v_cos_f32 v123, v123
    v_cos_f32 v124, v124
    v_cos_f32 v125, v125
    v_cos_f32 v126, v126
    v_cos_f32 v127, v127
    v_cvt_pk_bf16_f32 v196, v120, v121
    v_cvt_pk_bf16_f32 v197, v122, v123
    v_cvt_pk_bf16_f32 v198, v124, v125
    v_cvt_pk_bf16_f32 v199, v126, v127
    v_fract_f32 v120, v116
    v_add_f32 v121, v120, v115
    v_add_f32 v122, v121, v115
    v_add_f32 v123, v122, v115
    v_add_f32 v124, v123, v115
    v_add_f32 v125, v124, v115
    v_add_f32 v126, v125, v115
    v_add_f32 v127, v126, v115
    v_add_f32 v116, v120, v114
    v_cos_f32 v120, v120
    v_cos_f32 v121, v121
    v_cos_f32 v122, v122
    v_cos_f32 v123, v123
    v_cos_f32 v124, v124
    v_cos_f32 v125, v125
    v_cos_f32 v126, v126
    v_cos_f32 v127, v127
    v_cvt_pk_bf16_f32 v200, v120, v121
    v_cvt_pk_bf16_f32 v201, v122, v123
    v_cvt_pk_bf16_f32 v202, v124, v125
    v_cvt_pk_bf16_f32 v203, v126, v127
    v_fract_f32 v120, v116
    v_add_f32 v121, v120, v115
    v_add_f32 v122, v121, v115
    v_add_f32 v123, v122, v115
    v_add_f32 v124, v123, v115
    v_add_f32 v125, v124, v115
    v_add_f32 v126, v125, v115
    v_add_f32 v127, v126, v115
    v_add_f32 v116, v120, v114
    v_cos_f32 v120, v120
    v_cos_f32 v121, v121
    v_cos_f32 v122, v122
    v_cos_f32 v123, v123
    v_cos_f32 v124, v124
    v_cos_f32 v125, v125
    v_cos_f32 v126, v126
    v_cos_f32 v127, v127
    v_cvt_pk_bf16_f32 v204, v120, v121
    v_cvt_pk_bf16_f32 v205, v122, v123
    v_cvt_pk_bf16_f32 v206, v124, v125
    v_cvt_pk_bf16_f32 v207, v126, v127
    v_fract_f32 v120, v116
    v_add_f32 v121, v120, v115
    v_add_f32 v122, v121, v115
    v_add_f32 v123, v122, v115
    v_add_f32 v124, v123, v115
    v_add_f32 v125, v124, v115
    v_add_f32 v126, v125, v115
    v_add_f32 v127, v126, v115
    v_add_f32 v116, v120, v114
    v_cos_f32 v120, v120
    v_cos_f32 v121, v121
    v_cos_f32 v122, v122
    v_cos_f32 v123, v123
    v_cos_f32 v124, v124
    v_cos_f32 v125, v125
    v_cos_f32 v126, v126
    v_cos_f32 v127, v127
    v_cvt_pk_bf16_f32 v208, v120, v121
    v_cvt_pk_bf16_f32 v209, v122, v123
    v_cvt_pk_bf16_f32 v210, v124, v125
    v_cvt_pk_bf16_f32 v211, v126, v127
    v_fract_f32 v120, v116
    v_add_f32 v121, v120, v115
    v_add_f32 v122, v121, v115
    v_add_f32 v123, v122, v115
    v_add_f32 v124, v123, v115
    v_add_f32 v125, v124, v115
    v_add_f32 v126, v125, v115
    v_add_f32 v127, v126, v115
    v_add_f32 v116, v120, v114
    v_cos_f32 v120, v120
    v_cos_f32 v121, v121
    v_cos_f32 v122, v122
    v_cos_f32 v123, v123
    v_cos_f32 v124, v124
    v_cos_f32 v125, v125
    v_cos_f32 v126, v126
    v_cos_f32 v127, v127
    v_cvt_pk_bf16_f32 v212, v120, v121
    v_cvt_pk_bf16_f32 v213, v122, v123
    v_cvt_pk_bf16_f32 v214, v124, v125
    v_cvt_pk_bf16_f32 v215, v126, v127
    v_fract_f32 v120, v116
    v_add_f32 v121, v120, v115
    v_add_f32 v122, v121, v115
    v_add_f32 v123, v122, v115
    v_add_f32 v124, v123, v115
    v_add_f32 v125, v124, v115
    v_add_f32 v126, v125, v115
    v_add_f32 v127, v126, v115
    v_add_f32 v116, v120, v114
    v_cos_f32 v120, v120
    v_cos_f32 v121, v121
    v_cos_f32 v122, v122
    v_cos_f32 v123, v123
    v_cos_f32 v124, v124
    v_cos_f32 v125, v125
    v_cos_f32 v126, v126
    v_cos_f32 v127, v127
    v_cvt_pk_bf16_f32 v216, v120, v121
    v_cvt_pk_bf16_f32 v217, v122, v123
    v_cvt_pk_bf16_f32 v218, v124, v125
    v_cvt_pk_bf16_f32 v219, v126, v127
    v_fract_f32 v120, v116
    v_add_f32 v121, v120, v115
    v_add_f32 v122, v121, v115
    v_add_f32 v123, v122, v115
    v_add_f32 v124, v123, v115
    v_add_f32 v125, v124, v115
    v_add_f32 v126, v125, v115
    v_add_f32 v127, v126, v115
    v_add_f32 v116, v120, v114
    v_cos_f32 v120, v120
    v_cos_f32 v121, v121
    v_cos_f32 v122, v122
    v_cos_f32 v123, v123
    v_cos_f32 v124, v124
    v_cos_f32 v125, v125
    v_cos_f32 v126, v126
    v_cos_f32 v127, v127
    v_cvt_pk_bf16_f32 v220, v120, v121
    v_cvt_pk_bf16_f32 v221, v122, v123
    v_cvt_pk_bf16_f32 v222, v124, v125
    v_cvt_pk_bf16_f32 v223, v126, v127
    v_fract_f32 v120, v116
    v_add_f32 v121, v120, v115
    v_add_f32 v122, v121, v115
    v_add_f32 v123, v122, v115
    v_add_f32 v124, v123, v115
    v_add_f32 v125, v124, v115
    v_add_f32 v126, v125, v115
    v_add_f32 v127, v126, v115
    v_add_f32 v116, v120, v114
    v_cos_f32 v120, v120
    v_cos_f32 v121, v121
    v_cos_f32 v122, v122
    v_cos_f32 v123, v123
    v_cos_f32 v124, v124
    v_cos_f32 v125, v125
    v_cos_f32 v126, v126
    v_cos_f32 v127, v127
    v_cvt_pk_bf16_f32 v224, v120, v121
    v_cvt_pk_bf16_f32 v225, v122, v123
    v_cvt_pk_bf16_f32 v226, v124, v125
    v_cvt_pk_bf16_f32 v227, v126, v127
    v_fract_f32 v120, v116
    v_add_f32 v121, v120, v115
    v_add_f32 v122, v121, v115
    v_add_f32 v123, v122, v115
    v_add_f32 v124, v123, v115
    v_add_f32 v125, v124, v115
    v_add_f32 v126, v125, v115
    v_add_f32 v127, v126, v115
    v_add_f32 v116, v120, v114
    v_cos_f32 v120, v120
    v_cos_f32 v121, v121
    v_cos_f32 v122, v122
    v_cos_f32 v123, v123
    v_cos_f32 v124, v124
    v_cos_f32 v125, v125
    v_cos_f32 v126, v126
    v_cos_f32 v127, v127
    v_cvt_pk_bf16_f32 v228, v120, v121
    v_cvt_pk_bf16_f32 v229, v122, v123
    v_cvt_pk_bf16_f32 v230, v124, v125
    v_cvt_pk_bf16_f32 v231, v126, v127
    v_fract_f32 v120, v116
    v_add_f32 v121, v120, v115
    v_add_f32 v122, v121, v115
    v_add_f32 v123, v122, v115
    v_add_f32 v124, v123, v115
    v_add_f32 v125, v124, v115
    v_add_f32 v126, v125, v115
    v_add_f32 v127, v126, v115
    v_add_f32 v116, v120, v114
    v_cos_f32 v120, v120
    v_cos_f32 v121, v121
    v_cos_f32 v122, v122
    v_cos_f32 v123, v123
    v_cos_f32 v124, v124
    v_cos_f32 v125, v125
    v_cos_f32 v126, v126
    v_cos_f32 v127, v127
    v_cvt_pk_bf16_f32 v232, v120, v121
    v_cvt_pk_bf16_f32 v233, v122, v123
    v_cvt_pk_bf16_f32 v234, v124, v125
    v_cvt_pk_bf16_f32 v235, v126, v127
    v_fract_f32 v120, v116
    v_add_f32 v121, v120, v115
    v_add_f32 v122, v121, v115
    v_add_f32 v123, v122, v115
    v_add_f32 v124, v123, v115
    v_add_f32 v125, v124, v115
    v_add_f32 v126, v125, v115
    v_add_f32 v127, v126, v115
    v_add_f32 v116, v120, v114
    v_cos_f32 v120, v120
    v_cos_f32 v121, v121
    v_cos_f32 v122, v122
    v_cos_f32 v123, v123
    v_cos_f32 v124, v124
    v_cos_f32 v125, v125
    v_cos_f32 v126, v126
    v_cos_f32 v127, v127
    v_cvt_pk_bf16_f32 v236, v120, v121
    v_cvt_pk_bf16_f32 v237, v122, v123
    v_cvt_pk_bf16_f32 v238, v124, v125
    v_cvt_pk_bf16_f32 v239, v126, v127
    v_fract_f32 v120, v116
    v_add_f32 v121, v120, v115
    v_add_f32 v122, v121, v115
    v_add_f32 v123, v122, v115
    v_add_f32 v124, v123, v115
    v_add_f32 v125, v124, v115
    v_add_f32 v126, v125, v115
    v_add_f32 v127, v126, v115
    v_add_f32 v116, v120, v114
    v_cos_f32 v120, v120
    v_cos_f32 v121, v121
    v_cos_f32 v122, v122
    v_cos_f32 v123, v123
    v_cos_f32 v124, v124
    v_cos_f32 v125, v125
    v_cos_f32 v126, v126
    v_cos_f32 v127, v127
    v_cvt_pk_bf16_f32 v240, v120, v121
    v_cvt_pk_bf16_f32 v241, v122, v123
    v_cvt_pk_bf16_f32 v242, v124, v125
    v_cvt_pk_bf16_f32 v243, v126, v127
    v_fract_f32 v120, v116
    v_add_f32 v121, v120, v115
    v_add_f32 v122, v121, v115
    v_add_f32 v123, v122, v115
    v_add_f32 v124, v123, v115
    v_add_f32 v125, v124, v115
    v_add_f32 v126, v125, v115
    v_add_f32 v127, v126, v115
    v_add_f32 v116, v120, v114
    v_cos_f32 v120, v120
    v_cos_f32 v121, v121
    v_cos_f32 v122, v122
    v_cos_f32 v123, v123
    v_cos_f32 v124, v124
    v_cos_f32 v125, v125
    v_cos_f32 v126, v126
    v_cos_f32 v127, v127
    v_cvt_pk_bf16_f32 v244, v120, v121
    v_cvt_pk_bf16_f32 v245, v122, v123
    v_cvt_pk_bf16_f32 v246, v124, v125
    v_cvt_pk_bf16_f32 v247, v126, v127
    v_fract_f32 v120, v116
    v_add_f32 v121, v120, v115
    v_add_f32 v122, v121, v115
    v_add_f32 v123, v122, v115
    v_add_f32 v124, v123, v115
    v_add_f32 v125, v124, v115
    v_add_f32 v126, v125, v115
    v_add_f32 v127, v126, v115
    v_add_f32 v116, v120, v114
    v_cos_f32 v120, v120
    v_cos_f32 v121, v121
    v_cos_f32 v122, v122
    v_cos_f32 v123, v123
    v_cos_f32 v124, v124
    v_cos_f32 v125, v125
    v_cos_f32 v126, v126
    v_cos_f32 v127, v127
    v_cvt_pk_bf16_f32 v248, v120, v121
    v_cvt_pk_bf16_f32 v249, v122, v123
    v_cvt_pk_bf16_f32 v250, v124, v125
    v_cvt_pk_bf16_f32 v251, v126, v127
    v_fract_f32 v120, v116
    v_add_f32 v121, v120, v115
    v_add_f32 v122, v121, v115
    v_add_f32 v123, v122, v115
    v_add_f32 v124, v123, v115
    v_add_f32 v125, v124, v115
    v_add_f32 v126, v125, v115
    v_add_f32 v127, v126, v115
    v_add_f32 v116, v120, v114
    v_cos_f32 v120, v120
    v_cos_f32 v121, v121
    v_cos_f32 v122, v122
    v_cos_f32 v123, v123
    v_cos_f32 v124, v124
    v_cos_f32 v125, v125
    v_cos_f32 v126, v126
    v_cos_f32 v127, v127
    v_cvt_pk_bf16_f32 v252, v120, v121
    v_cvt_pk_bf16_f32 v253, v122, v123
    v_cvt_pk_bf16_f32 v254, v124, v125
    v_cvt_pk_bf16_f32 v255, v126, v127
    s_lshl_b32 s53, s58, 4
    s_add_u32 s53, s53, 61865984
    s_waitcnt vmcnt(0)
    s_barrier
    s_mul_i32 s52, s44, 263168
    s_add_u32 s52, s52, s57
    s_add_u32 s52, s52, s57
    s_add_u32 s51, s52, 0
    buffer_load_dwordx2 a[64:65], v6, s[64:67], s51 offen
    buffer_load_dwordx2 a[66:67], v6, s[60:63], s51 offen
    s_add_u32 s51, s52, 16448
    buffer_load_dwordx2 a[68:69], v6, s[64:67], s51 offen
    buffer_load_dwordx2 a[70:71], v6, s[60:63], s51 offen
    s_add_u32 s51, s52, 32896
    buffer_load_dwordx2 a[72:73], v6, s[64:67], s51 offen
    buffer_load_dwordx2 a[74:75], v6, s[60:63], s51 offen
    s_add_u32 s51, s52, 49344
    buffer_load_dwordx2 a[76:77], v6, s[64:67], s51 offen
    buffer_load_dwordx2 a[78:79], v6, s[60:63], s51 offen
    s_add_u32 s51, s52, 131584
    buffer_load_dwordx2 a[80:81], v6, s[64:67], s51 offen
    buffer_load_dwordx2 a[82:83], v6, s[60:63], s51 offen
    s_add_u32 s51, s52, 148032
    buffer_load_dwordx2 a[84:85], v6, s[64:67], s51 offen
    buffer_load_dwordx2 a[86:87], v6, s[60:63], s51 offen
    s_add_u32 s51, s52, 164480
    buffer_load_dwordx2 a[88:89], v6, s[64:67], s51 offen
    buffer_load_dwordx2 a[90:91], v6, s[60:63], s51 offen
    s_add_u32 s51, s52, 180928
    buffer_load_dwordx2 a[92:93], v6, s[64:67], s51 offen
    buffer_load_dwordx2 a[94:95], v6, s[60:63], s51 offen
    ds_read_b128 v[80:83], v8 offset:0
    ds_read_b128 v[84:87], v9 offset:0
    ds_read_b128 v[88:91], v10 offset:0
    ds_read_b128 v[92:95], v11 offset:0
    ds_read_b128 v[96:99], v12 offset:0
    ds_read_b128 v[100:103], v13 offset:0
    s_waitcnt lgkmcnt(5)
    v_mfma_f32_32x32x16_bf16 v[16:31], v[80:83], v[128:131], 0
    ds_read_b128 v[104:107], v14 offset:0
    s_waitcnt lgkmcnt(5)
    v_mfma_f32_32x32x16_bf16 v[16:31], v[84:87], v[132:135], v[16:31]
    ds_read_b128 v[108:111], v15 offset:0
    s_waitcnt lgkmcnt(5)
    v_mfma_f32_32x32x16_bf16 v[16:31], v[88:91], v[136:139], v[16:31]
    ds_read_b128 v[80:83], v8 offset:256
    s_waitcnt lgkmcnt(5)
    v_mfma_f32_32x32x16_bf16 v[16:31], v[92:95], v[140:143], v[16:31]
    ds_read_b128 v[84:87], v9 offset:256
    s_waitcnt lgkmcnt(5)
    v_mfma_f32_32x32x16_bf16 v[16:31], v[96:99], v[144:147], v[16:31]
    ds_read_b128 v[88:91], v10 offset:256
    s_waitcnt lgkmcnt(5)
    v_mfma_f32_32x32x16_bf16 v[16:31], v[100:103], v[148:151], v[16:31]
    ds_read_b128 v[92:95], v11 offset:256
    s_waitcnt lgkmcnt(5)
    v_mfma_f32_32x32x16_bf16 v[16:31], v[104:107], v[152:155], v[16:31]
    ds_read_b128 v[96:99], v12 offset:256
    s_waitcnt lgkmcnt(5)
    v_mfma_f32_32x32x16_bf16 v[16:31], v[108:111], v[156:159], v[16:31]
    ds_read_b128 v[100:103], v13 offset:256
    s_waitcnt lgkmcnt(5)
    v_mfma_f32_32x32x16_bf16 v[16:31], v[80:83], v[160:163], v[16:31]
    ds_read_b128 v[104:107], v14 offset:256
    s_waitcnt lgkmcnt(5)
    v_mfma_f32_32x32x16_bf16 v[16:31], v[84:87], v[164:167], v[16:31]
    ds_read_b128 v[108:111], v15 offset:256
    s_waitcnt lgkmcnt(5)
    v_mfma_f32_32x32x16_bf16 v[16:31], v[88:91], v[168:171], v[16:31]
    ds_read_b128 v[80:83], v8 offset:512
    s_waitcnt lgkmcnt(5)
    v_mfma_f32_32x32x16_bf16 v[16:31], v[92:95], v[172:175], v[16:31]
    ds_read_b128 v[84:87], v9 offset:512
    s_waitcnt lgkmcnt(5)
    v_mfma_f32_32x32x16_bf16 v[16:31], v[96:99], v[176:179], v[16:31]
    ds_read_b128 v[88:91], v10 offset:512
    s_waitcnt lgkmcnt(5)
    v_mfma_f32_32x32x16_bf16 v[16:31], v[100:103], v[180:183], v[16:31]
    ds_read_b128 v[92:95], v11 offset:512
    s_waitcnt lgkmcnt(5)
    v_mfma_f32_32x32x16_bf16 v[16:31], v[104:107], v[184:187], v[16:31]
    ds_read_b128 v[96:99], v12 offset:512
    s_waitcnt lgkmcnt(5)
    v_mfma_f32_32x32x16_bf16 v[16:31], v[108:111], v[188:191], v[16:31]
    ds_read_b128 v[100:103], v13 offset:512
    s_waitcnt lgkmcnt(5)
    v_mfma_f32_32x32x16_bf16 v[16:31], v[80:83], v[192:195], v[16:31]
    ds_read_b128 v[104:107], v14 offset:512
    s_waitcnt lgkmcnt(5)
    v_mfma_f32_32x32x16_bf16 v[16:31], v[84:87], v[196:199], v[16:31]
    ds_read_b128 v[108:111], v15 offset:512
    s_waitcnt lgkmcnt(5)
    v_mfma_f32_32x32x16_bf16 v[16:31], v[88:91], v[200:203], v[16:31]
    ds_read_b128 v[80:83], v8 offset:768
    s_waitcnt lgkmcnt(5)
    v_mfma_f32_32x32x16_bf16 v[16:31], v[92:95], v[204:207], v[16:31]
    ds_read_b128 v[84:87], v9 offset:768
    s_waitcnt lgkmcnt(5)
    v_mfma_f32_32x32x16_bf16 v[16:31], v[96:99], v[208:211], v[16:31]
    ds_read_b128 v[88:91], v10 offset:768
    s_waitcnt lgkmcnt(5)
    v_mfma_f32_32x32x16_bf16 v[16:31], v[100:103], v[212:215], v[16:31]
    ds_read_b128 v[92:95], v11 offset:768
    s_waitcnt lgkmcnt(5)
    v_mfma_f32_32x32x16_bf16 v[16:31], v[104:107], v[216:219], v[16:31]
    ds_read_b128 v[96:99], v12 offset:768
    s_waitcnt lgkmcnt(5)
    v_mfma_f32_32x32x16_bf16 v[16:31], v[108:111], v[220:223], v[16:31]
    ds_read_b128 v[100:103], v13 offset:768
    s_waitcnt lgkmcnt(5)
    v_mfma_f32_32x32x16_bf16 v[16:31], v[80:83], v[224:227], v[16:31]
    ds_read_b128 v[104:107], v14 offset:768
    s_waitcnt lgkmcnt(5)
    v_mfma_f32_32x32x16_bf16 v[16:31], v[84:87], v[228:231], v[16:31]
    ds_read_b128 v[108:111], v15 offset:768
    s_waitcnt lgkmcnt(5)
    v_mfma_f32_32x32x16_bf16 v[16:31], v[88:91], v[232:235], v[16:31]
    s_waitcnt lgkmcnt(4)
    v_mfma_f32_32x32x16_bf16 v[16:31], v[92:95], v[236:239], v[16:31]
    s_waitcnt lgkmcnt(3)
    v_mfma_f32_32x32x16_bf16 v[16:31], v[96:99], v[240:243], v[16:31]
    s_waitcnt lgkmcnt(2)
    v_mfma_f32_32x32x16_bf16 v[16:31], v[100:103], v[244:247], v[16:31]
    s_waitcnt lgkmcnt(1)
    v_mfma_f32_32x32x16_bf16 v[16:31], v[104:107], v[248:251], v[16:31]
    s_waitcnt lgkmcnt(0)
    v_mfma_f32_32x32x16_bf16 v[16:31], v[108:111], v[252:255], v[16:31]
    ds_read_b128 v[80:83], v8 offset:32768
    ds_read_b128 v[84:87], v9 offset:32768
    ds_read_b128 v[88:91], v10 offset:32768
    ds_read_b128 v[92:95], v11 offset:32768
    ds_read_b128 v[96:99], v12 offset:32768
    ds_read_b128 v[100:103], v13 offset:32768
    s_waitcnt lgkmcnt(5)
    v_mfma_f32_32x32x16_bf16 v[32:47], v[80:83], v[128:131], 0
    ds_read_b128 v[104:107], v14 offset:32768
    s_waitcnt lgkmcnt(5)
    v_mfma_f32_32x32x16_bf16 v[32:47], v[84:87], v[132:135], v[32:47]
    ds_read_b128 v[108:111], v15 offset:32768
    s_waitcnt lgkmcnt(5)
    v_mfma_f32_32x32x16_bf16 v[32:47], v[88:91], v[136:139], v[32:47]
    ds_read_b128 v[80:83], v8 offset:33024
    s_waitcnt lgkmcnt(5)
    v_mfma_f32_32x32x16_bf16 v[32:47], v[92:95], v[140:143], v[32:47]
    ds_read_b128 v[84:87], v9 offset:33024
    s_waitcnt lgkmcnt(5)
    v_mfma_f32_32x32x16_bf16 v[32:47], v[96:99], v[144:147], v[32:47]
    ds_read_b128 v[88:91], v10 offset:33024
    s_waitcnt lgkmcnt(5)
    v_mfma_f32_32x32x16_bf16 v[32:47], v[100:103], v[148:151], v[32:47]
    ds_read_b128 v[92:95], v11 offset:33024
    s_waitcnt lgkmcnt(5)
    v_mfma_f32_32x32x16_bf16 v[32:47], v[104:107], v[152:155], v[32:47]
    ds_read_b128 v[96:99], v12 offset:33024
    s_waitcnt lgkmcnt(5)
    v_mfma_f32_32x32x16_bf16 v[32:47], v[108:111], v[156:159], v[32:47]
    ds_read_b128 v[100:103], v13 offset:33024
    s_waitcnt lgkmcnt(5)
    v_mfma_f32_32x32x16_bf16 v[32:47], v[80:83], v[160:163], v[32:47]
    ds_read_b128 v[104:107], v14 offset:33024
    s_waitcnt lgkmcnt(5)
    v_mfma_f32_32x32x16_bf16 v[32:47], v[84:87], v[164:167], v[32:47]
    ds_read_b128 v[108:111], v15 offset:33024
    s_waitcnt lgkmcnt(5)
    v_mfma_f32_32x32x16_bf16 v[32:47], v[88:91], v[168:171], v[32:47]
    ds_read_b128 v[80:83], v8 offset:33280
    s_waitcnt lgkmcnt(5)
    v_mfma_f32_32x32x16_bf16 v[32:47], v[92:95], v[172:175], v[32:47]
    ds_read_b128 v[84:87], v9 offset:33280
    s_waitcnt lgkmcnt(5)
    v_mfma_f32_32x32x16_bf16 v[32:47], v[96:99], v[176:179], v[32:47]
    ds_read_b128 v[88:91], v10 offset:33280
    s_waitcnt lgkmcnt(5)
    v_mfma_f32_32x32x16_bf16 v[32:47], v[100:103], v[180:183], v[32:47]
    ds_read_b128 v[92:95], v11 offset:33280
    s_waitcnt lgkmcnt(5)
    v_mfma_f32_32x32x16_bf16 v[32:47], v[104:107], v[184:187], v[32:47]
    ds_read_b128 v[96:99], v12 offset:33280
    s_waitcnt lgkmcnt(5)
    v_mfma_f32_32x32x16_bf16 v[32:47], v[108:111], v[188:191], v[32:47]
    ds_read_b128 v[100:103], v13 offset:33280
    s_waitcnt lgkmcnt(5)
    v_mfma_f32_32x32x16_bf16 v[32:47], v[80:83], v[192:195], v[32:47]
    ds_read_b128 v[104:107], v14 offset:33280
    s_waitcnt lgkmcnt(5)
    v_mfma_f32_32x32x16_bf16 v[32:47], v[84:87], v[196:199], v[32:47]
    ds_read_b128 v[108:111], v15 offset:33280
    s_waitcnt lgkmcnt(5)
    v_mfma_f32_32x32x16_bf16 v[32:47], v[88:91], v[200:203], v[32:47]
    ds_read_b128 v[80:83], v8 offset:33536
    s_waitcnt lgkmcnt(5)
    v_mfma_f32_32x32x16_bf16 v[32:47], v[92:95], v[204:207], v[32:47]
    ds_read_b128 v[84:87], v9 offset:33536
    s_waitcnt lgkmcnt(5)
    v_mfma_f32_32x32x16_bf16 v[32:47], v[96:99], v[208:211], v[32:47]
    ds_read_b128 v[88:91], v10 offset:33536
    s_waitcnt lgkmcnt(5)
    v_mfma_f32_32x32x16_bf16 v[32:47], v[100:103], v[212:215], v[32:47]
    ds_read_b128 v[92:95], v11 offset:33536
    s_waitcnt lgkmcnt(5)
    v_mfma_f32_32x32x16_bf16 v[32:47], v[104:107], v[216:219], v[32:47]
    ds_read_b128 v[96:99], v12 offset:33536
    s_waitcnt lgkmcnt(5)
    v_mfma_f32_32x32x16_bf16 v[32:47], v[108:111], v[220:223], v[32:47]
    ds_read_b128 v[100:103], v13 offset:33536
    s_waitcnt lgkmcnt(5)
    v_mfma_f32_32x32x16_bf16 v[32:47], v[80:83], v[224:227], v[32:47]
    ds_read_b128 v[104:107], v14 offset:33536
    s_waitcnt lgkmcnt(5)
    v_mfma_f32_32x32x16_bf16 v[32:47], v[84:87], v[228:231], v[32:47]
    ds_read_b128 v[108:111], v15 offset:33536
    s_waitcnt lgkmcnt(5)
    v_mfma_f32_32x32x16_bf16 v[32:47], v[88:91], v[232:235], v[32:47]
    s_waitcnt lgkmcnt(4)
    v_mfma_f32_32x32x16_bf16 v[32:47], v[92:95], v[236:239], v[32:47]
    s_waitcnt lgkmcnt(3)
    v_mfma_f32_32x32x16_bf16 v[32:47], v[96:99], v[240:243], v[32:47]
    s_waitcnt lgkmcnt(2)
    v_mfma_f32_32x32x16_bf16 v[32:47], v[100:103], v[244:247], v[32:47]
    s_waitcnt lgkmcnt(1)
    v_mfma_f32_32x32x16_bf16 v[32:47], v[104:107], v[248:251], v[32:47]
    s_waitcnt lgkmcnt(0)
    v_mfma_f32_32x32x16_bf16 v[32:47], v[108:111], v[252:255], v[32:47]
    v_add_u32 v8, 0x10000, v8
    v_add_u32 v9, 0x10000, v9
    v_add_u32 v10, 0x10000, v10
    v_add_u32 v11, 0x10000, v11
    v_add_u32 v12, 0x10000, v12
    v_add_u32 v13, 0x10000, v13
    v_add_u32 v14, 0x10000, v14
    v_add_u32 v15, 0x10000, v15
    ds_read_b128 v[80:83], v8 offset:0
    ds_read_b128 v[84:87], v9 offset:0
    ds_read_b128 v[88:91], v10 offset:0
    ds_read_b128 v[92:95], v11 offset:0
    ds_read_b128 v[96:99], v12 offset:0
    ds_read_b128 v[100:103], v13 offset:0
    s_waitcnt lgkmcnt(5)
    v_mfma_f32_32x32x16_bf16 v[48:63], v[80:83], v[128:131], 0
    ds_read_b128 v[104:107], v14 offset:0
    s_waitcnt lgkmcnt(5)
    v_mfma_f32_32x32x16_bf16 v[48:63], v[84:87], v[132:135], v[48:63]
    ds_read_b128 v[108:111], v15 offset:0
    s_waitcnt lgkmcnt(5)
    v_mfma_f32_32x32x16_bf16 v[48:63], v[88:91], v[136:139], v[48:63]
    ds_read_b128 v[80:83], v8 offset:256
    s_waitcnt lgkmcnt(5)
    v_mfma_f32_32x32x16_bf16 v[48:63], v[92:95], v[140:143], v[48:63]
    ds_read_b128 v[84:87], v9 offset:256
    s_waitcnt lgkmcnt(5)
    v_mfma_f32_32x32x16_bf16 v[48:63], v[96:99], v[144:147], v[48:63]
    ds_read_b128 v[88:91], v10 offset:256
    s_waitcnt lgkmcnt(5)
    v_mfma_f32_32x32x16_bf16 v[48:63], v[100:103], v[148:151], v[48:63]
    ds_read_b128 v[92:95], v11 offset:256
    s_waitcnt lgkmcnt(5)
    v_mfma_f32_32x32x16_bf16 v[48:63], v[104:107], v[152:155], v[48:63]
    ds_read_b128 v[96:99], v12 offset:256
    s_waitcnt lgkmcnt(5)
    v_mfma_f32_32x32x16_bf16 v[48:63], v[108:111], v[156:159], v[48:63]
    ds_read_b128 v[100:103], v13 offset:256
    s_waitcnt lgkmcnt(5)
    v_mfma_f32_32x32x16_bf16 v[48:63], v[80:83], v[160:163], v[48:63]
    ds_read_b128 v[104:107], v14 offset:256
    s_waitcnt lgkmcnt(5)
    v_mfma_f32_32x32x16_bf16 v[48:63], v[84:87], v[164:167], v[48:63]
    ds_read_b128 v[108:111], v15 offset:256
    s_waitcnt lgkmcnt(5)
    v_mfma_f32_32x32x16_bf16 v[48:63], v[88:91], v[168:171], v[48:63]
    ds_read_b128 v[80:83], v8 offset:512
    s_waitcnt lgkmcnt(5)
    v_mfma_f32_32x32x16_bf16 v[48:63], v[92:95], v[172:175], v[48:63]
    ds_read_b128 v[84:87], v9 offset:512
    s_waitcnt lgkmcnt(5)
    v_mfma_f32_32x32x16_bf16 v[48:63], v[96:99], v[176:179], v[48:63]
    ds_read_b128 v[88:91], v10 offset:512
    s_waitcnt lgkmcnt(5)
    v_mfma_f32_32x32x16_bf16 v[48:63], v[100:103], v[180:183], v[48:63]
    ds_read_b128 v[92:95], v11 offset:512
    s_waitcnt lgkmcnt(5)
    v_mfma_f32_32x32x16_bf16 v[48:63], v[104:107], v[184:187], v[48:63]
    ds_read_b128 v[96:99], v12 offset:512
    s_waitcnt lgkmcnt(5)
    v_mfma_f32_32x32x16_bf16 v[48:63], v[108:111], v[188:191], v[48:63]
    ds_read_b128 v[100:103], v13 offset:512
    s_waitcnt lgkmcnt(5)
    v_mfma_f32_32x32x16_bf16 v[48:63], v[80:83], v[192:195], v[48:63]
    ds_read_b128 v[104:107], v14 offset:512
    s_waitcnt lgkmcnt(5)
    v_mfma_f32_32x32x16_bf16 v[48:63], v[84:87], v[196:199], v[48:63]
    ds_read_b128 v[108:111], v15 offset:512
    s_waitcnt lgkmcnt(5)
    v_mfma_f32_32x32x16_bf16 v[48:63], v[88:91], v[200:203], v[48:63]
    ds_read_b128 v[80:83], v8 offset:768
    s_waitcnt lgkmcnt(5)
    v_mfma_f32_32x32x16_bf16 v[48:63], v[92:95], v[204:207], v[48:63]
    ds_read_b128 v[84:87], v9 offset:768
    s_waitcnt lgkmcnt(5)
    v_mfma_f32_32x32x16_bf16 v[48:63], v[96:99], v[208:211], v[48:63]
    ds_read_b128 v[88:91], v10 offset:768
    s_waitcnt lgkmcnt(5)
    v_mfma_f32_32x32x16_bf16 v[48:63], v[100:103], v[212:215], v[48:63]
    ds_read_b128 v[92:95], v11 offset:768
    s_waitcnt lgkmcnt(5)
    v_mfma_f32_32x32x16_bf16 v[48:63], v[104:107], v[216:219], v[48:63]
    ds_read_b128 v[96:99], v12 offset:768
    s_waitcnt lgkmcnt(5)
    v_mfma_f32_32x32x16_bf16 v[48:63], v[108:111], v[220:223], v[48:63]
    ds_read_b128 v[100:103], v13 offset:768
    s_waitcnt lgkmcnt(5)
    v_mfma_f32_32x32x16_bf16 v[48:63], v[80:83], v[224:227], v[48:63]
    ds_read_b128 v[104:107], v14 offset:768
    s_waitcnt lgkmcnt(5)
    v_mfma_f32_32x32x16_bf16 v[48:63], v[84:87], v[228:231], v[48:63]
    ds_read_b128 v[108:111], v15 offset:768
    s_waitcnt lgkmcnt(5)
    v_mfma_f32_32x32x16_bf16 v[48:63], v[88:91], v[232:235], v[48:63]
    s_waitcnt lgkmcnt(4)
    v_mfma_f32_32x32x16_bf16 v[48:63], v[92:95], v[236:239], v[48:63]
    s_waitcnt lgkmcnt(3)
    v_mfma_f32_32x32x16_bf16 v[48:63], v[96:99], v[240:243], v[48:63]
    s_waitcnt lgkmcnt(2)
    v_mfma_f32_32x32x16_bf16 v[48:63], v[100:103], v[244:247], v[48:63]
    s_waitcnt lgkmcnt(1)
    v_mfma_f32_32x32x16_bf16 v[48:63], v[104:107], v[248:251], v[48:63]
    s_waitcnt lgkmcnt(0)
    v_mfma_f32_32x32x16_bf16 v[48:63], v[108:111], v[252:255], v[48:63]
    ds_read_b128 v[80:83], v8 offset:32768
    ds_read_b128 v[84:87], v9 offset:32768
    ds_read_b128 v[88:91], v10 offset:32768
    ds_read_b128 v[92:95], v11 offset:32768
    ds_read_b128 v[96:99], v12 offset:32768
    ds_read_b128 v[100:103], v13 offset:32768
    s_waitcnt lgkmcnt(5)
    v_mfma_f32_32x32x16_bf16 v[64:79], v[80:83], v[128:131], 0
    ds_read_b128 v[104:107], v14 offset:32768
    s_waitcnt lgkmcnt(5)
    v_mfma_f32_32x32x16_bf16 v[64:79], v[84:87], v[132:135], v[64:79]
    ds_read_b128 v[108:111], v15 offset:32768
    s_waitcnt lgkmcnt(5)
    v_mfma_f32_32x32x16_bf16 v[64:79], v[88:91], v[136:139], v[64:79]
    ds_read_b128 v[80:83], v8 offset:33024
    s_waitcnt lgkmcnt(5)
    v_mfma_f32_32x32x16_bf16 v[64:79], v[92:95], v[140:143], v[64:79]
    ds_read_b128 v[84:87], v9 offset:33024
    s_waitcnt lgkmcnt(5)
    v_mfma_f32_32x32x16_bf16 v[64:79], v[96:99], v[144:147], v[64:79]
    ds_read_b128 v[88:91], v10 offset:33024
    s_waitcnt lgkmcnt(5)
    v_mfma_f32_32x32x16_bf16 v[64:79], v[100:103], v[148:151], v[64:79]
    ds_read_b128 v[92:95], v11 offset:33024
    s_waitcnt lgkmcnt(5)
    v_mfma_f32_32x32x16_bf16 v[64:79], v[104:107], v[152:155], v[64:79]
    ds_read_b128 v[96:99], v12 offset:33024
    s_waitcnt lgkmcnt(5)
    v_mfma_f32_32x32x16_bf16 v[64:79], v[108:111], v[156:159], v[64:79]
    ds_read_b128 v[100:103], v13 offset:33024
    s_waitcnt lgkmcnt(5)
    v_mfma_f32_32x32x16_bf16 v[64:79], v[80:83], v[160:163], v[64:79]
    ds_read_b128 v[104:107], v14 offset:33024
    s_waitcnt lgkmcnt(5)
    v_mfma_f32_32x32x16_bf16 v[64:79], v[84:87], v[164:167], v[64:79]
    ds_read_b128 v[108:111], v15 offset:33024
    s_waitcnt lgkmcnt(5)
    v_mfma_f32_32x32x16_bf16 v[64:79], v[88:91], v[168:171], v[64:79]
    ds_read_b128 v[80:83], v8 offset:33280
    s_waitcnt lgkmcnt(5)
    v_mfma_f32_32x32x16_bf16 v[64:79], v[92:95], v[172:175], v[64:79]
    ds_read_b128 v[84:87], v9 offset:33280
    s_waitcnt lgkmcnt(5)
    v_mfma_f32_32x32x16_bf16 v[64:79], v[96:99], v[176:179], v[64:79]
    ds_read_b128 v[88:91], v10 offset:33280
    s_waitcnt lgkmcnt(5)
    v_mfma_f32_32x32x16_bf16 v[64:79], v[100:103], v[180:183], v[64:79]
    ds_read_b128 v[92:95], v11 offset:33280
    s_waitcnt lgkmcnt(5)
    v_mfma_f32_32x32x16_bf16 v[64:79], v[104:107], v[184:187], v[64:79]
    ds_read_b128 v[96:99], v12 offset:33280
    s_waitcnt lgkmcnt(5)
    v_mfma_f32_32x32x16_bf16 v[64:79], v[108:111], v[188:191], v[64:79]
    ds_read_b128 v[100:103], v13 offset:33280
    s_waitcnt lgkmcnt(5)
    v_mfma_f32_32x32x16_bf16 v[64:79], v[80:83], v[192:195], v[64:79]
    ds_read_b128 v[104:107], v14 offset:33280
    s_waitcnt lgkmcnt(5)
    v_mfma_f32_32x32x16_bf16 v[64:79], v[84:87], v[196:199], v[64:79]
    ds_read_b128 v[108:111], v15 offset:33280
    s_waitcnt lgkmcnt(5)
    v_mfma_f32_32x32x16_bf16 v[64:79], v[88:91], v[200:203], v[64:79]
    ds_read_b128 v[80:83], v8 offset:33536
    s_waitcnt lgkmcnt(5)
    v_mfma_f32_32x32x16_bf16 v[64:79], v[92:95], v[204:207], v[64:79]
    ds_read_b128 v[84:87], v9 offset:33536
    s_waitcnt lgkmcnt(5)
    v_mfma_f32_32x32x16_bf16 v[64:79], v[96:99], v[208:211], v[64:79]
    ds_read_b128 v[88:91], v10 offset:33536
    s_waitcnt lgkmcnt(5)
    v_mfma_f32_32x32x16_bf16 v[64:79], v[100:103], v[212:215], v[64:79]
    ds_read_b128 v[92:95], v11 offset:33536
    s_waitcnt lgkmcnt(5)
    v_mfma_f32_32x32x16_bf16 v[64:79], v[104:107], v[216:219], v[64:79]
    ds_read_b128 v[96:99], v12 offset:33536
    s_waitcnt lgkmcnt(5)
    v_mfma_f32_32x32x16_bf16 v[64:79], v[108:111], v[220:223], v[64:79]
    ds_read_b128 v[100:103], v13 offset:33536
    s_waitcnt lgkmcnt(5)
    v_mfma_f32_32x32x16_bf16 v[64:79], v[80:83], v[224:227], v[64:79]
    ds_read_b128 v[104:107], v14 offset:33536
    s_waitcnt lgkmcnt(5)
    v_mfma_f32_32x32x16_bf16 v[64:79], v[84:87], v[228:231], v[64:79]
    ds_read_b128 v[108:111], v15 offset:33536
    s_waitcnt lgkmcnt(5)
    v_mfma_f32_32x32x16_bf16 v[64:79], v[88:91], v[232:235], v[64:79]
    s_waitcnt lgkmcnt(4)
    v_mfma_f32_32x32x16_bf16 v[64:79], v[92:95], v[236:239], v[64:79]
    s_waitcnt lgkmcnt(3)
    v_mfma_f32_32x32x16_bf16 v[64:79], v[96:99], v[240:243], v[64:79]
    s_waitcnt lgkmcnt(2)
    v_mfma_f32_32x32x16_bf16 v[64:79], v[100:103], v[244:247], v[64:79]
    s_waitcnt lgkmcnt(1)
    v_mfma_f32_32x32x16_bf16 v[64:79], v[104:107], v[248:251], v[64:79]
    s_waitcnt lgkmcnt(0)
    v_mfma_f32_32x32x16_bf16 v[64:79], v[108:111], v[252:255], v[64:79]
    s_barrier
    s_lshl_b32 s51, s44, 13
    v_and_b32 v112, 31, v2
    v_lshrrev_b32 v113, 5, v2
    v_lshlrev_b32 v112, 8, v112
    v_lshl_add_u32 v112, v113, 6, v112
    v_add_u32 v112, s51, v112
    v_lshlrev_b32 v113, 4, v2
    v_add_u32 v113, s51, v113
    v_lshrrev_b32 v3, 2, v2
    v_lshlrev_b32 v3, 10, v3
    v_and_b32 v114, 3, v2
    v_lshl_add_u32 v3, v114, 4, v3
    s_and_b32 s51, s48, 3
    s_lshl_b32 s51, s51, 2
    s_add_u32 s51, s51, s44
    s_lshl_b32 s51, s51, 17
    s_add_u32 s53, s53, s51
    v_cvt_pk_bf16_f32 v80, v16, v17
    v_cvt_pk_bf16_f32 v81, v18, v19
    v_cvt_pk_bf16_f32 v82, v20, v21
    v_cvt_pk_bf16_f32 v83, v22, v23
    v_cvt_pk_bf16_f32 v84, v24, v25
    v_cvt_pk_bf16_f32 v85, v26, v27
    v_cvt_pk_bf16_f32 v86, v28, v29
    v_cvt_pk_bf16_f32 v87, v30, v31
    ds_write_b128 v112, v[80:83] offset:0
    ds_write_b128 v112, v[84:87] offset:128
    v_cvt_pk_bf16_f32 v88, v32, v33
    v_cvt_pk_bf16_f32 v89, v34, v35
    v_cvt_pk_bf16_f32 v90, v36, v37
    v_cvt_pk_bf16_f32 v91, v38, v39
    v_cvt_pk_bf16_f32 v92, v40, v41
    v_cvt_pk_bf16_f32 v93, v42, v43
    v_cvt_pk_bf16_f32 v94, v44, v45
    v_cvt_pk_bf16_f32 v95, v46, v47
    ds_write_b128 v112, v[88:91] offset:16
    ds_write_b128 v112, v[92:95] offset:144
    v_cvt_pk_bf16_f32 v96, v48, v49
    v_cvt_pk_bf16_f32 v97, v50, v51
    v_cvt_pk_bf16_f32 v98, v52, v53
    v_cvt_pk_bf16_f32 v99, v54, v55
    v_cvt_pk_bf16_f32 v100, v56, v57
    v_cvt_pk_bf16_f32 v101, v58, v59
    v_cvt_pk_bf16_f32 v102, v60, v61
    v_cvt_pk_bf16_f32 v103, v62, v63
    ds_write_b128 v112, v[96:99] offset:32
    ds_write_b128 v112, v[100:103] offset:160
    v_cvt_pk_bf16_f32 v104, v64, v65
    v_cvt_pk_bf16_f32 v105, v66, v67
    v_cvt_pk_bf16_f32 v106, v68, v69
    v_cvt_pk_bf16_f32 v107, v70, v71
    v_cvt_pk_bf16_f32 v108, v72, v73
    v_cvt_pk_bf16_f32 v109, v74, v75
    v_cvt_pk_bf16_f32 v110, v76, v77
    v_cvt_pk_bf16_f32 v111, v78, v79
    ds_write_b128 v112, v[104:107] offset:48
    ds_write_b128 v112, v[108:111] offset:176
    s_waitcnt lgkmcnt(0)
    ds_read_b128 v[16:19], v113 offset:0
    ds_read_b128 v[20:23], v113 offset:1024
    ds_read_b128 v[24:27], v113 offset:2048
    ds_read_b128 v[28:31], v113 offset:3072
    ds_read_b128 v[32:35], v113 offset:4096
    ds_read_b128 v[36:39], v113 offset:5120
    ds_read_b128 v[40:43], v113 offset:6144
    ds_read_b128 v[44:47], v113 offset:7168
    s_waitcnt lgkmcnt(7)
    buffer_store_dwordx4 v[16:19], v3, s[36:39], s53 offen sc1
    s_add_u32 s53, s53, 16384
    s_waitcnt lgkmcnt(6)
    buffer_store_dwordx4 v[20:23], v3, s[36:39], s53 offen sc1
    s_add_u32 s53, s53, 16384
    s_waitcnt lgkmcnt(5)
    buffer_store_dwordx4 v[24:27], v3, s[36:39], s53 offen sc1
    s_add_u32 s53, s53, 16384
    s_waitcnt lgkmcnt(4)
    buffer_store_dwordx4 v[28:31], v3, s[36:39], s53 offen sc1
    s_add_u32 s53, s53, 16384
    s_waitcnt lgkmcnt(3)
    buffer_store_dwordx4 v[32:35], v3, s[36:39], s53 offen sc1
    s_add_u32 s53, s53, 16384
    s_waitcnt lgkmcnt(2)
    buffer_store_dwordx4 v[36:39], v3, s[36:39], s53 offen sc1
    s_add_u32 s53, s53, 16384
    s_waitcnt lgkmcnt(1)
    buffer_store_dwordx4 v[40:43], v3, s[36:39], s53 offen sc1
    s_add_u32 s53, s53, 16384
    s_waitcnt lgkmcnt(0)
    buffer_store_dwordx4 v[44:47], v3, s[36:39], s53 offen sc1
    s_add_u32 s53, s53, 16384
    s_waitcnt vmcnt(8)
    s_lshl_b32 s51, s44, 12
    s_add_u32 s51, s51, 131072
    v_lshlrev_b32 v4, 3, v2
    v_add_u32 v4, s51, v4
    ds_write_b64 v4, a[64:65] offset:0
    ds_write_b64 v4, a[66:67] offset:16384
    ds_write_b64 v4, a[68:69] offset:512
    ds_write_b64 v4, a[70:71] offset:16896
    ds_write_b64 v4, a[72:73] offset:1024
    ds_write_b64 v4, a[74:75] offset:17408
    ds_write_b64 v4, a[76:77] offset:1536
    ds_write_b64 v4, a[78:79] offset:17920
    ds_write_b64 v4, a[80:81] offset:2048
    ds_write_b64 v4, a[82:83] offset:18432
    ds_write_b64 v4, a[84:85] offset:2560
    ds_write_b64 v4, a[86:87] offset:18944
    ds_write_b64 v4, a[88:89] offset:3072
    ds_write_b64 v4, a[90:91] offset:19456
    ds_write_b64 v4, a[92:93] offset:3584
    ds_write_b64 v4, a[94:95] offset:19968
    s_waitcnt lgkmcnt(0)
    s_waitcnt vmcnt(0)
    s_barrier
    s_cmp_lg_u32 s44, 0
    s_cbranch_scc1 PA_ARR_1
    v_mov_b32 v112, 1
    v_mov_b32 v113, 12
    s_mov_b64 exec, 1
    global_atomic_add v113, v112, s[30:31]
    s_mov_b64 exec, -1
PA_ARR_1:
PA2:
    s_sub_u32 s51, s49, s57
    s_lshl_b32 s51, s51, 1
    s_add_u32 s51, s51, 131072
    v_lshlrev_b32 v4, 3, v2
    v_add_u32 v4, s51, v4
    v_accvgpr_write_b32 a0, 0
    v_accvgpr_write_b32 a1, 0
    v_accvgpr_write_b32 a2, 0
    v_accvgpr_write_b32 a3, 0
    v_accvgpr_write_b32 a4, 0
    v_accvgpr_write_b32 a5, 0
    v_accvgpr_write_b32 a6, 0
    v_accvgpr_write_b32 a7, 0
    v_accvgpr_write_b32 a8, 0
    v_accvgpr_write_b32 a9, 0
    v_accvgpr_write_b32 a10, 0
    v_accvgpr_write_b32 a11, 0
    v_accvgpr_write_b32 a12, 0
    v_accvgpr_write_b32 a13, 0
    v_accvgpr_write_b32 a14, 0
    v_accvgpr_write_b32 a15, 0
    v_accvgpr_write_b32 a16, 0
    v_accvgpr_write_b32 a17, 0
    v_accvgpr_write_b32 a18, 0
    v_accvgpr_write_b32 a19, 0
    v_accvgpr_write_b32 a20, 0
    v_accvgpr_write_b32 a21, 0
    v_accvgpr_write_b32 a22, 0
    v_accvgpr_write_b32 a23, 0
    v_accvgpr_write_b32 a24, 0
    v_accvgpr_write_b32 a25, 0
    v_accvgpr_write_b32 a26, 0
    v_accvgpr_write_b32 a27, 0
    v_accvgpr_write_b32 a28, 0
    v_accvgpr_write_b32 a29, 0
    v_accvgpr_write_b32 a30, 0
    v_accvgpr_write_b32 a31, 0
    v_accvgpr_write_b32 a32, 0
    v_accvgpr_write_b32 a33, 0
    v_accvgpr_write_b32 a34, 0
    v_accvgpr_write_b32 a35, 0
    v_accvgpr_write_b32 a36, 0
    v_accvgpr_write_b32 a37, 0
    v_accvgpr_write_b32 a38, 0
    v_accvgpr_write_b32 a39, 0
    v_accvgpr_write_b32 a40, 0
    v_accvgpr_write_b32 a41, 0
    v_accvgpr_write_b32 a42, 0
    v_accvgpr_write_b32 a43, 0
    v_accvgpr_write_b32 a44, 0
    v_accvgpr_write_b32 a45, 0
    v_accvgpr_write_b32 a46, 0
    v_accvgpr_write_b32 a47, 0
    v_accvgpr_write_b32 a48, 0
    v_accvgpr_write_b32 a49, 0
    v_accvgpr_write_b32 a50, 0
    v_accvgpr_write_b32 a51, 0
    v_accvgpr_write_b32 a52, 0
    v_accvgpr_write_b32 a53, 0
    v_accvgpr_write_b32 a54, 0
    v_accvgpr_write_b32 a55, 0
    v_accvgpr_write_b32 a56, 0
    v_accvgpr_write_b32 a57, 0
    v_accvgpr_write_b32 a58, 0
    v_accvgpr_write_b32 a59, 0
    v_accvgpr_write_b32 a60, 0
    v_accvgpr_write_b32 a61, 0
    v_accvgpr_write_b32 a62, 0
    v_accvgpr_write_b32 a63, 0
    ds_read_u16_d16_hi a0, v4 offset:0
    ds_read_u16_d16_hi a1, v4 offset:512
    ds_read_u16_d16_hi a2, v4 offset:1024
    ds_read_u16_d16_hi a3, v4 offset:1536
    ds_read_u16_d16_hi a4, v4 offset:2048
    ds_read_u16_d16_hi a5, v4 offset:2560
    ds_read_u16_d16_hi a6, v4 offset:3072
    ds_read_u16_d16_hi a7, v4 offset:3584
    ds_read_u16_d16_hi a8, v4 offset:4096
    ds_read_u16_d16_hi a9, v4 offset:4608
    ds_read_u16_d16_hi a10, v4 offset:5120
    ds_read_u16_d16_hi a11, v4 offset:5632
    ds_read_u16_d16_hi a12, v4 offset:6144
    ds_read_u16_d16_hi a13, v4 offset:6656
    ds_read_u16_d16_hi a14, v4 offset:7168
    ds_read_u16_d16_hi a15, v4 offset:7680
    ds_read_u16_d16_hi a16, v4 offset:8192
    ds_read_u16_d16_hi a17, v4 offset:8704
    ds_read_u16_d16_hi a18, v4 offset:9216
    ds_read_u16_d16_hi a19, v4 offset:9728
    ds_read_u16_d16_hi a20, v4 offset:10240
    ds_read_u16_d16_hi a21, v4 offset:10752
    ds_read_u16_d16_hi a22, v4 offset:11264
    ds_read_u16_d16_hi a23, v4 offset:11776
    ds_read_u16_d16_hi a24, v4 offset:12288
    ds_read_u16_d16_hi a25, v4 offset:12800
    ds_read_u16_d16_hi a26, v4 offset:13312
    ds_read_u16_d16_hi a27, v4 offset:13824
    ds_read_u16_d16_hi a28, v4 offset:14336
    ds_read_u16_d16_hi a29, v4 offset:14848
    ds_read_u16_d16_hi a30, v4 offset:15360
    ds_read_u16_d16_hi a31, v4 offset:15872
    ds_read_u16_d16_hi a32, v4 offset:16384
    ds_read_u16_d16_hi a33, v4 offset:16896
    ds_read_u16_d16_hi a34, v4 offset:17408
    ds_read_u16_d16_hi a35, v4 offset:17920
    ds_read_u16_d16_hi a36, v4 offset:18432
    ds_read_u16_d16_hi a37, v4 offset:18944
    ds_read_u16_d16_hi a38, v4 offset:19456
    ds_read_u16_d16_hi a39, v4 offset:19968
    ds_read_u16_d16_hi a40, v4 offset:20480
    ds_read_u16_d16_hi a41, v4 offset:20992
    ds_read_u16_d16_hi a42, v4 offset:21504
    ds_read_u16_d16_hi a43, v4 offset:22016
    ds_read_u16_d16_hi a44, v4 offset:22528
    ds_read_u16_d16_hi a45, v4 offset:23040
    ds_read_u16_d16_hi a46, v4 offset:23552
    ds_read_u16_d16_hi a47, v4 offset:24064
    ds_read_u16_d16_hi a48, v4 offset:24576
    ds_read_u16_d16_hi a49, v4 offset:25088
    ds_read_u16_d16_hi a50, v4 offset:25600
    ds_read_u16_d16_hi a51, v4 offset:26112
    ds_read_u16_d16_hi a52, v4 offset:26624
    ds_read_u16_d16_hi a53, v4 offset:27136
    ds_read_u16_d16_hi a54, v4 offset:27648
    ds_read_u16_d16_hi a55, v4 offset:28160
    ds_read_u16_d16_hi a56, v4 offset:28672
    ds_read_u16_d16_hi a57, v4 offset:29184
    ds_read_u16_d16_hi a58, v4 offset:29696
    ds_read_u16_d16_hi a59, v4 offset:30208
    ds_read_u16_d16_hi a60, v4 offset:30720
    ds_read_u16_d16_hi a61, v4 offset:31232
    ds_read_u16_d16_hi a62, v4 offset:31744
    ds_read_u16_d16_hi a63, v4 offset:32256
    s_waitcnt lgkmcnt(0)
    v_and_b32 v4, 31, v2
    v_lshrrev_b32 v5, 5, v2
    v_lshlrev_b32 v7, 4, v4
    v_lshl_add_u32 v7, v5, 10, v7
    v_lshlrev_b32 v3, 4, v2
    s_lshl_b32 s50, s49, 13
    s_mov_b32 s56, 0x36000000
    s_mov_b32 s55, 4096
    s_and_b32 s51, s49, 255
    s_cmp_eq_u32 s51, 0
    s_cselect_b32 s56, 0x35800000, s56
    s_cselect_b32 s55, 0x40000000, s55
    s_cmp_eq_u32 s49, 256
    s_cselect_b32 s50, 4096, s50
    v_add_u32 v8, s55, v7
    v_add_u32 v9, s55, v3
    v_lshrrev_b32 v113, 5, v2
    v_lshlrev_b32 v113, 2, v113
    v_cvt_f32_u32 v113, v113
    v_and_b32 v112, 31, v2
    v_cvt_f32_u32 v112, v112
    v_mul_f32 v112, 0x3d000000, v112
    v_add_f32 v114, 0x00000000, v113
    v_mul_f32 v114, v114, v112
    v_fract_f32 v114, v114
    v_cos_f32 v116, v114
    v_sin_f32 v118, v114
    v_add_f32 v114, 0x3f800000, v113
    v_mul_f32 v114, v114, v112
    v_fract_f32 v114, v114
    v_cos_f32 v117, v114
    v_sin_f32 v119, v114
    v_cvt_pk_bf16_f32 v128, v116, v117
    v_cvt_pk_bf16_f32 v136, v118, v119
    v_xor_b32 v144, 0x80008000, v136
    v_add_f32 v114, 0x40000000, v113
    v_mul_f32 v114, v114, v112
    v_fract_f32 v114, v114
    v_cos_f32 v116, v114
    v_sin_f32 v118, v114
    v_add_f32 v114, 0x40400000, v113
    v_mul_f32 v114, v114, v112
    v_fract_f32 v114, v114
    v_cos_f32 v117, v114
    v_sin_f32 v119, v114
    v_cvt_pk_bf16_f32 v129, v116, v117
    v_cvt_pk_bf16_f32 v137, v118, v119
    v_xor_b32 v145, 0x80008000, v137
    v_add_f32 v114, 0x41000000, v113
    v_mul_f32 v114, v114, v112
    v_fract_f32 v114, v114
    v_cos_f32 v116, v114
    v_sin_f32 v118, v114
    v_add_f32 v114, 0x41100000, v113
    v_mul_f32 v114, v114, v112
    v_fract_f32 v114, v114
    v_cos_f32 v117, v114
    v_sin_f32 v119, v114
    v_cvt_pk_bf16_f32 v130, v116, v117
    v_cvt_pk_bf16_f32 v138, v118, v119
    v_xor_b32 v146, 0x80008000, v138
    v_add_f32 v114, 0x41200000, v113
    v_mul_f32 v114, v114, v112
    v_fract_f32 v114, v114
    v_cos_f32 v116, v114
    v_sin_f32 v118, v114
    v_add_f32 v114, 0x41300000, v113
    v_mul_f32 v114, v114, v112
    v_fract_f32 v114, v114
    v_cos_f32 v117, v114
    v_sin_f32 v119, v114
    v_cvt_pk_bf16_f32 v131, v116, v117
    v_cvt_pk_bf16_f32 v139, v118, v119
    v_xor_b32 v147, 0x80008000, v139
    v_add_f32 v114, 0x41800000, v113
    v_mul_f32 v114, v114, v112
    v_fract_f32 v114, v114
    v_cos_f32 v116, v114
    v_sin_f32 v118, v114
    v_add_f32 v114, 0x41880000, v113
    v_mul_f32 v114, v114, v112
    v_fract_f32 v114, v114
    v_cos_f32 v117, v114
    v_sin_f32 v119, v114
    v_cvt_pk_bf16_f32 v132, v116, v117
    v_cvt_pk_bf16_f32 v140, v118, v119
    v_xor_b32 v148, 0x80008000, v140
    v_add_f32 v114, 0x41900000, v113
    v_mul_f32 v114, v114, v112
    v_fract_f32 v114, v114
    v_cos_f32 v116, v114
    v_sin_f32 v118, v114
    v_add_f32 v114, 0x41980000, v113
    v_mul_f32 v114, v114, v112
    v_fract_f32 v114, v114
    v_cos_f32 v117, v114
    v_sin_f32 v119, v114
    v_cvt_pk_bf16_f32 v133, v116, v117
    v_cvt_pk_bf16_f32 v141, v118, v119
    v_xor_b32 v149, 0x80008000, v141
    v_add_f32 v114, 0x41c00000, v113
    v_mul_f32 v114, v114, v112
    v_fract_f32 v114, v114
    v_cos_f32 v116, v114
    v_sin_f32 v118, v114
    v_add_f32 v114, 0x41c80000, v113
    v_mul_f32 v114, v114, v112
    v_fract_f32 v114, v114
    v_cos_f32 v117, v114
    v_sin_f32 v119, v114
    v_cvt_pk_bf16_f32 v134, v116, v117
    v_cvt_pk_bf16_f32 v142, v118, v119
    v_xor_b32 v150, 0x80008000, v142
    v_add_f32 v114, 0x41d00000, v113
    v_mul_f32 v114, v114, v112
    v_fract_f32 v114, v114
    v_cos_f32 v116, v114
    v_sin_f32 v118, v114
    v_add_f32 v114, 0x41d80000, v113
    v_mul_f32 v114, v114, v112
    v_fract_f32 v114, v114
    v_cos_f32 v117, v114
    v_sin_f32 v119, v114
    v_cvt_pk_bf16_f32 v135, v116, v117
    v_cvt_pk_bf16_f32 v143, v118, v119
    v_xor_b32 v151, 0x80008000, v143
    v_mul_f32 v112, 0.5, v112
    v_add_f32 v114, 0x00000000, v113
    v_mul_f32 v114, v114, v112
    v_fract_f32 v114, v114
    v_cos_f32 v116, v114
    v_sin_f32 v118, v114
    v_add_f32 v114, 0x3f800000, v113
    v_mul_f32 v114, v114, v112
    v_fract_f32 v114, v114
    v_cos_f32 v117, v114
    v_sin_f32 v119, v114
    v_cvt_pk_bf16_f32 v152, v116, v117
    v_cvt_pk_bf16_f32 v184, v118, v119
    v_xor_b32 v216, 0x80008000, v184
    v_add_f32 v114, 0x40000000, v113
    v_mul_f32 v114, v114, v112
    v_fract_f32 v114, v114
    v_cos_f32 v116, v114
    v_sin_f32 v118, v114
    v_add_f32 v114, 0x40400000, v113
    v_mul_f32 v114, v114, v112
    v_fract_f32 v114, v114
    v_cos_f32 v117, v114
    v_sin_f32 v119, v114
    v_cvt_pk_bf16_f32 v153, v116, v117
    v_cvt_pk_bf16_f32 v185, v118, v119
    v_xor_b32 v217, 0x80008000, v185
    v_add_f32 v114, 0x41000000, v113
    v_mul_f32 v114, v114, v112
    v_fract_f32 v114, v114
    v_cos_f32 v116, v114
    v_sin_f32 v118, v114
    v_add_f32 v114, 0x41100000, v113
    v_mul_f32 v114, v114, v112
    v_fract_f32 v114, v114
    v_cos_f32 v117, v114
    v_sin_f32 v119, v114
    v_cvt_pk_bf16_f32 v154, v116, v117
    v_cvt_pk_bf16_f32 v186, v118, v119
    v_xor_b32 v218, 0x80008000, v186
    v_add_f32 v114, 0x41200000, v113
    v_mul_f32 v114, v114, v112
    v_fract_f32 v114, v114
    v_cos_f32 v116, v114
    v_sin_f32 v118, v114
    v_add_f32 v114, 0x41300000, v113
    v_mul_f32 v114, v114, v112
    v_fract_f32 v114, v114
    v_cos_f32 v117, v114
    v_sin_f32 v119, v114
    v_cvt_pk_bf16_f32 v155, v116, v117
    v_cvt_pk_bf16_f32 v187, v118, v119
    v_xor_b32 v219, 0x80008000, v187
    v_add_f32 v114, 0x41800000, v113
    v_mul_f32 v114, v114, v112
    v_fract_f32 v114, v114
    v_cos_f32 v116, v114
    v_sin_f32 v118, v114
    v_add_f32 v114, 0x41880000, v113
    v_mul_f32 v114, v114, v112
    v_fract_f32 v114, v114
    v_cos_f32 v117, v114
    v_sin_f32 v119, v114
    v_cvt_pk_bf16_f32 v156, v116, v117
    v_cvt_pk_bf16_f32 v188, v118, v119
    v_xor_b32 v220, 0x80008000, v188
    v_add_f32 v114, 0x41900000, v113
    v_mul_f32 v114, v114, v112
    v_fract_f32 v114, v114
    v_cos_f32 v116, v114
    v_sin_f32 v118, v114
    v_add_f32 v114, 0x41980000, v113
    v_mul_f32 v114, v114, v112
    v_fract_f32 v114, v114
    v_cos_f32 v117, v114
    v_sin_f32 v119, v114
    v_cvt_pk_bf16_f32 v157, v116, v117
    v_cvt_pk_bf16_f32 v189, v118, v119
    v_xor_b32 v221, 0x80008000, v189
    v_add_f32 v114, 0x41c00000, v113
    v_mul_f32 v114, v114, v112
    v_fract_f32 v114, v114
    v_cos_f32 v116, v114
    v_sin_f32 v118, v114
    v_add_f32 v114, 0x41c80000, v113
    v_mul_f32 v114, v114, v112
    v_fract_f32 v114, v114
    v_cos_f32 v117, v114
    v_sin_f32 v119, v114
    v_cvt_pk_bf16_f32 v158, v116, v117
    v_cvt_pk_bf16_f32 v190, v118, v119
    v_xor_b32 v222, 0x80008000, v190
    v_add_f32 v114, 0x41d00000, v113
    v_mul_f32 v114, v114, v112
    v_fract_f32 v114, v114
    v_cos_f32 v116, v114
    v_sin_f32 v118, v114
    v_add_f32 v114, 0x41d80000, v113
    v_mul_f32 v114, v114, v112
    v_fract_f32 v114, v114
    v_cos_f32 v117, v114
    v_sin_f32 v119, v114
    v_cvt_pk_bf16_f32 v159, v116, v117
    v_cvt_pk_bf16_f32 v191, v118, v119
    v_xor_b32 v223, 0x80008000, v191
    v_add_f32 v114, 0x42000000, v113
    v_mul_f32 v114, v114, v112
    v_fract_f32 v114, v114
    v_cos_f32 v116, v114
    v_sin_f32 v118, v114
    v_add_f32 v114, 0x42040000, v113
    v_mul_f32 v114, v114, v112
    v_fract_f32 v114, v114
    v_cos_f32 v117, v114
    v_sin_f32 v119, v114
    v_cvt_pk_bf16_f32 v160, v116, v117
    v_cvt_pk_bf16_f32 v192, v118, v119
    v_xor_b32 v224, 0x80008000, v192
    v_add_f32 v114, 0x42080000, v113
    v_mul_f32 v114, v114, v112
    v_fract_f32 v114, v114
    v_cos_f32 v116, v114
    v_sin_f32 v118, v114
    v_add_f32 v114, 0x420c0000, v113
    v_mul_f32 v114, v114, v112
    v_fract_f32 v114, v114
    v_cos_f32 v117, v114
    v_sin_f32 v119, v114
    v_cvt_pk_bf16_f32 v161, v116, v117
    v_cvt_pk_bf16_f32 v193, v118, v119
    v_xor_b32 v225, 0x80008000, v193
    v_add_f32 v114, 0x42200000, v113
    v_mul_f32 v114, v114, v112
    v_fract_f32 v114, v114
    v_cos_f32 v116, v114
    v_sin_f32 v118, v114
    v_add_f32 v114, 0x42240000, v113
    v_mul_f32 v114, v114, v112
    v_fract_f32 v114, v114
    v_cos_f32 v117, v114
    v_sin_f32 v119, v114
    v_cvt_pk_bf16_f32 v162, v116, v117
    v_cvt_pk_bf16_f32 v194, v118, v119
    v_xor_b32 v226, 0x80008000, v194
    v_add_f32 v114, 0x42280000, v113
    v_mul_f32 v114, v114, v112
    v_fract_f32 v114, v114
    v_cos_f32 v116, v114
    v_sin_f32 v118, v114
    v_add_f32 v114, 0x422c0000, v113
    v_mul_f32 v114, v114, v112
    v_fract_f32 v114, v114
    v_cos_f32 v117, v114
    v_sin_f32 v119, v114
    v_cvt_pk_bf16_f32 v163, v116, v117
    v_cvt_pk_bf16_f32 v195, v118, v119
    v_xor_b32 v227, 0x80008000, v195
    v_add_f32 v114, 0x42400000, v113
    v_mul_f32 v114, v114, v112
    v_fract_f32 v114, v114
    v_cos_f32 v116, v114
    v_sin_f32 v118, v114
    v_add_f32 v114, 0x42440000, v113
    v_mul_f32 v114, v114, v112
    v_fract_f32 v114, v114
    v_cos_f32 v117, v114
    v_sin_f32 v119, v114
    v_cvt_pk_bf16_f32 v164, v116, v117
    v_cvt_pk_bf16_f32 v196, v118, v119
    v_xor_b32 v228, 0x80008000, v196
    v_add_f32 v114, 0x42480000, v113
    v_mul_f32 v114, v114, v112
    v_fract_f32 v114, v114
    v_cos_f32 v116, v114
    v_sin_f32 v118, v114
    v_add_f32 v114, 0x424c0000, v113
    v_mul_f32 v114, v114, v112
    v_fract_f32 v114, v114
    v_cos_f32 v117, v114
    v_sin_f32 v119, v114
    v_cvt_pk_bf16_f32 v165, v116, v117
    v_cvt_pk_bf16_f32 v197, v118, v119
    v_xor_b32 v229, 0x80008000, v197
    v_add_f32 v114, 0x42600000, v113
    v_mul_f32 v114, v114, v112
    v_fract_f32 v114, v114
    v_cos_f32 v116, v114
    v_sin_f32 v118, v114
    v_add_f32 v114, 0x42640000, v113
    v_mul_f32 v114, v114, v112
    v_fract_f32 v114, v114
    v_cos_f32 v117, v114
    v_sin_f32 v119, v114
    v_cvt_pk_bf16_f32 v166, v116, v117
    v_cvt_pk_bf16_f32 v198, v118, v119
    v_xor_b32 v230, 0x80008000, v198
    v_add_f32 v114, 0x42680000, v113
    v_mul_f32 v114, v114, v112
    v_fract_f32 v114, v114
    v_cos_f32 v116, v114
    v_sin_f32 v118, v114
    v_add_f32 v114, 0x426c0000, v113
    v_mul_f32 v114, v114, v112
    v_fract_f32 v114, v114
    v_cos_f32 v117, v114
    v_sin_f32 v119, v114
    v_cvt_pk_bf16_f32 v167, v116, v117
    v_cvt_pk_bf16_f32 v199, v118, v119
    v_xor_b32 v231, 0x80008000, v199
    v_add_f32 v112, 0.5, v112
    v_add_f32 v114, 0x00000000, v113
    v_mul_f32 v114, v114, v112
    v_fract_f32 v114, v114
    v_cos_f32 v116, v114
    v_sin_f32 v118, v114
    v_add_f32 v114, 0x3f800000, v113
    v_mul_f32 v114, v114, v112
    v_fract_f32 v114, v114
    v_cos_f32 v117, v114
    v_sin_f32 v119, v114
    v_cvt_pk_bf16_f32 v168, v116, v117
    v_cvt_pk_bf16_f32 v200, v118, v119
    v_xor_b32 v232, 0x80008000, v200
    v_add_f32 v114, 0x40000000, v113
    v_mul_f32 v114, v114, v112
    v_fract_f32 v114, v114
    v_cos_f32 v116, v114
    v_sin_f32 v118, v114
    v_add_f32 v114, 0x40400000, v113
    v_mul_f32 v114, v114, v112
    v_fract_f32 v114, v114
    v_cos_f32 v117, v114
    v_sin_f32 v119, v114
    v_cvt_pk_bf16_f32 v169, v116, v117
    v_cvt_pk_bf16_f32 v201, v118, v119
    v_xor_b32 v233, 0x80008000, v201
    v_add_f32 v114, 0x41000000, v113
    v_mul_f32 v114, v114, v112
    v_fract_f32 v114, v114
    v_cos_f32 v116, v114
    v_sin_f32 v118, v114
    v_add_f32 v114, 0x41100000, v113
    v_mul_f32 v114, v114, v112
    v_fract_f32 v114, v114
    v_cos_f32 v117, v114
    v_sin_f32 v119, v114
    v_cvt_pk_bf16_f32 v170, v116, v117
    v_cvt_pk_bf16_f32 v202, v118, v119
    v_xor_b32 v234, 0x80008000, v202
    v_add_f32 v114, 0x41200000, v113
    v_mul_f32 v114, v114, v112
    v_fract_f32 v114, v114
    v_cos_f32 v116, v114
    v_sin_f32 v118, v114
    v_add_f32 v114, 0x41300000, v113
    v_mul_f32 v114, v114, v112
    v_fract_f32 v114, v114
    v_cos_f32 v117, v114
    v_sin_f32 v119, v114
    v_cvt_pk_bf16_f32 v171, v116, v117
    v_cvt_pk_bf16_f32 v203, v118, v119
    v_xor_b32 v235, 0x80008000, v203
    v_add_f32 v114, 0x41800000, v113
    v_mul_f32 v114, v114, v112
    v_fract_f32 v114, v114
    v_cos_f32 v116, v114
    v_sin_f32 v118, v114
    v_add_f32 v114, 0x41880000, v113
    v_mul_f32 v114, v114, v112
    v_fract_f32 v114, v114
    v_cos_f32 v117, v114
    v_sin_f32 v119, v114
    v_cvt_pk_bf16_f32 v172, v116, v117
    v_cvt_pk_bf16_f32 v204, v118, v119
    v_xor_b32 v236, 0x80008000, v204
    v_add_f32 v114, 0x41900000, v113
    v_mul_f32 v114, v114, v112
    v_fract_f32 v114, v114
    v_cos_f32 v116, v114
    v_sin_f32 v118, v114
    v_add_f32 v114, 0x41980000, v113
    v_mul_f32 v114, v114, v112
    v_fract_f32 v114, v114
    v_cos_f32 v117, v114
    v_sin_f32 v119, v114
    v_cvt_pk_bf16_f32 v173, v116, v117
    v_cvt_pk_bf16_f32 v205, v118, v119
    v_xor_b32 v237, 0x80008000, v205
    v_add_f32 v114, 0x41c00000, v113
    v_mul_f32 v114, v114, v112
    v_fract_f32 v114, v114
    v_cos_f32 v116, v114
    v_sin_f32 v118, v114
    v_add_f32 v114, 0x41c80000, v113
    v_mul_f32 v114, v114, v112
    v_fract_f32 v114, v114
    v_cos_f32 v117, v114
    v_sin_f32 v119, v114
    v_cvt_pk_bf16_f32 v174, v116, v117
    v_cvt_pk_bf16_f32 v206, v118, v119
    v_xor_b32 v238, 0x80008000, v206
    v_add_f32 v114, 0x41d00000, v113
    v_mul_f32 v114, v114, v112
    v_fract_f32 v114, v114
    v_cos_f32 v116, v114
    v_sin_f32 v118, v114
    v_add_f32 v114, 0x41d80000, v113
    v_mul_f32 v114, v114, v112
    v_fract_f32 v114, v114
    v_cos_f32 v117, v114
    v_sin_f32 v119, v114
    v_cvt_pk_bf16_f32 v175, v116, v117
    v_cvt_pk_bf16_f32 v207, v118, v119
    v_xor_b32 v239, 0x80008000, v207
    v_add_f32 v114, 0x42000000, v113
    v_mul_f32 v114, v114, v112
    v_fract_f32 v114, v114
    v_cos_f32 v116, v114
    v_sin_f32 v118, v114
    v_add_f32 v114, 0x42040000, v113
    v_mul_f32 v114, v114, v112
    v_fract_f32 v114, v114
    v_cos_f32 v117, v114
    v_sin_f32 v119, v114
    v_cvt_pk_bf16_f32 v176, v116, v117
    v_cvt_pk_bf16_f32 v208, v118, v119
    v_xor_b32 v240, 0x80008000, v208
    v_add_f32 v114, 0x42080000, v113
    v_mul_f32 v114, v114, v112
    v_fract_f32 v114, v114
    v_cos_f32 v116, v114
    v_sin_f32 v118, v114
    v_add_f32 v114, 0x420c0000, v113
    v_mul_f32 v114, v114, v112
    v_fract_f32 v114, v114
    v_cos_f32 v117, v114
    v_sin_f32 v119, v114
    v_cvt_pk_bf16_f32 v177, v116, v117
    v_cvt_pk_bf16_f32 v209, v118, v119
    v_xor_b32 v241, 0x80008000, v209
    v_add_f32 v114, 0x42200000, v113
    v_mul_f32 v114, v114, v112
    v_fract_f32 v114, v114
    v_cos_f32 v116, v114
    v_sin_f32 v118, v114
    v_add_f32 v114, 0x42240000, v113
    v_mul_f32 v114, v114, v112
    v_fract_f32 v114, v114
    v_cos_f32 v117, v114
    v_sin_f32 v119, v114
    v_cvt_pk_bf16_f32 v178, v116, v117
    v_cvt_pk_bf16_f32 v210, v118, v119
    v_xor_b32 v242, 0x80008000, v210
    v_add_f32 v114, 0x42280000, v113
    v_mul_f32 v114, v114, v112
    v_fract_f32 v114, v114
    v_cos_f32 v116, v114
    v_sin_f32 v118, v114
    v_add_f32 v114, 0x422c0000, v113
    v_mul_f32 v114, v114, v112
    v_fract_f32 v114, v114
    v_cos_f32 v117, v114
    v_sin_f32 v119, v114
    v_cvt_pk_bf16_f32 v179, v116, v117
    v_cvt_pk_bf16_f32 v211, v118, v119
    v_xor_b32 v243, 0x80008000, v211
    v_add_f32 v114, 0x42400000, v113
    v_mul_f32 v114, v114, v112
    v_fract_f32 v114, v114
    v_cos_f32 v116, v114
    v_sin_f32 v118, v114
    v_add_f32 v114, 0x42440000, v113
    v_mul_f32 v114, v114, v112
    v_fract_f32 v114, v114
    v_cos_f32 v117, v114
    v_sin_f32 v119, v114
    v_cvt_pk_bf16_f32 v180, v116, v117
    v_cvt_pk_bf16_f32 v212, v118, v119
    v_xor_b32 v244, 0x80008000, v212
    v_add_f32 v114, 0x42480000, v113
    v_mul_f32 v114, v114, v112
    v_fract_f32 v114, v114
    v_cos_f32 v116, v114
    v_sin_f32 v118, v114
    v_add_f32 v114, 0x424c0000, v113
    v_mul_f32 v114, v114, v112
    v_fract_f32 v114, v114
    v_cos_f32 v117, v114
    v_sin_f32 v119, v114
    v_cvt_pk_bf16_f32 v181, v116, v117
    v_cvt_pk_bf16_f32 v213, v118, v119
    v_xor_b32 v245, 0x80008000, v213
    v_add_f32 v114, 0x42600000, v113
    v_mul_f32 v114, v114, v112
    v_fract_f32 v114, v114
    v_cos_f32 v116, v114
    v_sin_f32 v118, v114
    v_add_f32 v114, 0x42640000, v113
    v_mul_f32 v114, v114, v112
    v_fract_f32 v114, v114
    v_cos_f32 v117, v114
    v_sin_f32 v119, v114
    v_cvt_pk_bf16_f32 v182, v116, v117
    v_cvt_pk_bf16_f32 v214, v118, v119
    v_xor_b32 v246, 0x80008000, v214
    v_add_f32 v114, 0x42680000, v113
    v_mul_f32 v114, v114, v112
    v_fract_f32 v114, v114
    v_cos_f32 v116, v114
    v_sin_f32 v118, v114
    v_add_f32 v114, 0x426c0000, v113
    v_mul_f32 v114, v114, v112
    v_fract_f32 v114, v114
    v_cos_f32 v117, v114
    v_sin_f32 v119, v114
    v_cvt_pk_bf16_f32 v183, v116, v117
    v_cvt_pk_bf16_f32 v215, v118, v119
    v_xor_b32 v247, 0x80008000, v215
    s_mov_b32 s54, 0
    v_mov_b32 v4, 12
PA2_W:
    global_load_dword v5, v4, s[30:31] sc1
    s_add_u32 s54, s54, 1
    s_cmp_gt_u32 s54, 65536
    s_cbranch_scc1 EXIT
    s_waitcnt vmcnt(0)
    v_readfirstlane_b32 s51, v5
    s_nop 0
    s_cmp_ge_u32 s51, 64
    s_cbranch_scc1 PA2_W_OK
    s_sleep 4
    s_branch PA2_W
PA2_W_OK:
    s_add_u32 s51, s50, 61865984
    s_nop 0
    buffer_load_dwordx4 v[80:83], v7, s[36:39], s51 offen offset:0 sc1
    buffer_load_dwordx4 v[84:87], v7, s[36:39], s51 offen offset:2048 sc1
    buffer_load_dwordx4 v[88:91], v7, s[36:39], s51 offen offset:512 sc1
    buffer_load_dwordx4 v[92:95], v7, s[36:39], s51 offen offset:2560 sc1
    buffer_load_dwordx4 v[96:99], v8, s[36:39], s51 offen offset:0 sc1
    buffer_load_dwordx4 v[100:103], v8, s[36:39], s51 offen offset:2048 sc1
    buffer_load_dwordx4 v[104:107], v8, s[36:39], s51 offen offset:512 sc1
    buffer_load_dwordx4 v[108:111], v8, s[36:39], s51 offen offset:2560 sc1
    s_waitcnt vmcnt(0)
    v_mfma_f32_32x32x16_bf16 v[16:31], v[80:83], v[128:131], 0
    v_mfma_f32_32x32x16_bf16 v[16:31], v[84:87], v[132:135], v[16:31]
    v_mfma_f32_32x32x16_bf16 v[16:31], v[96:99], v[136:139], v[16:31]
    v_mfma_f32_32x32x16_bf16 v[16:31], v[100:103], v[140:143], v[16:31]
    v_mfma_f32_32x32x16_bf16 v[32:47], v[96:99], v[128:131], 0
    v_mfma_f32_32x32x16_bf16 v[32:47], v[100:103], v[132:135], v[32:47]
    v_mfma_f32_32x32x16_bf16 v[32:47], v[80:83], v[144:147], v[32:47]
    v_mfma_f32_32x32x16_bf16 v[32:47], v[84:87], v[148:151], v[32:47]
    v_mfma_f32_32x32x16_bf16 v[48:63], v[88:91], v[128:131], 0
    v_mfma_f32_32x32x16_bf16 v[48:63], v[92:95], v[132:135], v[48:63]
    v_mfma_f32_32x32x16_bf16 v[48:63], v[104:107], v[136:139], v[48:63]
    v_mfma_f32_32x32x16_bf16 v[48:63], v[108:111], v[140:143], v[48:63]
    v_mfma_f32_32x32x16_bf16 v[64:79], v[104:107], v[128:131], 0
    v_mfma_f32_32x32x16_bf16 v[64:79], v[108:111], v[132:135], v[64:79]
    v_mfma_f32_32x32x16_bf16 v[64:79], v[88:91], v[144:147], v[64:79]
    v_mfma_f32_32x32x16_bf16 v[64:79], v[92:95], v[148:151], v[64:79]
    v_lshrrev_b32 v113, 5, v2
    v_lshlrev_b32 v113, 2, v113
    v_cvt_f32_u32 v113, v113
    v_and_b32 v112, 31, v2
    v_cvt_f32_u32 v112, v112
    v_mul_f32 v112, 0x3a000000, v112
    v_add_f32 v116, 0x00000000, v113
    v_mul_f32 v116, v116, v112
    v_cos_f32 v117, v116
    v_sin_f32 v118, v116
    s_nop 0
    v_mul_f32 v119, v32, v118
    v_mul_f32 v32, v32, v117
    v_fma_f32 v32, -v16, v118, v32
    v_fma_f32 v16, v16, v117, v119
    v_add_f32 v120, 0x3f800000, v113
    v_mul_f32 v120, v120, v112
    v_cos_f32 v121, v120
    v_sin_f32 v122, v120
    s_nop 0
    v_mul_f32 v123, v33, v122
    v_mul_f32 v33, v33, v121
    v_fma_f32 v33, -v17, v122, v33
    v_fma_f32 v17, v17, v121, v123
    v_add_f32 v116, 0x40000000, v113
    v_mul_f32 v116, v116, v112
    v_cos_f32 v117, v116
    v_sin_f32 v118, v116
    s_nop 0
    v_mul_f32 v119, v34, v118
    v_mul_f32 v34, v34, v117
    v_fma_f32 v34, -v18, v118, v34
    v_fma_f32 v18, v18, v117, v119
    v_add_f32 v120, 0x40400000, v113
    v_mul_f32 v120, v120, v112
    v_cos_f32 v121, v120
    v_sin_f32 v122, v120
    s_nop 0
    v_mul_f32 v123, v35, v122
    v_mul_f32 v35, v35, v121
    v_fma_f32 v35, -v19, v122, v35
    v_fma_f32 v19, v19, v121, v123
    v_add_f32 v116, 0x41000000, v113
    v_mul_f32 v116, v116, v112
    v_cos_f32 v117, v116
    v_sin_f32 v118, v116
    s_nop 0
    v_mul_f32 v119, v36, v118
    v_mul_f32 v36, v36, v117
    v_fma_f32 v36, -v20, v118, v36
    v_fma_f32 v20, v20, v117, v119
    v_add_f32 v120, 0x41100000, v113
    v_mul_f32 v120, v120, v112
    v_cos_f32 v121, v120
    v_sin_f32 v122, v120
    s_nop 0
    v_mul_f32 v123, v37, v122
    v_mul_f32 v37, v37, v121
    v_fma_f32 v37, -v21, v122, v37
    v_fma_f32 v21, v21, v121, v123
    v_add_f32 v116, 0x41200000, v113
    v_mul_f32 v116, v116, v112
    v_cos_f32 v117, v116
    v_sin_f32 v118, v116
    s_nop 0
    v_mul_f32 v119, v38, v118
    v_mul_f32 v38, v38, v117
    v_fma_f32 v38, -v22, v118, v38
    v_fma_f32 v22, v22, v117, v119
    v_add_f32 v120, 0x41300000, v113
    v_mul_f32 v120, v120, v112
    v_cos_f32 v121, v120
    v_sin_f32 v122, v120
    s_nop 0
    v_mul_f32 v123, v39, v122
    v_mul_f32 v39, v39, v121
    v_fma_f32 v39, -v23, v122, v39
    v_fma_f32 v23, v23, v121, v123
    v_add_f32 v116, 0x41800000, v113
    v_mul_f32 v116, v116, v112
    v_cos_f32 v117, v116
    v_sin_f32 v118, v116
    s_nop 0
    v_mul_f32 v119, v40, v118
    v_mul_f32 v40, v40, v117
    v_fma_f32 v40, -v24, v118, v40
    v_fma_f32 v24, v24, v117, v119
    v_add_f32 v120, 0x41880000, v113
    v_mul_f32 v120, v120, v112
    v_cos_f32 v121, v120
    v_sin_f32 v122, v120
    s_nop 0
    v_mul_f32 v123, v41, v122
    v_mul_f32 v41, v41, v121
    v_fma_f32 v41, -v25, v122, v41
    v_fma_f32 v25, v25, v121, v123
    v_add_f32 v116, 0x41900000, v113
    v_mul_f32 v116, v116, v112
    v_cos_f32 v117, v116
    v_sin_f32 v118, v116
    s_nop 0
    v_mul_f32 v119, v42, v118
    v_mul_f32 v42, v42, v117
    v_fma_f32 v42, -v26, v118, v42
    v_fma_f32 v26, v26, v117, v119
    v_add_f32 v120, 0x41980000, v113
    v_mul_f32 v120, v120, v112
    v_cos_f32 v121, v120
    v_sin_f32 v122, v120
    s_nop 0
    v_mul_f32 v123, v43, v122
    v_mul_f32 v43, v43, v121
    v_fma_f32 v43, -v27, v122, v43
    v_fma_f32 v27, v27, v121, v123
    v_add_f32 v116, 0x41c00000, v113
    v_mul_f32 v116, v116, v112
    v_cos_f32 v117, v116
    v_sin_f32 v118, v116
    s_nop 0
    v_mul_f32 v119, v44, v118
    v_mul_f32 v44, v44, v117
    v_fma_f32 v44, -v28, v118, v44
    v_fma_f32 v28, v28, v117, v119
    v_add_f32 v120, 0x41c80000, v113
    v_mul_f32 v120, v120, v112
    v_cos_f32 v121, v120
    v_sin_f32 v122, v120
    s_nop 0
    v_mul_f32 v123, v45, v122
    v_mul_f32 v45, v45, v121
    v_fma_f32 v45, -v29, v122, v45
    v_fma_f32 v29, v29, v121, v123
    v_add_f32 v116, 0x41d00000, v113
    v_mul_f32 v116, v116, v112
    v_cos_f32 v117, v116
    v_sin_f32 v118, v116
    s_nop 0
    v_mul_f32 v119, v46, v118
    v_mul_f32 v46, v46, v117
    v_fma_f32 v46, -v30, v118, v46
    v_fma_f32 v30, v30, v117, v119
    v_add_f32 v120, 0x41d80000, v113
    v_mul_f32 v120, v120, v112
    v_cos_f32 v121, v120
    v_sin_f32 v122, v120
    s_nop 0
    v_mul_f32 v123, v47, v122
    v_mul_f32 v47, v47, v121
    v_fma_f32 v47, -v31, v122, v47
    v_fma_f32 v31, v31, v121, v123
    v_add_f32 v116, 0x42000000, v113
    v_mul_f32 v116, v116, v112
    v_cos_f32 v117, v116
    v_sin_f32 v118, v116
    s_nop 0
    v_mul_f32 v119, v64, v118
    v_mul_f32 v64, v64, v117
    v_fma_f32 v64, -v48, v118, v64
    v_fma_f32 v48, v48, v117, v119
    v_add_f32 v120, 0x42040000, v113
    v_mul_f32 v120, v120, v112
    v_cos_f32 v121, v120
    v_sin_f32 v122, v120
    s_nop 0
    v_mul_f32 v123, v65, v122
    v_mul_f32 v65, v65, v121
    v_fma_f32 v65, -v49, v122, v65
    v_fma_f32 v49, v49, v121, v123
    v_add_f32 v116, 0x42080000, v113
    v_mul_f32 v116, v116, v112
    v_cos_f32 v117, v116
    v_sin_f32 v118, v116
    s_nop 0
    v_mul_f32 v119, v66, v118
    v_mul_f32 v66, v66, v117
    v_fma_f32 v66, -v50, v118, v66
    v_fma_f32 v50, v50, v117, v119
    v_add_f32 v120, 0x420c0000, v113
    v_mul_f32 v120, v120, v112
    v_cos_f32 v121, v120
    v_sin_f32 v122, v120
    s_nop 0
    v_mul_f32 v123, v67, v122
    v_mul_f32 v67, v67, v121
    v_fma_f32 v67, -v51, v122, v67
    v_fma_f32 v51, v51, v121, v123
    v_add_f32 v116, 0x42200000, v113
    v_mul_f32 v116, v116, v112
    v_cos_f32 v117, v116
    v_sin_f32 v118, v116
    s_nop 0
    v_mul_f32 v119, v68, v118
    v_mul_f32 v68, v68, v117
    v_fma_f32 v68, -v52, v118, v68
    v_fma_f32 v52, v52, v117, v119
    v_add_f32 v120, 0x42240000, v113
    v_mul_f32 v120, v120, v112
    v_cos_f32 v121, v120
    v_sin_f32 v122, v120
    s_nop 0
    v_mul_f32 v123, v69, v122
    v_mul_f32 v69, v69, v121
    v_fma_f32 v69, -v53, v122, v69
    v_fma_f32 v53, v53, v121, v123
    v_add_f32 v116, 0x42280000, v113
    v_mul_f32 v116, v116, v112
    v_cos_f32 v117, v116
    v_sin_f32 v118, v116
    s_nop 0
    v_mul_f32 v119, v70, v118
    v_mul_f32 v70, v70, v117
    v_fma_f32 v70, -v54, v118, v70
    v_fma_f32 v54, v54, v117, v119
    v_add_f32 v120, 0x422c0000, v113
    v_mul_f32 v120, v120, v112
    v_cos_f32 v121, v120
    v_sin_f32 v122, v120
    s_nop 0
    v_mul_f32 v123, v71, v122
    v_mul_f32 v71, v71, v121
    v_fma_f32 v71, -v55, v122, v71
    v_fma_f32 v55, v55, v121, v123
    v_add_f32 v116, 0x42400000, v113
    v_mul_f32 v116, v116, v112
    v_cos_f32 v117, v116
    v_sin_f32 v118, v116
    s_nop 0
    v_mul_f32 v119, v72, v118
    v_mul_f32 v72, v72, v117
    v_fma_f32 v72, -v56, v118, v72
    v_fma_f32 v56, v56, v117, v119
    v_add_f32 v120, 0x42440000, v113
    v_mul_f32 v120, v120, v112
    v_cos_f32 v121, v120
    v_sin_f32 v122, v120
    s_nop 0
    v_mul_f32 v123, v73, v122
    v_mul_f32 v73, v73, v121
    v_fma_f32 v73, -v57, v122, v73
    v_fma_f32 v57, v57, v121, v123
    v_add_f32 v116, 0x42480000, v113
    v_mul_f32 v116, v116, v112
    v_cos_f32 v117, v116
    v_sin_f32 v118, v116
    s_nop 0
    v_mul_f32 v119, v74, v118
    v_mul_f32 v74, v74, v117
    v_fma_f32 v74, -v58, v118, v74
    v_fma_f32 v58, v58, v117, v119
    v_add_f32 v120, 0x424c0000, v113
    v_mul_f32 v120, v120, v112
    v_cos_f32 v121, v120
    v_sin_f32 v122, v120
    s_nop 0
    v_mul_f32 v123, v75, v122
    v_mul_f32 v75, v75, v121
    v_fma_f32 v75, -v59, v122, v75
    v_fma_f32 v59, v59, v121, v123
    v_add_f32 v116, 0x42600000, v113
    v_mul_f32 v116, v116, v112
    v_cos_f32 v117, v116
    v_sin_f32 v118, v116
    s_nop 0
    v_mul_f32 v119, v76, v118
    v_mul_f32 v76, v76, v117
    v_fma_f32 v76, -v60, v118, v76
    v_fma_f32 v60, v60, v117, v119
    v_add_f32 v120, 0x42640000, v113
    v_mul_f32 v120, v120, v112
    v_cos_f32 v121, v120
    v_sin_f32 v122, v120
    s_nop 0
    v_mul_f32 v123, v77, v122
    v_mul_f32 v77, v77, v121
    v_fma_f32 v77, -v61, v122, v77
    v_fma_f32 v61, v61, v121, v123
    v_add_f32 v116, 0x42680000, v113
    v_mul_f32 v116, v116, v112
    v_cos_f32 v117, v116
    v_sin_f32 v118, v116
    s_nop 0
    v_mul_f32 v119, v78, v118
    v_mul_f32 v78, v78, v117
    v_fma_f32 v78, -v62, v118, v78
    v_fma_f32 v62, v62, v117, v119
    v_add_f32 v120, 0x426c0000, v113
    v_mul_f32 v120, v120, v112
    v_cos_f32 v121, v120
    v_sin_f32 v122, v120
    s_nop 0
    v_mul_f32 v123, v79, v122
    v_mul_f32 v79, v79, v121
    v_fma_f32 v79, -v63, v122, v79
    v_fma_f32 v63, v63, v121, v123
    v_cvt_pk_bf16_f32 v80, v16, v17
    v_cvt_pk_bf16_f32 v96, v32, v33
    v_cvt_pk_bf16_f32 v81, v18, v19
    v_cvt_pk_bf16_f32 v97, v34, v35
    v_cvt_pk_bf16_f32 v82, v20, v21
    v_cvt_pk_bf16_f32 v98, v36, v37
    v_cvt_pk_bf16_f32 v83, v22, v23
    v_cvt_pk_bf16_f32 v99, v38, v39
    v_cvt_pk_bf16_f32 v84, v24, v25
    v_cvt_pk_bf16_f32 v100, v40, v41
    v_cvt_pk_bf16_f32 v85, v26, v27
    v_cvt_pk_bf16_f32 v101, v42, v43
    v_cvt_pk_bf16_f32 v86, v28, v29
    v_cvt_pk_bf16_f32 v102, v44, v45
    v_cvt_pk_bf16_f32 v87, v30, v31
    v_cvt_pk_bf16_f32 v103, v46, v47
    v_cvt_pk_bf16_f32 v88, v48, v49
    v_cvt_pk_bf16_f32 v104, v64, v65
    v_cvt_pk_bf16_f32 v89, v50, v51
    v_cvt_pk_bf16_f32 v105, v66, v67
    v_cvt_pk_bf16_f32 v90, v52, v53
    v_cvt_pk_bf16_f32 v106, v68, v69
    v_cvt_pk_bf16_f32 v91, v54, v55
    v_cvt_pk_bf16_f32 v107, v70, v71
    v_cvt_pk_bf16_f32 v92, v56, v57
    v_cvt_pk_bf16_f32 v108, v72, v73
    v_cvt_pk_bf16_f32 v93, v58, v59
    v_cvt_pk_bf16_f32 v109, v74, v75
    v_cvt_pk_bf16_f32 v94, v60, v61
    v_cvt_pk_bf16_f32 v110, v76, v77
    v_cvt_pk_bf16_f32 v95, v62, v63
    v_cvt_pk_bf16_f32 v111, v78, v79
    v_mfma_f32_32x32x16_bf16 v[16:31], v[152:155], v[80:83], 0
    v_mfma_f32_32x32x16_bf16 v[16:31], v[156:159], v[84:87], v[16:31]
    v_mfma_f32_32x32x16_bf16 v[16:31], v[160:163], v[88:91], v[16:31]
    v_mfma_f32_32x32x16_bf16 v[16:31], v[164:167], v[92:95], v[16:31]
    v_mfma_f32_32x32x16_bf16 v[16:31], v[184:187], v[96:99], v[16:31]
    v_mfma_f32_32x32x16_bf16 v[16:31], v[188:191], v[100:103], v[16:31]
    v_mfma_f32_32x32x16_bf16 v[16:31], v[192:195], v[104:107], v[16:31]
    v_mfma_f32_32x32x16_bf16 v[16:31], v[196:199], v[108:111], v[16:31]
    v_mfma_f32_32x32x16_bf16 v[32:47], v[152:155], v[96:99], 0
    v_mfma_f32_32x32x16_bf16 v[32:47], v[156:159], v[100:103], v[32:47]
    v_mfma_f32_32x32x16_bf16 v[32:47], v[160:163], v[104:107], v[32:47]
    v_mfma_f32_32x32x16_bf16 v[32:47], v[164:167], v[108:111], v[32:47]
    v_mfma_f32_32x32x16_bf16 v[32:47], v[216:219], v[80:83], v[32:47]
    v_mfma_f32_32x32x16_bf16 v[32:47], v[220:223], v[84:87], v[32:47]
    v_mfma_f32_32x32x16_bf16 v[32:47], v[224:227], v[88:91], v[32:47]
    v_mfma_f32_32x32x16_bf16 v[32:47], v[228:231], v[92:95], v[32:47]
    v_mfma_f32_32x32x16_bf16 v[48:63], v[168:171], v[80:83], 0
    v_mfma_f32_32x32x16_bf16 v[48:63], v[172:175], v[84:87], v[48:63]
    v_mfma_f32_32x32x16_bf16 v[48:63], v[176:179], v[88:91], v[48:63]
    v_mfma_f32_32x32x16_bf16 v[48:63], v[180:183], v[92:95], v[48:63]
    v_mfma_f32_32x32x16_bf16 v[48:63], v[200:203], v[96:99], v[48:63]
    v_mfma_f32_32x32x16_bf16 v[48:63], v[204:207], v[100:103], v[48:63]
    v_mfma_f32_32x32x16_bf16 v[48:63], v[208:211], v[104:107], v[48:63]
    v_mfma_f32_32x32x16_bf16 v[48:63], v[212:215], v[108:111], v[48:63]
    v_mfma_f32_32x32x16_bf16 v[64:79], v[168:171], v[96:99], 0
    v_mfma_f32_32x32x16_bf16 v[64:79], v[172:175], v[100:103], v[64:79]
    v_mfma_f32_32x32x16_bf16 v[64:79], v[176:179], v[104:107], v[64:79]
    v_mfma_f32_32x32x16_bf16 v[64:79], v[180:183], v[108:111], v[64:79]
    v_mfma_f32_32x32x16_bf16 v[64:79], v[232:235], v[80:83], v[64:79]
    v_mfma_f32_32x32x16_bf16 v[64:79], v[236:239], v[84:87], v[64:79]
    v_mfma_f32_32x32x16_bf16 v[64:79], v[240:243], v[88:91], v[64:79]
    v_mfma_f32_32x32x16_bf16 v[64:79], v[244:247], v[92:95], v[64:79]
    v_accvgpr_read_b32 v117, a0
    v_accvgpr_read_b32 v118, a32
    v_mul_f32 v119, v32, v118
    v_mul_f32 v32, v32, v117
    v_fma_f32 v32, v16, v118, v32
    v_fma_f32 v16, v16, v117, -v119
    v_accvgpr_read_b32 v121, a1
    v_accvgpr_read_b32 v122, a33
    v_mul_f32 v123, v33, v122
    v_mul_f32 v33, v33, v121
    v_fma_f32 v33, v17, v122, v33
    v_fma_f32 v17, v17, v121, -v123
    v_accvgpr_read_b32 v117, a2
    v_accvgpr_read_b32 v118, a34
    v_mul_f32 v119, v34, v118
    v_mul_f32 v34, v34, v117
    v_fma_f32 v34, v18, v118, v34
    v_fma_f32 v18, v18, v117, -v119
    v_accvgpr_read_b32 v121, a3
    v_accvgpr_read_b32 v122, a35
    v_mul_f32 v123, v35, v122
    v_mul_f32 v35, v35, v121
    v_fma_f32 v35, v19, v122, v35
    v_fma_f32 v19, v19, v121, -v123
    v_accvgpr_read_b32 v117, a4
    v_accvgpr_read_b32 v118, a36
    v_mul_f32 v119, v36, v118
    v_mul_f32 v36, v36, v117
    v_fma_f32 v36, v20, v118, v36
    v_fma_f32 v20, v20, v117, -v119
    v_accvgpr_read_b32 v121, a5
    v_accvgpr_read_b32 v122, a37
    v_mul_f32 v123, v37, v122
    v_mul_f32 v37, v37, v121
    v_fma_f32 v37, v21, v122, v37
    v_fma_f32 v21, v21, v121, -v123
    v_accvgpr_read_b32 v117, a6
    v_accvgpr_read_b32 v118, a38
    v_mul_f32 v119, v38, v118
    v_mul_f32 v38, v38, v117
    v_fma_f32 v38, v22, v118, v38
    v_fma_f32 v22, v22, v117, -v119
    v_accvgpr_read_b32 v121, a7
    v_accvgpr_read_b32 v122, a39
    v_mul_f32 v123, v39, v122
    v_mul_f32 v39, v39, v121
    v_fma_f32 v39, v23, v122, v39
    v_fma_f32 v23, v23, v121, -v123
    v_accvgpr_read_b32 v117, a8
    v_accvgpr_read_b32 v118, a40
    v_mul_f32 v119, v40, v118
    v_mul_f32 v40, v40, v117
    v_fma_f32 v40, v24, v118, v40
    v_fma_f32 v24, v24, v117, -v119
    v_accvgpr_read_b32 v121, a9
    v_accvgpr_read_b32 v122, a41
    v_mul_f32 v123, v41, v122
    v_mul_f32 v41, v41, v121
    v_fma_f32 v41, v25, v122, v41
    v_fma_f32 v25, v25, v121, -v123
    v_accvgpr_read_b32 v117, a10
    v_accvgpr_read_b32 v118, a42
    v_mul_f32 v119, v42, v118
    v_mul_f32 v42, v42, v117
    v_fma_f32 v42, v26, v118, v42
    v_fma_f32 v26, v26, v117, -v119
    v_accvgpr_read_b32 v121, a11
    v_accvgpr_read_b32 v122, a43
    v_mul_f32 v123, v43, v122
    v_mul_f32 v43, v43, v121
    v_fma_f32 v43, v27, v122, v43
    v_fma_f32 v27, v27, v121, -v123
    v_accvgpr_read_b32 v117, a12
    v_accvgpr_read_b32 v118, a44
    v_mul_f32 v119, v44, v118
    v_mul_f32 v44, v44, v117
    v_fma_f32 v44, v28, v118, v44
    v_fma_f32 v28, v28, v117, -v119
    v_accvgpr_read_b32 v121, a13
    v_accvgpr_read_b32 v122, a45
    v_mul_f32 v123, v45, v122
    v_mul_f32 v45, v45, v121
    v_fma_f32 v45, v29, v122, v45
    v_fma_f32 v29, v29, v121, -v123
    v_accvgpr_read_b32 v117, a14
    v_accvgpr_read_b32 v118, a46
    v_mul_f32 v119, v46, v118
    v_mul_f32 v46, v46, v117
    v_fma_f32 v46, v30, v118, v46
    v_fma_f32 v30, v30, v117, -v119
    v_accvgpr_read_b32 v121, a15
    v_accvgpr_read_b32 v122, a47
    v_mul_f32 v123, v47, v122
    v_mul_f32 v47, v47, v121
    v_fma_f32 v47, v31, v122, v47
    v_fma_f32 v31, v31, v121, -v123
    v_accvgpr_read_b32 v117, a16
    v_accvgpr_read_b32 v118, a48
    v_mul_f32 v119, v64, v118
    v_mul_f32 v64, v64, v117
    v_fma_f32 v64, v48, v118, v64
    v_fma_f32 v48, v48, v117, -v119
    v_accvgpr_read_b32 v121, a17
    v_accvgpr_read_b32 v122, a49
    v_mul_f32 v123, v65, v122
    v_mul_f32 v65, v65, v121
    v_fma_f32 v65, v49, v122, v65
    v_fma_f32 v49, v49, v121, -v123
    v_accvgpr_read_b32 v117, a18
    v_accvgpr_read_b32 v118, a50
    v_mul_f32 v119, v66, v118
    v_mul_f32 v66, v66, v117
    v_fma_f32 v66, v50, v118, v66
    v_fma_f32 v50, v50, v117, -v119
    v_accvgpr_read_b32 v121, a19
    v_accvgpr_read_b32 v122, a51
    v_mul_f32 v123, v67, v122
    v_mul_f32 v67, v67, v121
    v_fma_f32 v67, v51, v122, v67
    v_fma_f32 v51, v51, v121, -v123
    v_accvgpr_read_b32 v117, a20
    v_accvgpr_read_b32 v118, a52
    v_mul_f32 v119, v68, v118
    v_mul_f32 v68, v68, v117
    v_fma_f32 v68, v52, v118, v68
    v_fma_f32 v52, v52, v117, -v119
    v_accvgpr_read_b32 v121, a21
    v_accvgpr_read_b32 v122, a53
    v_mul_f32 v123, v69, v122
    v_mul_f32 v69, v69, v121
    v_fma_f32 v69, v53, v122, v69
    v_fma_f32 v53, v53, v121, -v123
    v_accvgpr_read_b32 v117, a22
    v_accvgpr_read_b32 v118, a54
    v_mul_f32 v119, v70, v118
    v_mul_f32 v70, v70, v117
    v_fma_f32 v70, v54, v118, v70
    v_fma_f32 v54, v54, v117, -v119
    v_accvgpr_read_b32 v121, a23
    v_accvgpr_read_b32 v122, a55
    v_mul_f32 v123, v71, v122
    v_mul_f32 v71, v71, v121
    v_fma_f32 v71, v55, v122, v71
    v_fma_f32 v55, v55, v121, -v123
    v_accvgpr_read_b32 v117, a24
    v_accvgpr_read_b32 v118, a56
    v_mul_f32 v119, v72, v118
    v_mul_f32 v72, v72, v117
    v_fma_f32 v72, v56, v118, v72
    v_fma_f32 v56, v56, v117, -v119
    v_accvgpr_read_b32 v121, a25
    v_accvgpr_read_b32 v122, a57
    v_mul_f32 v123, v73, v122
    v_mul_f32 v73, v73, v121
    v_fma_f32 v73, v57, v122, v73
    v_fma_f32 v57, v57, v121, -v123
    v_accvgpr_read_b32 v117, a26
    v_accvgpr_read_b32 v118, a58
    v_mul_f32 v119, v74, v118
    v_mul_f32 v74, v74, v117
    v_fma_f32 v74, v58, v118, v74
    v_fma_f32 v58, v58, v117, -v119
    v_accvgpr_read_b32 v121, a27
    v_accvgpr_read_b32 v122, a59
    v_mul_f32 v123, v75, v122
    v_mul_f32 v75, v75, v121
    v_fma_f32 v75, v59, v122, v75
    v_fma_f32 v59, v59, v121, -v123
    v_accvgpr_read_b32 v117, a28
    v_accvgpr_read_b32 v118, a60
    v_mul_f32 v119, v76, v118
    v_mul_f32 v76, v76, v117
    v_fma_f32 v76, v60, v118, v76
    v_fma_f32 v60, v60, v117, -v119
    v_accvgpr_read_b32 v121, a29
    v_accvgpr_read_b32 v122, a61
    v_mul_f32 v123, v77, v122
    v_mul_f32 v77, v77, v121
    v_fma_f32 v77, v61, v122, v77
    v_fma_f32 v61, v61, v121, -v123
    v_accvgpr_read_b32 v117, a30
    v_accvgpr_read_b32 v118, a62
    v_mul_f32 v119, v78, v118
    v_mul_f32 v78, v78, v117
    v_fma_f32 v78, v62, v118, v78
    v_fma_f32 v62, v62, v117, -v119
    v_accvgpr_read_b32 v121, a31
    v_accvgpr_read_b32 v122, a63
    v_mul_f32 v123, v79, v122
    v_mul_f32 v79, v79, v121
    v_fma_f32 v79, v63, v122, v79
    v_fma_f32 v63, v63, v121, -v123
    v_cvt_pk_bf16_f32 v80, v16, v17
    v_cvt_pk_bf16_f32 v96, v32, v33
    v_cvt_pk_bf16_f32 v81, v18, v19
    v_cvt_pk_bf16_f32 v97, v34, v35
    v_cvt_pk_bf16_f32 v82, v20, v21
    v_cvt_pk_bf16_f32 v98, v36, v37
    v_cvt_pk_bf16_f32 v83, v22, v23
    v_cvt_pk_bf16_f32 v99, v38, v39
    v_cvt_pk_bf16_f32 v84, v24, v25
    v_cvt_pk_bf16_f32 v100, v40, v41
    v_cvt_pk_bf16_f32 v85, v26, v27
    v_cvt_pk_bf16_f32 v101, v42, v43
    v_cvt_pk_bf16_f32 v86, v28, v29
    v_cvt_pk_bf16_f32 v102, v44, v45
    v_cvt_pk_bf16_f32 v87, v30, v31
    v_cvt_pk_bf16_f32 v103, v46, v47
    v_cvt_pk_bf16_f32 v88, v48, v49
    v_cvt_pk_bf16_f32 v104, v64, v65
    v_cvt_pk_bf16_f32 v89, v50, v51
    v_cvt_pk_bf16_f32 v105, v66, v67
    v_cvt_pk_bf16_f32 v90, v52, v53
    v_cvt_pk_bf16_f32 v106, v68, v69
    v_cvt_pk_bf16_f32 v91, v54, v55
    v_cvt_pk_bf16_f32 v107, v70, v71
    v_cvt_pk_bf16_f32 v92, v56, v57
    v_cvt_pk_bf16_f32 v108, v72, v73
    v_cvt_pk_bf16_f32 v93, v58, v59
    v_cvt_pk_bf16_f32 v109, v74, v75
    v_cvt_pk_bf16_f32 v94, v60, v61
    v_cvt_pk_bf16_f32 v110, v76, v77
    v_cvt_pk_bf16_f32 v95, v62, v63
    v_cvt_pk_bf16_f32 v111, v78, v79
    v_mfma_f32_32x32x16_bf16 v[16:31], v[80:83], v[152:155], 0
    v_mfma_f32_32x32x16_bf16 v[16:31], v[84:87], v[156:159], v[16:31]
    v_mfma_f32_32x32x16_bf16 v[16:31], v[88:91], v[160:163], v[16:31]
    v_mfma_f32_32x32x16_bf16 v[16:31], v[92:95], v[164:167], v[16:31]
    v_mfma_f32_32x32x16_bf16 v[16:31], v[96:99], v[216:219], v[16:31]
    v_mfma_f32_32x32x16_bf16 v[16:31], v[100:103], v[220:223], v[16:31]
    v_mfma_f32_32x32x16_bf16 v[16:31], v[104:107], v[224:227], v[16:31]
    v_mfma_f32_32x32x16_bf16 v[16:31], v[108:111], v[228:231], v[16:31]
    v_mfma_f32_32x32x16_bf16 v[32:47], v[96:99], v[152:155], 0
    v_mfma_f32_32x32x16_bf16 v[32:47], v[100:103], v[156:159], v[32:47]
    v_mfma_f32_32x32x16_bf16 v[32:47], v[104:107], v[160:163], v[32:47]
    v_mfma_f32_32x32x16_bf16 v[32:47], v[108:111], v[164:167], v[32:47]
    v_mfma_f32_32x32x16_bf16 v[32:47], v[80:83], v[184:187], v[32:47]
    v_mfma_f32_32x32x16_bf16 v[32:47], v[84:87], v[188:191], v[32:47]
    v_mfma_f32_32x32x16_bf16 v[32:47], v[88:91], v[192:195], v[32:47]
    v_mfma_f32_32x32x16_bf16 v[32:47], v[92:95], v[196:199], v[32:47]
    v_mfma_f32_32x32x16_bf16 v[48:63], v[80:83], v[168:171], 0
    v_mfma_f32_32x32x16_bf16 v[48:63], v[84:87], v[172:175], v[48:63]
    v_mfma_f32_32x32x16_bf16 v[48:63], v[88:91], v[176:179], v[48:63]
    v_mfma_f32_32x32x16_bf16 v[48:63], v[92:95], v[180:183], v[48:63]
    v_mfma_f32_32x32x16_bf16 v[48:63], v[96:99], v[232:235], v[48:63]
    v_mfma_f32_32x32x16_bf16 v[48:63], v[100:103], v[236:239], v[48:63]
    v_mfma_f32_32x32x16_bf16 v[48:63], v[104:107], v[240:243], v[48:63]
    v_mfma_f32_32x32x16_bf16 v[48:63], v[108:111], v[244:247], v[48:63]
    v_mfma_f32_32x32x16_bf16 v[64:79], v[96:99], v[168:171], 0
    v_mfma_f32_32x32x16_bf16 v[64:79], v[100:103], v[172:175], v[64:79]
    v_mfma_f32_32x32x16_bf16 v[64:79], v[104:107], v[176:179], v[64:79]
    v_mfma_f32_32x32x16_bf16 v[64:79], v[108:111], v[180:183], v[64:79]
    v_mfma_f32_32x32x16_bf16 v[64:79], v[80:83], v[200:203], v[64:79]
    v_mfma_f32_32x32x16_bf16 v[64:79], v[84:87], v[204:207], v[64:79]
    v_mfma_f32_32x32x16_bf16 v[64:79], v[88:91], v[208:211], v[64:79]
    v_mfma_f32_32x32x16_bf16 v[64:79], v[92:95], v[212:215], v[64:79]
    v_lshrrev_b32 v113, 5, v2
    v_lshlrev_b32 v113, 2, v113
    v_cvt_f32_u32 v113, v113
    v_and_b32 v112, 31, v2
    v_cvt_f32_u32 v112, v112
    v_mul_f32 v112, 0x3a000000, v112
    v_add_f32 v116, 0x00000000, v113
    v_mul_f32 v116, v116, v112
    v_cos_f32 v117, v116
    v_sin_f32 v118, v116
    s_nop 0
    v_mul_f32 v119, v32, v118
    v_mul_f32 v32, v32, v117
    v_fma_f32 v32, v16, v118, v32
    v_fma_f32 v16, v16, v117, -v119
    v_add_f32 v120, 0x3f800000, v113
    v_mul_f32 v120, v120, v112
    v_cos_f32 v121, v120
    v_sin_f32 v122, v120
    s_nop 0
    v_mul_f32 v123, v33, v122
    v_mul_f32 v33, v33, v121
    v_fma_f32 v33, v17, v122, v33
    v_fma_f32 v17, v17, v121, -v123
    v_add_f32 v116, 0x40000000, v113
    v_mul_f32 v116, v116, v112
    v_cos_f32 v117, v116
    v_sin_f32 v118, v116
    s_nop 0
    v_mul_f32 v119, v34, v118
    v_mul_f32 v34, v34, v117
    v_fma_f32 v34, v18, v118, v34
    v_fma_f32 v18, v18, v117, -v119
    v_add_f32 v120, 0x40400000, v113
    v_mul_f32 v120, v120, v112
    v_cos_f32 v121, v120
    v_sin_f32 v122, v120
    s_nop 0
    v_mul_f32 v123, v35, v122
    v_mul_f32 v35, v35, v121
    v_fma_f32 v35, v19, v122, v35
    v_fma_f32 v19, v19, v121, -v123
    v_add_f32 v116, 0x41000000, v113
    v_mul_f32 v116, v116, v112
    v_cos_f32 v117, v116
    v_sin_f32 v118, v116
    s_nop 0
    v_mul_f32 v119, v36, v118
    v_mul_f32 v36, v36, v117
    v_fma_f32 v36, v20, v118, v36
    v_fma_f32 v20, v20, v117, -v119
    v_add_f32 v120, 0x41100000, v113
    v_mul_f32 v120, v120, v112
    v_cos_f32 v121, v120
    v_sin_f32 v122, v120
    s_nop 0
    v_mul_f32 v123, v37, v122
    v_mul_f32 v37, v37, v121
    v_fma_f32 v37, v21, v122, v37
    v_fma_f32 v21, v21, v121, -v123
    v_add_f32 v116, 0x41200000, v113
    v_mul_f32 v116, v116, v112
    v_cos_f32 v117, v116
    v_sin_f32 v118, v116
    s_nop 0
    v_mul_f32 v119, v38, v118
    v_mul_f32 v38, v38, v117
    v_fma_f32 v38, v22, v118, v38
    v_fma_f32 v22, v22, v117, -v119
    v_add_f32 v120, 0x41300000, v113
    v_mul_f32 v120, v120, v112
    v_cos_f32 v121, v120
    v_sin_f32 v122, v120
    s_nop 0
    v_mul_f32 v123, v39, v122
    v_mul_f32 v39, v39, v121
    v_fma_f32 v39, v23, v122, v39
    v_fma_f32 v23, v23, v121, -v123
    v_add_f32 v116, 0x41800000, v113
    v_mul_f32 v116, v116, v112
    v_cos_f32 v117, v116
    v_sin_f32 v118, v116
    s_nop 0
    v_mul_f32 v119, v40, v118
    v_mul_f32 v40, v40, v117
    v_fma_f32 v40, v24, v118, v40
    v_fma_f32 v24, v24, v117, -v119
    v_add_f32 v120, 0x41880000, v113
    v_mul_f32 v120, v120, v112
    v_cos_f32 v121, v120
    v_sin_f32 v122, v120
    s_nop 0
    v_mul_f32 v123, v41, v122
    v_mul_f32 v41, v41, v121
    v_fma_f32 v41, v25, v122, v41
    v_fma_f32 v25, v25, v121, -v123
    v_add_f32 v116, 0x41900000, v113
    v_mul_f32 v116, v116, v112
    v_cos_f32 v117, v116
    v_sin_f32 v118, v116
    s_nop 0
    v_mul_f32 v119, v42, v118
    v_mul_f32 v42, v42, v117
    v_fma_f32 v42, v26, v118, v42
    v_fma_f32 v26, v26, v117, -v119
    v_add_f32 v120, 0x41980000, v113
    v_mul_f32 v120, v120, v112
    v_cos_f32 v121, v120
    v_sin_f32 v122, v120
    s_nop 0
    v_mul_f32 v123, v43, v122
    v_mul_f32 v43, v43, v121
    v_fma_f32 v43, v27, v122, v43
    v_fma_f32 v27, v27, v121, -v123
    v_add_f32 v116, 0x41c00000, v113
    v_mul_f32 v116, v116, v112
    v_cos_f32 v117, v116
    v_sin_f32 v118, v116
    s_nop 0
    v_mul_f32 v119, v44, v118
    v_mul_f32 v44, v44, v117
    v_fma_f32 v44, v28, v118, v44
    v_fma_f32 v28, v28, v117, -v119
    v_add_f32 v120, 0x41c80000, v113
    v_mul_f32 v120, v120, v112
    v_cos_f32 v121, v120
    v_sin_f32 v122, v120
    s_nop 0
    v_mul_f32 v123, v45, v122
    v_mul_f32 v45, v45, v121
    v_fma_f32 v45, v29, v122, v45
    v_fma_f32 v29, v29, v121, -v123
    v_add_f32 v116, 0x41d00000, v113
    v_mul_f32 v116, v116, v112
    v_cos_f32 v117, v116
    v_sin_f32 v118, v116
    s_nop 0
    v_mul_f32 v119, v46, v118
    v_mul_f32 v46, v46, v117
    v_fma_f32 v46, v30, v118, v46
    v_fma_f32 v30, v30, v117, -v119
    v_add_f32 v120, 0x41d80000, v113
    v_mul_f32 v120, v120, v112
    v_cos_f32 v121, v120
    v_sin_f32 v122, v120
    s_nop 0
    v_mul_f32 v123, v47, v122
    v_mul_f32 v47, v47, v121
    v_fma_f32 v47, v31, v122, v47
    v_fma_f32 v31, v31, v121, -v123
    v_add_f32 v112, 0x3c800000, v112
    v_add_f32 v116, 0x00000000, v113
    v_mul_f32 v116, v116, v112
    v_cos_f32 v117, v116
    v_sin_f32 v118, v116
    s_nop 0
    v_mul_f32 v119, v64, v118
    v_mul_f32 v64, v64, v117
    v_fma_f32 v64, v48, v118, v64
    v_fma_f32 v48, v48, v117, -v119
    v_add_f32 v120, 0x3f800000, v113
    v_mul_f32 v120, v120, v112
    v_cos_f32 v121, v120
    v_sin_f32 v122, v120
    s_nop 0
    v_mul_f32 v123, v65, v122
    v_mul_f32 v65, v65, v121
    v_fma_f32 v65, v49, v122, v65
    v_fma_f32 v49, v49, v121, -v123
    v_add_f32 v116, 0x40000000, v113
    v_mul_f32 v116, v116, v112
    v_cos_f32 v117, v116
    v_sin_f32 v118, v116
    s_nop 0
    v_mul_f32 v119, v66, v118
    v_mul_f32 v66, v66, v117
    v_fma_f32 v66, v50, v118, v66
    v_fma_f32 v50, v50, v117, -v119
    v_add_f32 v120, 0x40400000, v113
    v_mul_f32 v120, v120, v112
    v_cos_f32 v121, v120
    v_sin_f32 v122, v120
    s_nop 0
    v_mul_f32 v123, v67, v122
    v_mul_f32 v67, v67, v121
    v_fma_f32 v67, v51, v122, v67
    v_fma_f32 v51, v51, v121, -v123
    v_add_f32 v116, 0x41000000, v113
    v_mul_f32 v116, v116, v112
    v_cos_f32 v117, v116
    v_sin_f32 v118, v116
    s_nop 0
    v_mul_f32 v119, v68, v118
    v_mul_f32 v68, v68, v117
    v_fma_f32 v68, v52, v118, v68
    v_fma_f32 v52, v52, v117, -v119
    v_add_f32 v120, 0x41100000, v113
    v_mul_f32 v120, v120, v112
    v_cos_f32 v121, v120
    v_sin_f32 v122, v120
    s_nop 0
    v_mul_f32 v123, v69, v122
    v_mul_f32 v69, v69, v121
    v_fma_f32 v69, v53, v122, v69
    v_fma_f32 v53, v53, v121, -v123
    v_add_f32 v116, 0x41200000, v113
    v_mul_f32 v116, v116, v112
    v_cos_f32 v117, v116
    v_sin_f32 v118, v116
    s_nop 0
    v_mul_f32 v119, v70, v118
    v_mul_f32 v70, v70, v117
    v_fma_f32 v70, v54, v118, v70
    v_fma_f32 v54, v54, v117, -v119
    v_add_f32 v120, 0x41300000, v113
    v_mul_f32 v120, v120, v112
    v_cos_f32 v121, v120
    v_sin_f32 v122, v120
    s_nop 0
    v_mul_f32 v123, v71, v122
    v_mul_f32 v71, v71, v121
    v_fma_f32 v71, v55, v122, v71
    v_fma_f32 v55, v55, v121, -v123
    v_add_f32 v116, 0x41800000, v113
    v_mul_f32 v116, v116, v112
    v_cos_f32 v117, v116
    v_sin_f32 v118, v116
    s_nop 0
    v_mul_f32 v119, v72, v118
    v_mul_f32 v72, v72, v117
    v_fma_f32 v72, v56, v118, v72
    v_fma_f32 v56, v56, v117, -v119
    v_add_f32 v120, 0x41880000, v113
    v_mul_f32 v120, v120, v112
    v_cos_f32 v121, v120
    v_sin_f32 v122, v120
    s_nop 0
    v_mul_f32 v123, v73, v122
    v_mul_f32 v73, v73, v121
    v_fma_f32 v73, v57, v122, v73
    v_fma_f32 v57, v57, v121, -v123
    v_add_f32 v116, 0x41900000, v113
    v_mul_f32 v116, v116, v112
    v_cos_f32 v117, v116
    v_sin_f32 v118, v116
    s_nop 0
    v_mul_f32 v119, v74, v118
    v_mul_f32 v74, v74, v117
    v_fma_f32 v74, v58, v118, v74
    v_fma_f32 v58, v58, v117, -v119
    v_add_f32 v120, 0x41980000, v113
    v_mul_f32 v120, v120, v112
    v_cos_f32 v121, v120
    v_sin_f32 v122, v120
    s_nop 0
    v_mul_f32 v123, v75, v122
    v_mul_f32 v75, v75, v121
    v_fma_f32 v75, v59, v122, v75
    v_fma_f32 v59, v59, v121, -v123
    v_add_f32 v116, 0x41c00000, v113
    v_mul_f32 v116, v116, v112
    v_cos_f32 v117, v116
    v_sin_f32 v118, v116
    s_nop 0
    v_mul_f32 v119, v76, v118
    v_mul_f32 v76, v76, v117
    v_fma_f32 v76, v60, v118, v76
    v_fma_f32 v60, v60, v117, -v119
    v_add_f32 v120, 0x41c80000, v113
    v_mul_f32 v120, v120, v112
    v_cos_f32 v121, v120
    v_sin_f32 v122, v120
    s_nop 0
    v_mul_f32 v123, v77, v122
    v_mul_f32 v77, v77, v121
    v_fma_f32 v77, v61, v122, v77
    v_fma_f32 v61, v61, v121, -v123
    v_add_f32 v116, 0x41d00000, v113
    v_mul_f32 v116, v116, v112
    v_cos_f32 v117, v116
    v_sin_f32 v118, v116
    s_nop 0
    v_mul_f32 v119, v78, v118
    v_mul_f32 v78, v78, v117
    v_fma_f32 v78, v62, v118, v78
    v_fma_f32 v62, v62, v117, -v119
    v_add_f32 v120, 0x41d80000, v113
    v_mul_f32 v120, v120, v112
    v_cos_f32 v121, v120
    v_sin_f32 v122, v120
    s_nop 0
    v_mul_f32 v123, v79, v122
    v_mul_f32 v79, v79, v121
    v_fma_f32 v79, v63, v122, v79
    v_fma_f32 v63, v63, v121, -v123
    v_cvt_pk_bf16_f32 v80, v16, v17
    v_cvt_pk_bf16_f32 v96, v32, v33
    v_cvt_pk_bf16_f32 v81, v18, v19
    v_cvt_pk_bf16_f32 v97, v34, v35
    v_cvt_pk_bf16_f32 v82, v20, v21
    v_cvt_pk_bf16_f32 v98, v36, v37
    v_cvt_pk_bf16_f32 v83, v22, v23
    v_cvt_pk_bf16_f32 v99, v38, v39
    v_cvt_pk_bf16_f32 v84, v24, v25
    v_cvt_pk_bf16_f32 v100, v40, v41
    v_cvt_pk_bf16_f32 v85, v26, v27
    v_cvt_pk_bf16_f32 v101, v42, v43
    v_cvt_pk_bf16_f32 v86, v28, v29
    v_cvt_pk_bf16_f32 v102, v44, v45
    v_cvt_pk_bf16_f32 v87, v30, v31
    v_cvt_pk_bf16_f32 v103, v46, v47
    v_cvt_pk_bf16_f32 v88, v48, v49
    v_cvt_pk_bf16_f32 v104, v64, v65
    v_cvt_pk_bf16_f32 v89, v50, v51
    v_cvt_pk_bf16_f32 v105, v66, v67
    v_cvt_pk_bf16_f32 v90, v52, v53
    v_cvt_pk_bf16_f32 v106, v68, v69
    v_cvt_pk_bf16_f32 v91, v54, v55
    v_cvt_pk_bf16_f32 v107, v70, v71
    v_cvt_pk_bf16_f32 v92, v56, v57
    v_cvt_pk_bf16_f32 v108, v72, v73
    v_cvt_pk_bf16_f32 v93, v58, v59
    v_cvt_pk_bf16_f32 v109, v74, v75
    v_cvt_pk_bf16_f32 v94, v60, v61
    v_cvt_pk_bf16_f32 v110, v76, v77
    v_cvt_pk_bf16_f32 v95, v62, v63
    v_cvt_pk_bf16_f32 v111, v78, v79
    v_mfma_f32_32x32x16_bf16 v[16:31], v[80:83], v[128:131], 0
    v_mfma_f32_32x32x16_bf16 v[16:31], v[84:87], v[132:135], v[16:31]
    v_mfma_f32_32x32x16_bf16 v[16:31], v[96:99], v[144:147], v[16:31]
    v_mfma_f32_32x32x16_bf16 v[16:31], v[100:103], v[148:151], v[16:31]
    v_mfma_f32_32x32x16_bf16 v[32:47], v[96:99], v[128:131], 0
    v_mfma_f32_32x32x16_bf16 v[32:47], v[100:103], v[132:135], v[32:47]
    v_mfma_f32_32x32x16_bf16 v[32:47], v[80:83], v[136:139], v[32:47]
    v_mfma_f32_32x32x16_bf16 v[32:47], v[84:87], v[140:143], v[32:47]
    v_mfma_f32_32x32x16_bf16 v[48:63], v[88:91], v[128:131], 0
    v_mfma_f32_32x32x16_bf16 v[48:63], v[92:95], v[132:135], v[48:63]
    v_mfma_f32_32x32x16_bf16 v[48:63], v[104:107], v[144:147], v[48:63]
    v_mfma_f32_32x32x16_bf16 v[48:63], v[108:111], v[148:151], v[48:63]
    v_mfma_f32_32x32x16_bf16 v[64:79], v[104:107], v[128:131], 0
    v_mfma_f32_32x32x16_bf16 v[64:79], v[108:111], v[132:135], v[64:79]
    v_mfma_f32_32x32x16_bf16 v[64:79], v[88:91], v[136:139], v[64:79]
    v_mfma_f32_32x32x16_bf16 v[64:79], v[92:95], v[140:143], v[64:79]
    v_mul_f32 v16, s56, v16
    v_mul_f32 v17, s56, v17
    v_mul_f32 v18, s56, v18
    v_mul_f32 v19, s56, v19
    v_mul_f32 v20, s56, v20
    v_mul_f32 v21, s56, v21
    v_mul_f32 v22, s56, v22
    v_mul_f32 v23, s56, v23
    v_mul_f32 v24, s56, v24
    v_mul_f32 v25, s56, v25
    v_mul_f32 v26, s56, v26
    v_mul_f32 v27, s56, v27
    v_mul_f32 v28, s56, v28
    v_mul_f32 v29, s56, v29
    v_mul_f32 v30, s56, v30
    v_mul_f32 v31, s56, v31
    v_mul_f32 v32, s56, v32
    v_mul_f32 v33, s56, v33
    v_mul_f32 v34, s56, v34
    v_mul_f32 v35, s56, v35
    v_mul_f32 v36, s56, v36
    v_mul_f32 v37, s56, v37
    v_mul_f32 v38, s56, v38
    v_mul_f32 v39, s56, v39
    v_mul_f32 v40, s56, v40
    v_mul_f32 v41, s56, v41
    v_mul_f32 v42, s56, v42
    v_mul_f32 v43, s56, v43
    v_mul_f32 v44, s56, v44
    v_mul_f32 v45, s56, v45
    v_mul_f32 v46, s56, v46
    v_mul_f32 v47, s56, v47
    v_mul_f32 v48, s56, v48
    v_mul_f32 v49, s56, v49
    v_mul_f32 v50, s56, v50
    v_mul_f32 v51, s56, v51
    v_mul_f32 v52, s56, v52
    v_mul_f32 v53, s56, v53
    v_mul_f32 v54, s56, v54
    v_mul_f32 v55, s56, v55
    v_mul_f32 v56, s56, v56
    v_mul_f32 v57, s56, v57
    v_mul_f32 v58, s56, v58
    v_mul_f32 v59, s56, v59
    v_mul_f32 v60, s56, v60
    v_mul_f32 v61, s56, v61
    v_mul_f32 v62, s56, v62
    v_mul_f32 v63, s56, v63
    v_mul_f32 v64, s56, v64
    v_mul_f32 v65, s56, v65
    v_mul_f32 v66, s56, v66
    v_mul_f32 v67, s56, v67
    v_mul_f32 v68, s56, v68
    v_mul_f32 v69, s56, v69
    v_mul_f32 v70, s56, v70
    v_mul_f32 v71, s56, v71
    v_mul_f32 v72, s56, v72
    v_mul_f32 v73, s56, v73
    v_mul_f32 v74, s56, v74
    v_mul_f32 v75, s56, v75
    v_mul_f32 v76, s56, v76
    v_mul_f32 v77, s56, v77
    v_mul_f32 v78, s56, v78
    v_mul_f32 v79, s56, v79
    v_cvt_pk_bf16_f32 v80, v16, v17
    v_cvt_pk_bf16_f32 v96, v32, v33
    v_cvt_pk_bf16_f32 v81, v18, v19
    v_cvt_pk_bf16_f32 v97, v34, v35
    v_cvt_pk_bf16_f32 v82, v20, v21
    v_cvt_pk_bf16_f32 v98, v36, v37
    v_cvt_pk_bf16_f32 v83, v22, v23
    v_cvt_pk_bf16_f32 v99, v38, v39
    v_cvt_pk_bf16_f32 v84, v24, v25
    v_cvt_pk_bf16_f32 v100, v40, v41
    v_cvt_pk_bf16_f32 v85, v26, v27
    v_cvt_pk_bf16_f32 v101, v42, v43
    v_cvt_pk_bf16_f32 v86, v28, v29
    v_cvt_pk_bf16_f32 v102, v44, v45
    v_cvt_pk_bf16_f32 v87, v30, v31
    v_cvt_pk_bf16_f32 v103, v46, v47
    v_cvt_pk_bf16_f32 v88, v48, v49
    v_cvt_pk_bf16_f32 v104, v64, v65
    v_cvt_pk_bf16_f32 v89, v50, v51
    v_cvt_pk_bf16_f32 v105, v66, v67
    v_cvt_pk_bf16_f32 v90, v52, v53
    v_cvt_pk_bf16_f32 v106, v68, v69
    v_cvt_pk_bf16_f32 v91, v54, v55
    v_cvt_pk_bf16_f32 v107, v70, v71
    v_cvt_pk_bf16_f32 v92, v56, v57
    v_cvt_pk_bf16_f32 v108, v72, v73
    v_cvt_pk_bf16_f32 v93, v58, v59
    v_cvt_pk_bf16_f32 v109, v74, v75
    v_cvt_pk_bf16_f32 v94, v60, v61
    v_cvt_pk_bf16_f32 v110, v76, v77
    v_cvt_pk_bf16_f32 v95, v62, v63
    v_cvt_pk_bf16_f32 v111, v78, v79
    s_add_u32 s51, s50, 63963136
    buffer_store_dwordx4 v[80:83], v3, s[36:39], s51 offen offset:0 sc1
    buffer_store_dwordx4 v[84:87], v3, s[36:39], s51 offen offset:1024 sc1
    buffer_store_dwordx4 v[88:91], v3, s[36:39], s51 offen offset:2048 sc1
    buffer_store_dwordx4 v[92:95], v3, s[36:39], s51 offen offset:3072 sc1
    buffer_store_dwordx4 v[96:99], v9, s[36:39], s51 offen offset:0 sc1
    buffer_store_dwordx4 v[100:103], v9, s[36:39], s51 offen offset:1024 sc1
    buffer_store_dwordx4 v[104:107], v9, s[36:39], s51 offen offset:2048 sc1
    buffer_store_dwordx4 v[108:111], v9, s[36:39], s51 offen offset:3072 sc1
PA2_END:
    s_waitcnt vmcnt(0)
    s_barrier
    s_cmp_lg_u32 s44, 0
    s_cbranch_scc1 PA_ARR_2
    v_mov_b32 v4, 1
    v_mov_b32 v5, 16
    s_mov_b64 exec, 1
    global_atomic_add v5, v4, s[30:31]
    s_mov_b64 exec, -1
PA_ARR_2:
    s_cmp_ge_u32 s48, 64
    s_cbranch_scc1 OP
    v_lshrrev_b32 v4, 4, v2
    v_lshlrev_b32 v5, 2, v4
    v_and_b32 v6, 15, v2
    v_xor_b32 v5, v5, v6
    v_lshlrev_b32 v5, 4, v5
    s_lshl_b32 s51, s44, 2
    v_add_u32 v6, s51, v4
    v_lshl_add_u32 v7, v6, 12, v5
    v_bfe_u32 v5, v2, 2, 2
    v_and_b32 v6, 1, v4
    v_lshl_add_u32 v6, v5, 1, v6
    v_lshlrev_b32 v6, 5, v6
    v_lshl_add_u32 v6, v5, 8, v6
    v_and_b32 v5, 3, v2
    v_lshl_add_u32 v6, v5, 3, v6
    v_lshrrev_b32 v4, 1, v4
    v_lshl_add_u32 v8, v4, 11, v6
    v_xor_b32 v9, 64, v8
    v_xor_b32 v10, 128, v8
    v_xor_b32 v11, 192, v8
    v_add_u32 v12, 0x10000, v8
    v_add_u32 v13, 0x10000, v9
    v_add_u32 v14, 0x10000, v10
    v_add_u32 v15, 0x10000, v11
    s_and_b32 s51, s48, 3
    s_lshl_b32 s51, s51, 2
    s_add_u32 s51, s51, s44
    s_lshl_b32 s58, s51, 5
    v_and_b32 v4, 3, v2
    v_bfe_u32 v5, v2, 2, 1
    v_lshl_add_u32 v6, v5, 4, v4
    v_bfe_u32 v112, v2, 3, 2
    v_lshl_add_u32 v6, v112, 2, v6
    v_add_u32 v6, s58, v6
    v_lshl_add_u32 v3, v5, 3, v4
    v_lshl_add_u32 v3, v112, 6, v3
    v_lshrrev_b32 v5, 5, v2
    v_lshlrev_b32 v3, 11, v3
    v_lshl_add_u32 v3, v5, 5, v3
    v_cvt_f32_u32 v112, v6
    v_mul_f32 v112, 0x3b000000, v112
    v_lshlrev_b32 v5, 2, v5
    v_cvt_f32_u32 v113, v5
    v_mul_f32 v113, v113, v112
    v_mul_f32 v6, 0x41000000, v112
    v_mul_f32 v4, 0x43800000, v112
    v_fract_f32 v4, v4
    v_cmp_gt_u32 vcc, 32, v2
    v_fract_f32 v120, v113
    v_add_f32 v122, v120, v112
    v_add_f32 v124, v122, v112
    v_add_f32 v126, v124, v112
    v_add_f32 v121, 0x3e800000, v120
    v_add_f32 v123, 0x3e800000, v122
    v_add_f32 v125, 0x3e800000, v124
    v_add_f32 v127, 0x3e800000, v126
    v_add_f32 v113, v120, v6
    v_cndmask_b32 v121, v121, v4, vcc
    v_cos_f32 v120, v120
    v_cos_f32 v121, v121
    v_cos_f32 v122, v122
    v_cos_f32 v123, v123
    v_cos_f32 v124, v124
    v_cos_f32 v125, v125
    v_cos_f32 v126, v126
    v_cos_f32 v127, v127
    v_cvt_pk_bf16_f32 v128, v120, v121
    v_cvt_pk_bf16_f32 v129, v122, v123
    v_cvt_pk_bf16_f32 v130, v124, v125
    v_cvt_pk_bf16_f32 v131, v126, v127
    v_fract_f32 v120, v113
    v_add_f32 v122, v120, v112
    v_add_f32 v124, v122, v112
    v_add_f32 v126, v124, v112
    v_add_f32 v121, 0x3e800000, v120
    v_add_f32 v123, 0x3e800000, v122
    v_add_f32 v125, 0x3e800000, v124
    v_add_f32 v127, 0x3e800000, v126
    v_add_f32 v113, v120, v6
    v_cos_f32 v120, v120
    v_cos_f32 v121, v121
    v_cos_f32 v122, v122
    v_cos_f32 v123, v123
    v_cos_f32 v124, v124
    v_cos_f32 v125, v125
    v_cos_f32 v126, v126
    v_cos_f32 v127, v127
    v_cvt_pk_bf16_f32 v132, v120, v121
    v_cvt_pk_bf16_f32 v133, v122, v123
    v_cvt_pk_bf16_f32 v134, v124, v125
    v_cvt_pk_bf16_f32 v135, v126, v127
    v_fract_f32 v120, v113
    v_add_f32 v122, v120, v112
    v_add_f32 v124, v122, v112
    v_add_f32 v126, v124, v112
    v_add_f32 v121, 0x3e800000, v120
    v_add_f32 v123, 0x3e800000, v122
    v_add_f32 v125, 0x3e800000, v124
    v_add_f32 v127, 0x3e800000, v126
    v_add_f32 v113, v120, v6
    v_cos_f32 v120, v120
    v_cos_f32 v121, v121
    v_cos_f32 v122, v122
    v_cos_f32 v123, v123
    v_cos_f32 v124, v124
    v_cos_f32 v125, v125
    v_cos_f32 v126, v126
    v_cos_f32 v127, v127
    v_cvt_pk_bf16_f32 v136, v120, v121
    v_cvt_pk_bf16_f32 v137, v122, v123
    v_cvt_pk_bf16_f32 v138, v124, v125
    v_cvt_pk_bf16_f32 v139, v126, v127
    v_fract_f32 v120, v113
    v_add_f32 v122, v120, v112
    v_add_f32 v124, v122, v112
    v_add_f32 v126, v124, v112
    v_add_f32 v121, 0x3e800000, v120
    v_add_f32 v123, 0x3e800000, v122
    v_add_f32 v125, 0x3e800000, v124
    v_add_f32 v127, 0x3e800000, v126
    v_add_f32 v113, v120, v6
    v_cos_f32 v120, v120
    v_cos_f32 v121, v121
    v_cos_f32 v122, v122
    v_cos_f32 v123, v123
    v_cos_f32 v124, v124
    v_cos_f32 v125, v125
    v_cos_f32 v126, v126
    v_cos_f32 v127, v127
    v_cvt_pk_bf16_f32 v140, v120, v121
    v_cvt_pk_bf16_f32 v141, v122, v123
    v_cvt_pk_bf16_f32 v142, v124, v125
    v_cvt_pk_bf16_f32 v143, v126, v127
    v_fract_f32 v120, v113
    v_add_f32 v122, v120, v112
    v_add_f32 v124, v122, v112
    v_add_f32 v126, v124, v112
    v_add_f32 v121, 0x3e800000, v120
    v_add_f32 v123, 0x3e800000, v122
    v_add_f32 v125, 0x3e800000, v124
    v_add_f32 v127, 0x3e800000, v126
    v_add_f32 v113, v120, v6
    v_cos_f32 v120, v120
    v_cos_f32 v121, v121
    v_cos_f32 v122, v122
    v_cos_f32 v123, v123
    v_cos_f32 v124, v124
    v_cos_f32 v125, v125
    v_cos_f32 v126, v126
    v_cos_f32 v127, v127
    v_cvt_pk_bf16_f32 v144, v120, v121
    v_cvt_pk_bf16_f32 v145, v122, v123
    v_cvt_pk_bf16_f32 v146, v124, v125
    v_cvt_pk_bf16_f32 v147, v126, v127
    v_fract_f32 v120, v113
    v_add_f32 v122, v120, v112
    v_add_f32 v124, v122, v112
    v_add_f32 v126, v124, v112
    v_add_f32 v121, 0x3e800000, v120
    v_add_f32 v123, 0x3e800000, v122
    v_add_f32 v125, 0x3e800000, v124
    v_add_f32 v127, 0x3e800000, v126
    v_add_f32 v113, v120, v6
    v_cos_f32 v120, v120
    v_cos_f32 v121, v121
    v_cos_f32 v122, v122
    v_cos_f32 v123, v123
    v_cos_f32 v124, v124
    v_cos_f32 v125, v125
    v_cos_f32 v126, v126
    v_cos_f32 v127, v127
    v_cvt_pk_bf16_f32 v148, v120, v121
    v_cvt_pk_bf16_f32 v149, v122, v123
    v_cvt_pk_bf16_f32 v150, v124, v125
    v_cvt_pk_bf16_f32 v151, v126, v127
    v_fract_f32 v120, v113
    v_add_f32 v122, v120, v112
    v_add_f32 v124, v122, v112
    v_add_f32 v126, v124, v112
    v_add_f32 v121, 0x3e800000, v120
    v_add_f32 v123, 0x3e800000, v122
    v_add_f32 v125, 0x3e800000, v124
    v_add_f32 v127, 0x3e800000, v126
    v_add_f32 v113, v120, v6
    v_cos_f32 v120, v120
    v_cos_f32 v121, v121
    v_cos_f32 v122, v122
    v_cos_f32 v123, v123
    v_cos_f32 v124, v124
    v_cos_f32 v125, v125
    v_cos_f32 v126, v126
    v_cos_f32 v127, v127
    v_cvt_pk_bf16_f32 v152, v120, v121
    v_cvt_pk_bf16_f32 v153, v122, v123
    v_cvt_pk_bf16_f32 v154, v124, v125
    v_cvt_pk_bf16_f32 v155, v126, v127
    v_fract_f32 v120, v113
    v_add_f32 v122, v120, v112
    v_add_f32 v124, v122, v112
    v_add_f32 v126, v124, v112
    v_add_f32 v121, 0x3e800000, v120
    v_add_f32 v123, 0x3e800000, v122
    v_add_f32 v125, 0x3e800000, v124
    v_add_f32 v127, 0x3e800000, v126
    v_add_f32 v113, v120, v6
    v_cos_f32 v120, v120
    v_cos_f32 v121, v121
    v_cos_f32 v122, v122
    v_cos_f32 v123, v123
    v_cos_f32 v124, v124
    v_cos_f32 v125, v125
    v_cos_f32 v126, v126
    v_cos_f32 v127, v127
    v_cvt_pk_bf16_f32 v156, v120, v121
    v_cvt_pk_bf16_f32 v157, v122, v123
    v_cvt_pk_bf16_f32 v158, v124, v125
    v_cvt_pk_bf16_f32 v159, v126, v127
    v_fract_f32 v120, v113
    v_add_f32 v122, v120, v112
    v_add_f32 v124, v122, v112
    v_add_f32 v126, v124, v112
    v_add_f32 v121, 0x3e800000, v120
    v_add_f32 v123, 0x3e800000, v122
    v_add_f32 v125, 0x3e800000, v124
    v_add_f32 v127, 0x3e800000, v126
    v_add_f32 v113, v120, v6
    v_cos_f32 v120, v120
    v_cos_f32 v121, v121
    v_cos_f32 v122, v122
    v_cos_f32 v123, v123
    v_cos_f32 v124, v124
    v_cos_f32 v125, v125
    v_cos_f32 v126, v126
    v_cos_f32 v127, v127
    v_cvt_pk_bf16_f32 v160, v120, v121
    v_cvt_pk_bf16_f32 v161, v122, v123
    v_cvt_pk_bf16_f32 v162, v124, v125
    v_cvt_pk_bf16_f32 v163, v126, v127
    v_fract_f32 v120, v113
    v_add_f32 v122, v120, v112
    v_add_f32 v124, v122, v112
    v_add_f32 v126, v124, v112
    v_add_f32 v121, 0x3e800000, v120
    v_add_f32 v123, 0x3e800000, v122
    v_add_f32 v125, 0x3e800000, v124
    v_add_f32 v127, 0x3e800000, v126
    v_add_f32 v113, v120, v6
    v_cos_f32 v120, v120
    v_cos_f32 v121, v121
    v_cos_f32 v122, v122
    v_cos_f32 v123, v123
    v_cos_f32 v124, v124
    v_cos_f32 v125, v125
    v_cos_f32 v126, v126
    v_cos_f32 v127, v127
    v_cvt_pk_bf16_f32 v164, v120, v121
    v_cvt_pk_bf16_f32 v165, v122, v123
    v_cvt_pk_bf16_f32 v166, v124, v125
    v_cvt_pk_bf16_f32 v167, v126, v127
    v_fract_f32 v120, v113
    v_add_f32 v122, v120, v112
    v_add_f32 v124, v122, v112
    v_add_f32 v126, v124, v112
    v_add_f32 v121, 0x3e800000, v120
    v_add_f32 v123, 0x3e800000, v122
    v_add_f32 v125, 0x3e800000, v124
    v_add_f32 v127, 0x3e800000, v126
    v_add_f32 v113, v120, v6
    v_cos_f32 v120, v120
    v_cos_f32 v121, v121
    v_cos_f32 v122, v122
    v_cos_f32 v123, v123
    v_cos_f32 v124, v124
    v_cos_f32 v125, v125
    v_cos_f32 v126, v126
    v_cos_f32 v127, v127
    v_cvt_pk_bf16_f32 v168, v120, v121
    v_cvt_pk_bf16_f32 v169, v122, v123
    v_cvt_pk_bf16_f32 v170, v124, v125
    v_cvt_pk_bf16_f32 v171, v126, v127
    v_fract_f32 v120, v113
    v_add_f32 v122, v120, v112
    v_add_f32 v124, v122, v112
    v_add_f32 v126, v124, v112
    v_add_f32 v121, 0x3e800000, v120
    v_add_f32 v123, 0x3e800000, v122
    v_add_f32 v125, 0x3e800000, v124
    v_add_f32 v127, 0x3e800000, v126
    v_add_f32 v113, v120, v6
    v_cos_f32 v120, v120
    v_cos_f32 v121, v121
    v_cos_f32 v122, v122
    v_cos_f32 v123, v123
    v_cos_f32 v124, v124
    v_cos_f32 v125, v125
    v_cos_f32 v126, v126
    v_cos_f32 v127, v127
    v_cvt_pk_bf16_f32 v172, v120, v121
    v_cvt_pk_bf16_f32 v173, v122, v123
    v_cvt_pk_bf16_f32 v174, v124, v125
    v_cvt_pk_bf16_f32 v175, v126, v127
    v_fract_f32 v120, v113
    v_add_f32 v122, v120, v112
    v_add_f32 v124, v122, v112
    v_add_f32 v126, v124, v112
    v_add_f32 v121, 0x3e800000, v120
    v_add_f32 v123, 0x3e800000, v122
    v_add_f32 v125, 0x3e800000, v124
    v_add_f32 v127, 0x3e800000, v126
    v_add_f32 v113, v120, v6
    v_cos_f32 v120, v120
    v_cos_f32 v121, v121
    v_cos_f32 v122, v122
    v_cos_f32 v123, v123
    v_cos_f32 v124, v124
    v_cos_f32 v125, v125
    v_cos_f32 v126, v126
    v_cos_f32 v127, v127
    v_cvt_pk_bf16_f32 v176, v120, v121
    v_cvt_pk_bf16_f32 v177, v122, v123
    v_cvt_pk_bf16_f32 v178, v124, v125
    v_cvt_pk_bf16_f32 v179, v126, v127
    v_fract_f32 v120, v113
    v_add_f32 v122, v120, v112
    v_add_f32 v124, v122, v112
    v_add_f32 v126, v124, v112
    v_add_f32 v121, 0x3e800000, v120
    v_add_f32 v123, 0x3e800000, v122
    v_add_f32 v125, 0x3e800000, v124
    v_add_f32 v127, 0x3e800000, v126
    v_add_f32 v113, v120, v6
    v_cos_f32 v120, v120
    v_cos_f32 v121, v121
    v_cos_f32 v122, v122
    v_cos_f32 v123, v123
    v_cos_f32 v124, v124
    v_cos_f32 v125, v125
    v_cos_f32 v126, v126
    v_cos_f32 v127, v127
    v_cvt_pk_bf16_f32 v180, v120, v121
    v_cvt_pk_bf16_f32 v181, v122, v123
    v_cvt_pk_bf16_f32 v182, v124, v125
    v_cvt_pk_bf16_f32 v183, v126, v127
    v_fract_f32 v120, v113
    v_add_f32 v122, v120, v112
    v_add_f32 v124, v122, v112
    v_add_f32 v126, v124, v112
    v_add_f32 v121, 0x3e800000, v120
    v_add_f32 v123, 0x3e800000, v122
    v_add_f32 v125, 0x3e800000, v124
    v_add_f32 v127, 0x3e800000, v126
    v_add_f32 v113, v120, v6
    v_cos_f32 v120, v120
    v_cos_f32 v121, v121
    v_cos_f32 v122, v122
    v_cos_f32 v123, v123
    v_cos_f32 v124, v124
    v_cos_f32 v125, v125
    v_cos_f32 v126, v126
    v_cos_f32 v127, v127
    v_cvt_pk_bf16_f32 v184, v120, v121
    v_cvt_pk_bf16_f32 v185, v122, v123
    v_cvt_pk_bf16_f32 v186, v124, v125
    v_cvt_pk_bf16_f32 v187, v126, v127
    v_fract_f32 v120, v113
    v_add_f32 v122, v120, v112
    v_add_f32 v124, v122, v112
    v_add_f32 v126, v124, v112
    v_add_f32 v121, 0x3e800000, v120
    v_add_f32 v123, 0x3e800000, v122
    v_add_f32 v125, 0x3e800000, v124
    v_add_f32 v127, 0x3e800000, v126
    v_add_f32 v113, v120, v6
    v_cos_f32 v120, v120
    v_cos_f32 v121, v121
    v_cos_f32 v122, v122
    v_cos_f32 v123, v123
    v_cos_f32 v124, v124
    v_cos_f32 v125, v125
    v_cos_f32 v126, v126
    v_cos_f32 v127, v127
    v_cvt_pk_bf16_f32 v188, v120, v121
    v_cvt_pk_bf16_f32 v189, v122, v123
    v_cvt_pk_bf16_f32 v190, v124, v125
    v_cvt_pk_bf16_f32 v191, v126, v127
    v_fract_f32 v120, v113
    v_add_f32 v122, v120, v112
    v_add_f32 v124, v122, v112
    v_add_f32 v126, v124, v112
    v_add_f32 v121, 0x3e800000, v120
    v_add_f32 v123, 0x3e800000, v122
    v_add_f32 v125, 0x3e800000, v124
    v_add_f32 v127, 0x3e800000, v126
    v_add_f32 v113, v120, v6
    v_cos_f32 v120, v120
    v_cos_f32 v121, v121
    v_cos_f32 v122, v122
    v_cos_f32 v123, v123
    v_cos_f32 v124, v124
    v_cos_f32 v125, v125
    v_cos_f32 v126, v126
    v_cos_f32 v127, v127
    v_cvt_pk_bf16_f32 v192, v120, v121
    v_cvt_pk_bf16_f32 v193, v122, v123
    v_cvt_pk_bf16_f32 v194, v124, v125
    v_cvt_pk_bf16_f32 v195, v126, v127
    v_fract_f32 v120, v113
    v_add_f32 v122, v120, v112
    v_add_f32 v124, v122, v112
    v_add_f32 v126, v124, v112
    v_add_f32 v121, 0x3e800000, v120
    v_add_f32 v123, 0x3e800000, v122
    v_add_f32 v125, 0x3e800000, v124
    v_add_f32 v127, 0x3e800000, v126
    v_add_f32 v113, v120, v6
    v_cos_f32 v120, v120
    v_cos_f32 v121, v121
    v_cos_f32 v122, v122
    v_cos_f32 v123, v123
    v_cos_f32 v124, v124
    v_cos_f32 v125, v125
    v_cos_f32 v126, v126
    v_cos_f32 v127, v127
    v_cvt_pk_bf16_f32 v196, v120, v121
    v_cvt_pk_bf16_f32 v197, v122, v123
    v_cvt_pk_bf16_f32 v198, v124, v125
    v_cvt_pk_bf16_f32 v199, v126, v127
    v_fract_f32 v120, v113
    v_add_f32 v122, v120, v112
    v_add_f32 v124, v122, v112
    v_add_f32 v126, v124, v112
    v_add_f32 v121, 0x3e800000, v120
    v_add_f32 v123, 0x3e800000, v122
    v_add_f32 v125, 0x3e800000, v124
    v_add_f32 v127, 0x3e800000, v126
    v_add_f32 v113, v120, v6
    v_cos_f32 v120, v120
    v_cos_f32 v121, v121
    v_cos_f32 v122, v122
    v_cos_f32 v123, v123
    v_cos_f32 v124, v124
    v_cos_f32 v125, v125
    v_cos_f32 v126, v126
    v_cos_f32 v127, v127
    v_cvt_pk_bf16_f32 v200, v120, v121
    v_cvt_pk_bf16_f32 v201, v122, v123
    v_cvt_pk_bf16_f32 v202, v124, v125
    v_cvt_pk_bf16_f32 v203, v126, v127
    v_fract_f32 v120, v113
    v_add_f32 v122, v120, v112
    v_add_f32 v124, v122, v112
    v_add_f32 v126, v124, v112
    v_add_f32 v121, 0x3e800000, v120
    v_add_f32 v123, 0x3e800000, v122
    v_add_f32 v125, 0x3e800000, v124
    v_add_f32 v127, 0x3e800000, v126
    v_add_f32 v113, v120, v6
    v_cos_f32 v120, v120
    v_cos_f32 v121, v121
    v_cos_f32 v122, v122
    v_cos_f32 v123, v123
    v_cos_f32 v124, v124
    v_cos_f32 v125, v125
    v_cos_f32 v126, v126
    v_cos_f32 v127, v127
    v_cvt_pk_bf16_f32 v204, v120, v121
    v_cvt_pk_bf16_f32 v205, v122, v123
    v_cvt_pk_bf16_f32 v206, v124, v125
    v_cvt_pk_bf16_f32 v207, v126, v127
    v_fract_f32 v120, v113
    v_add_f32 v122, v120, v112
    v_add_f32 v124, v122, v112
    v_add_f32 v126, v124, v112
    v_add_f32 v121, 0x3e800000, v120
    v_add_f32 v123, 0x3e800000, v122
    v_add_f32 v125, 0x3e800000, v124
    v_add_f32 v127, 0x3e800000, v126
    v_add_f32 v113, v120, v6
    v_cos_f32 v120, v120
    v_cos_f32 v121, v121
    v_cos_f32 v122, v122
    v_cos_f32 v123, v123
    v_cos_f32 v124, v124
    v_cos_f32 v125, v125
    v_cos_f32 v126, v126
    v_cos_f32 v127, v127
    v_cvt_pk_bf16_f32 v208, v120, v121
    v_cvt_pk_bf16_f32 v209, v122, v123
    v_cvt_pk_bf16_f32 v210, v124, v125
    v_cvt_pk_bf16_f32 v211, v126, v127
    v_fract_f32 v120, v113
    v_add_f32 v122, v120, v112
    v_add_f32 v124, v122, v112
    v_add_f32 v126, v124, v112
    v_add_f32 v121, 0x3e800000, v120
    v_add_f32 v123, 0x3e800000, v122
    v_add_f32 v125, 0x3e800000, v124
    v_add_f32 v127, 0x3e800000, v126
    v_add_f32 v113, v120, v6
    v_cos_f32 v120, v120
    v_cos_f32 v121, v121
    v_cos_f32 v122, v122
    v_cos_f32 v123, v123
    v_cos_f32 v124, v124
    v_cos_f32 v125, v125
    v_cos_f32 v126, v126
    v_cos_f32 v127, v127
    v_cvt_pk_bf16_f32 v212, v120, v121
    v_cvt_pk_bf16_f32 v213, v122, v123
    v_cvt_pk_bf16_f32 v214, v124, v125
    v_cvt_pk_bf16_f32 v215, v126, v127
    v_fract_f32 v120, v113
    v_add_f32 v122, v120, v112
    v_add_f32 v124, v122, v112
    v_add_f32 v126, v124, v112
    v_add_f32 v121, 0x3e800000, v120
    v_add_f32 v123, 0x3e800000, v122
    v_add_f32 v125, 0x3e800000, v124
    v_add_f32 v127, 0x3e800000, v126
    v_add_f32 v113, v120, v6
    v_cos_f32 v120, v120
    v_cos_f32 v121, v121
    v_cos_f32 v122, v122
    v_cos_f32 v123, v123
    v_cos_f32 v124, v124
    v_cos_f32 v125, v125
    v_cos_f32 v126, v126
    v_cos_f32 v127, v127
    v_cvt_pk_bf16_f32 v216, v120, v121
    v_cvt_pk_bf16_f32 v217, v122, v123
    v_cvt_pk_bf16_f32 v218, v124, v125
    v_cvt_pk_bf16_f32 v219, v126, v127
    v_fract_f32 v120, v113
    v_add_f32 v122, v120, v112
    v_add_f32 v124, v122, v112
    v_add_f32 v126, v124, v112
    v_add_f32 v121, 0x3e800000, v120
    v_add_f32 v123, 0x3e800000, v122
    v_add_f32 v125, 0x3e800000, v124
    v_add_f32 v127, 0x3e800000, v126
    v_add_f32 v113, v120, v6
    v_cos_f32 v120, v120
    v_cos_f32 v121, v121
    v_cos_f32 v122, v122
    v_cos_f32 v123, v123
    v_cos_f32 v124, v124
    v_cos_f32 v125, v125
    v_cos_f32 v126, v126
    v_cos_f32 v127, v127
    v_cvt_pk_bf16_f32 v220, v120, v121
    v_cvt_pk_bf16_f32 v221, v122, v123
    v_cvt_pk_bf16_f32 v222, v124, v125
    v_cvt_pk_bf16_f32 v223, v126, v127
    v_fract_f32 v120, v113
    v_add_f32 v122, v120, v112
    v_add_f32 v124, v122, v112
    v_add_f32 v126, v124, v112
    v_add_f32 v121, 0x3e800000, v120
    v_add_f32 v123, 0x3e800000, v122
    v_add_f32 v125, 0x3e800000, v124
    v_add_f32 v127, 0x3e800000, v126
    v_add_f32 v113, v120, v6
    v_cos_f32 v120, v120
    v_cos_f32 v121, v121
    v_cos_f32 v122, v122
    v_cos_f32 v123, v123
    v_cos_f32 v124, v124
    v_cos_f32 v125, v125
    v_cos_f32 v126, v126
    v_cos_f32 v127, v127
    v_cvt_pk_bf16_f32 v224, v120, v121
    v_cvt_pk_bf16_f32 v225, v122, v123
    v_cvt_pk_bf16_f32 v226, v124, v125
    v_cvt_pk_bf16_f32 v227, v126, v127
    v_fract_f32 v120, v113
    v_add_f32 v122, v120, v112
    v_add_f32 v124, v122, v112
    v_add_f32 v126, v124, v112
    v_add_f32 v121, 0x3e800000, v120
    v_add_f32 v123, 0x3e800000, v122
    v_add_f32 v125, 0x3e800000, v124
    v_add_f32 v127, 0x3e800000, v126
    v_add_f32 v113, v120, v6
    v_cos_f32 v120, v120
    v_cos_f32 v121, v121
    v_cos_f32 v122, v122
    v_cos_f32 v123, v123
    v_cos_f32 v124, v124
    v_cos_f32 v125, v125
    v_cos_f32 v126, v126
    v_cos_f32 v127, v127
    v_cvt_pk_bf16_f32 v228, v120, v121
    v_cvt_pk_bf16_f32 v229, v122, v123
    v_cvt_pk_bf16_f32 v230, v124, v125
    v_cvt_pk_bf16_f32 v231, v126, v127
    v_fract_f32 v120, v113
    v_add_f32 v122, v120, v112
    v_add_f32 v124, v122, v112
    v_add_f32 v126, v124, v112
    v_add_f32 v121, 0x3e800000, v120
    v_add_f32 v123, 0x3e800000, v122
    v_add_f32 v125, 0x3e800000, v124
    v_add_f32 v127, 0x3e800000, v126
    v_add_f32 v113, v120, v6
    v_cos_f32 v120, v120
    v_cos_f32 v121, v121
    v_cos_f32 v122, v122
    v_cos_f32 v123, v123
    v_cos_f32 v124, v124
    v_cos_f32 v125, v125
    v_cos_f32 v126, v126
    v_cos_f32 v127, v127
    v_cvt_pk_bf16_f32 v232, v120, v121
    v_cvt_pk_bf16_f32 v233, v122, v123
    v_cvt_pk_bf16_f32 v234, v124, v125
    v_cvt_pk_bf16_f32 v235, v126, v127
    v_fract_f32 v120, v113
    v_add_f32 v122, v120, v112
    v_add_f32 v124, v122, v112
    v_add_f32 v126, v124, v112
    v_add_f32 v121, 0x3e800000, v120
    v_add_f32 v123, 0x3e800000, v122
    v_add_f32 v125, 0x3e800000, v124
    v_add_f32 v127, 0x3e800000, v126
    v_add_f32 v113, v120, v6
    v_cos_f32 v120, v120
    v_cos_f32 v121, v121
    v_cos_f32 v122, v122
    v_cos_f32 v123, v123
    v_cos_f32 v124, v124
    v_cos_f32 v125, v125
    v_cos_f32 v126, v126
    v_cos_f32 v127, v127
    v_cvt_pk_bf16_f32 v236, v120, v121
    v_cvt_pk_bf16_f32 v237, v122, v123
    v_cvt_pk_bf16_f32 v238, v124, v125
    v_cvt_pk_bf16_f32 v239, v126, v127
    v_fract_f32 v120, v113
    v_add_f32 v122, v120, v112
    v_add_f32 v124, v122, v112
    v_add_f32 v126, v124, v112
    v_add_f32 v121, 0x3e800000, v120
    v_add_f32 v123, 0x3e800000, v122
    v_add_f32 v125, 0x3e800000, v124
    v_add_f32 v127, 0x3e800000, v126
    v_add_f32 v113, v120, v6
    v_cos_f32 v120, v120
    v_cos_f32 v121, v121
    v_cos_f32 v122, v122
    v_cos_f32 v123, v123
    v_cos_f32 v124, v124
    v_cos_f32 v125, v125
    v_cos_f32 v126, v126
    v_cos_f32 v127, v127
    v_cvt_pk_bf16_f32 v240, v120, v121
    v_cvt_pk_bf16_f32 v241, v122, v123
    v_cvt_pk_bf16_f32 v242, v124, v125
    v_cvt_pk_bf16_f32 v243, v126, v127
    v_fract_f32 v120, v113
    v_add_f32 v122, v120, v112
    v_add_f32 v124, v122, v112
    v_add_f32 v126, v124, v112
    v_add_f32 v121, 0x3e800000, v120
    v_add_f32 v123, 0x3e800000, v122
    v_add_f32 v125, 0x3e800000, v124
    v_add_f32 v127, 0x3e800000, v126
    v_add_f32 v113, v120, v6
    v_cos_f32 v120, v120
    v_cos_f32 v121, v121
    v_cos_f32 v122, v122
    v_cos_f32 v123, v123
    v_cos_f32 v124, v124
    v_cos_f32 v125, v125
    v_cos_f32 v126, v126
    v_cos_f32 v127, v127
    v_cvt_pk_bf16_f32 v244, v120, v121
    v_cvt_pk_bf16_f32 v245, v122, v123
    v_cvt_pk_bf16_f32 v246, v124, v125
    v_cvt_pk_bf16_f32 v247, v126, v127
    v_fract_f32 v120, v113
    v_add_f32 v122, v120, v112
    v_add_f32 v124, v122, v112
    v_add_f32 v126, v124, v112
    v_add_f32 v121, 0x3e800000, v120
    v_add_f32 v123, 0x3e800000, v122
    v_add_f32 v125, 0x3e800000, v124
    v_add_f32 v127, 0x3e800000, v126
    v_add_f32 v113, v120, v6
    v_cos_f32 v120, v120
    v_cos_f32 v121, v121
    v_cos_f32 v122, v122
    v_cos_f32 v123, v123
    v_cos_f32 v124, v124
    v_cos_f32 v125, v125
    v_cos_f32 v126, v126
    v_cos_f32 v127, v127
    v_cvt_pk_bf16_f32 v248, v120, v121
    v_cvt_pk_bf16_f32 v249, v122, v123
    v_cvt_pk_bf16_f32 v250, v124, v125
    v_cvt_pk_bf16_f32 v251, v126, v127
    v_fract_f32 v120, v113
    v_add_f32 v122, v120, v112
    v_add_f32 v124, v122, v112
    v_add_f32 v126, v124, v112
    v_add_f32 v121, 0x3e800000, v120
    v_add_f32 v123, 0x3e800000, v122
    v_add_f32 v125, 0x3e800000, v124
    v_add_f32 v127, 0x3e800000, v126
    v_add_f32 v113, v120, v6
    v_cos_f32 v120, v120
    v_cos_f32 v121, v121
    v_cos_f32 v122, v122
    v_cos_f32 v123, v123
    v_cos_f32 v124, v124
    v_cos_f32 v125, v125
    v_cos_f32 v126, v126
    v_cos_f32 v127, v127
    v_cvt_pk_bf16_f32 v252, v120, v121
    v_cvt_pk_bf16_f32 v253, v122, v123
    v_cvt_pk_bf16_f32 v254, v124, v125
    v_cvt_pk_bf16_f32 v255, v126, v127
    s_mov_b32 s54, 0
    v_mov_b32 v4, 16
PA3_W:
    global_load_dword v5, v4, s[30:31] sc1
    s_add_u32 s54, s54, 1
    s_cmp_gt_u32 s54, 65536
    s_cbranch_scc1 EXIT
    s_waitcnt vmcnt(0)
    v_readfirstlane_b32 s51, v5
    s_nop 0
    s_cmp_ge_u32 s51, 65
    s_cbranch_scc1 PA3_W_OK
    s_sleep 4
    s_branch PA3_W
PA3_W_OK:
    s_lshr_b32 s52, s48, 2
    s_lshl_b32 s53, s52, 8
    s_add_u32 s53, s53, 63963136
    s_lshl_b32 s59, s44, 10
    s_add_u32 m0, s59, 0
    s_add_u32 s51, s53, 0
    buffer_load_dwordx4 v7, s[36:39], s51 offen sc1 lds
    s_add_u32 m0, s59, 4096
    s_add_u32 s51, s53, 65536
    buffer_load_dwordx4 v7, s[36:39], s51 offen sc1 lds
    s_add_u32 m0, s59, 8192
    s_add_u32 s51, s53, 131072
    buffer_load_dwordx4 v7, s[36:39], s51 offen sc1 lds
    s_add_u32 m0, s59, 12288
    s_add_u32 s51, s53, 196608
    buffer_load_dwordx4 v7, s[36:39], s51 offen sc1 lds
    s_add_u32 m0, s59, 16384
    s_add_u32 s51, s53, 262144
    buffer_load_dwordx4 v7, s[36:39], s51 offen sc1 lds
    s_add_u32 m0, s59, 20480
    s_add_u32 s51, s53, 327680
    buffer_load_dwordx4 v7, s[36:39], s51 offen sc1 lds
    s_add_u32 m0, s59, 24576
    s_add_u32 s51, s53, 393216
    buffer_load_dwordx4 v7, s[36:39], s51 offen sc1 lds
    s_add_u32 m0, s59, 28672
    s_add_u32 s51, s53, 458752
    buffer_load_dwordx4 v7, s[36:39], s51 offen sc1 lds
    s_add_u32 m0, s59, 32768
    s_add_u32 s51, s53, 524288
    buffer_load_dwordx4 v7, s[36:39], s51 offen sc1 lds
    s_add_u32 m0, s59, 36864
    s_add_u32 s51, s53, 589824
    buffer_load_dwordx4 v7, s[36:39], s51 offen sc1 lds
    s_add_u32 m0, s59, 40960
    s_add_u32 s51, s53, 655360
    buffer_load_dwordx4 v7, s[36:39], s51 offen sc1 lds
    s_add_u32 m0, s59, 45056
    s_add_u32 s51, s53, 720896
    buffer_load_dwordx4 v7, s[36:39], s51 offen sc1 lds
    s_add_u32 m0, s59, 49152
    s_add_u32 s51, s53, 786432
    buffer_load_dwordx4 v7, s[36:39], s51 offen sc1 lds
    s_add_u32 m0, s59, 53248
    s_add_u32 s51, s53, 851968
    buffer_load_dwordx4 v7, s[36:39], s51 offen sc1 lds
    s_add_u32 m0, s59, 57344
    s_add_u32 s51, s53, 917504
    buffer_load_dwordx4 v7, s[36:39], s51 offen sc1 lds
    s_add_u32 m0, s59, 61440
    s_add_u32 s51, s53, 983040
    buffer_load_dwordx4 v7, s[36:39], s51 offen sc1 lds
    s_add_u32 m0, s59, 65536
    s_add_u32 s51, s53, 1048576
    buffer_load_dwordx4 v7, s[36:39], s51 offen sc1 lds
    s_add_u32 m0, s59, 69632
    s_add_u32 s51, s53, 1114112
    buffer_load_dwordx4 v7, s[36:39], s51 offen sc1 lds
    s_add_u32 m0, s59, 73728
    s_add_u32 s51, s53, 1179648
    buffer_load_dwordx4 v7, s[36:39], s51 offen sc1 lds
    s_add_u32 m0, s59, 77824
    s_add_u32 s51, s53, 1245184
    buffer_load_dwordx4 v7, s[36:39], s51 offen sc1 lds
    s_add_u32 m0, s59, 81920
    s_add_u32 s51, s53, 1310720
    buffer_load_dwordx4 v7, s[36:39], s51 offen sc1 lds
    s_add_u32 m0, s59, 86016
    s_add_u32 s51, s53, 1376256
    buffer_load_dwordx4 v7, s[36:39], s51 offen sc1 lds
    s_add_u32 m0, s59, 90112
    s_add_u32 s51, s53, 1441792
    buffer_load_dwordx4 v7, s[36:39], s51 offen sc1 lds
    s_add_u32 m0, s59, 94208
    s_add_u32 s51, s53, 1507328
    buffer_load_dwordx4 v7, s[36:39], s51 offen sc1 lds
    s_add_u32 m0, s59, 98304
    s_add_u32 s51, s53, 1572864
    buffer_load_dwordx4 v7, s[36:39], s51 offen sc1 lds
    s_add_u32 m0, s59, 102400
    s_add_u32 s51, s53, 1638400
    buffer_load_dwordx4 v7, s[36:39], s51 offen sc1 lds
    s_add_u32 m0, s59, 106496
    s_add_u32 s51, s53, 1703936
    buffer_load_dwordx4 v7, s[36:39], s51 offen sc1 lds
    s_add_u32 m0, s59, 110592
    s_add_u32 s51, s53, 1769472
    buffer_load_dwordx4 v7, s[36:39], s51 offen sc1 lds
    s_add_u32 m0, s59, 114688
    s_add_u32 s51, s53, 1835008
    buffer_load_dwordx4 v7, s[36:39], s51 offen sc1 lds
    s_add_u32 m0, s59, 118784
    s_add_u32 s51, s53, 1900544
    buffer_load_dwordx4 v7, s[36:39], s51 offen sc1 lds
    s_add_u32 m0, s59, 122880
    s_add_u32 s51, s53, 1966080
    buffer_load_dwordx4 v7, s[36:39], s51 offen sc1 lds
    s_add_u32 m0, s59, 126976
    s_add_u32 s51, s53, 2031616
    buffer_load_dwordx4 v7, s[36:39], s51 offen sc1 lds
    s_mov_b32 s40, s28
    s_mov_b32 s41, s29
    s_mov_b32 s42, 4194304
    s_mov_b32 s43, 0x20000
    s_and_b32 s51, s52, 1
    s_lshl_b32 s53, s51, 10
    s_lshr_b32 s51, s52, 2
    s_lshl_b32 s51, s51, 4
    s_add_u32 s53, s53, s51
    s_and_b32 s51, s52, 2
    s_lshl_b32 s51, s51, 1
    s_add_u32 s53, s53, s51
    s_lshl_b32 s53, s53, 11
    s_lshl_b32 s51, s58, 1
    s_add_u32 s53, s53, s51
    s_waitcnt vmcnt(0)
    s_barrier
    ds_read_b64_tr_b16 v[80:81], v8 offset:0
    ds_read_b64_tr_b16 v[82:83], v8 offset:1024
    ds_read_b64_tr_b16 v[84:85], v8 offset:4096
    ds_read_b64_tr_b16 v[86:87], v8 offset:5120
    ds_read_b64_tr_b16 v[88:89], v8 offset:8192
    ds_read_b64_tr_b16 v[90:91], v8 offset:9216
    ds_read_b64_tr_b16 v[92:93], v8 offset:12288
    ds_read_b64_tr_b16 v[94:95], v8 offset:13312
    ds_read_b64_tr_b16 v[96:97], v8 offset:16384
    ds_read_b64_tr_b16 v[98:99], v8 offset:17408
    ds_read_b64_tr_b16 v[100:101], v8 offset:20480
    ds_read_b64_tr_b16 v[102:103], v8 offset:21504
    s_waitcnt lgkmcnt(10)
    v_mfma_f32_32x32x16_bf16 v[16:31], v[128:131], v[80:83], 0
    ds_read_b64_tr_b16 v[104:105], v8 offset:24576
    ds_read_b64_tr_b16 v[106:107], v8 offset:25600
    s_waitcnt lgkmcnt(10)
    v_mfma_f32_32x32x16_bf16 v[16:31], v[132:135], v[84:87], v[16:31]
    ds_read_b64_tr_b16 v[108:109], v8 offset:28672
    ds_read_b64_tr_b16 v[110:111], v8 offset:29696
    s_waitcnt lgkmcnt(10)
    v_mfma_f32_32x32x16_bf16 v[16:31], v[136:139], v[88:91], v[16:31]
    ds_read_b64_tr_b16 v[80:81], v8 offset:32768
    ds_read_b64_tr_b16 v[82:83], v8 offset:33792
    s_waitcnt lgkmcnt(10)
    v_mfma_f32_32x32x16_bf16 v[16:31], v[140:143], v[92:95], v[16:31]
    ds_read_b64_tr_b16 v[84:85], v8 offset:36864
    ds_read_b64_tr_b16 v[86:87], v8 offset:37888
    s_waitcnt lgkmcnt(10)
    v_mfma_f32_32x32x16_bf16 v[16:31], v[144:147], v[96:99], v[16:31]
    ds_read_b64_tr_b16 v[88:89], v8 offset:40960
    ds_read_b64_tr_b16 v[90:91], v8 offset:41984
    s_waitcnt lgkmcnt(10)
    v_mfma_f32_32x32x16_bf16 v[16:31], v[148:151], v[100:103], v[16:31]
    ds_read_b64_tr_b16 v[92:93], v8 offset:45056
    ds_read_b64_tr_b16 v[94:95], v8 offset:46080
    s_waitcnt lgkmcnt(10)
    v_mfma_f32_32x32x16_bf16 v[16:31], v[152:155], v[104:107], v[16:31]
    ds_read_b64_tr_b16 v[96:97], v8 offset:49152
    ds_read_b64_tr_b16 v[98:99], v8 offset:50176
    s_waitcnt lgkmcnt(10)
    v_mfma_f32_32x32x16_bf16 v[16:31], v[156:159], v[108:111], v[16:31]
    ds_read_b64_tr_b16 v[100:101], v8 offset:53248
    ds_read_b64_tr_b16 v[102:103], v8 offset:54272
    s_waitcnt lgkmcnt(10)
    v_mfma_f32_32x32x16_bf16 v[16:31], v[160:163], v[80:83], v[16:31]
    ds_read_b64_tr_b16 v[104:105], v8 offset:57344
    ds_read_b64_tr_b16 v[106:107], v8 offset:58368
    s_waitcnt lgkmcnt(10)
    v_mfma_f32_32x32x16_bf16 v[16:31], v[164:167], v[84:87], v[16:31]
    ds_read_b64_tr_b16 v[108:109], v8 offset:61440
    ds_read_b64_tr_b16 v[110:111], v8 offset:62464
    s_waitcnt lgkmcnt(10)
    v_mfma_f32_32x32x16_bf16 v[16:31], v[168:171], v[88:91], v[16:31]
    ds_read_b64_tr_b16 v[80:81], v12 offset:0
    ds_read_b64_tr_b16 v[82:83], v12 offset:1024
    s_waitcnt lgkmcnt(10)
    v_mfma_f32_32x32x16_bf16 v[16:31], v[172:175], v[92:95], v[16:31]
    ds_read_b64_tr_b16 v[84:85], v12 offset:4096
    ds_read_b64_tr_b16 v[86:87], v12 offset:5120
    s_waitcnt lgkmcnt(10)
    v_mfma_f32_32x32x16_bf16 v[16:31], v[176:179], v[96:99], v[16:31]
    ds_read_b64_tr_b16 v[88:89], v12 offset:8192
    ds_read_b64_tr_b16 v[90:91], v12 offset:9216
    s_waitcnt lgkmcnt(10)
    v_mfma_f32_32x32x16_bf16 v[16:31], v[180:183], v[100:103], v[16:31]
    ds_read_b64_tr_b16 v[92:93], v12 offset:12288
    ds_read_b64_tr_b16 v[94:95], v12 offset:13312
    s_waitcnt lgkmcnt(10)
    v_mfma_f32_32x32x16_bf16 v[16:31], v[184:187], v[104:107], v[16:31]
    ds_read_b64_tr_b16 v[96:97], v12 offset:16384
    ds_read_b64_tr_b16 v[98:99], v12 offset:17408
    s_waitcnt lgkmcnt(10)
    v_mfma_f32_32x32x16_bf16 v[16:31], v[188:191], v[108:111], v[16:31]
    ds_read_b64_tr_b16 v[100:101], v12 offset:20480
    ds_read_b64_tr_b16 v[102:103], v12 offset:21504
    s_waitcnt lgkmcnt(10)
    v_mfma_f32_32x32x16_bf16 v[16:31], v[192:195], v[80:83], v[16:31]
    ds_read_b64_tr_b16 v[104:105], v12 offset:24576
    ds_read_b64_tr_b16 v[106:107], v12 offset:25600
    s_waitcnt lgkmcnt(10)
    v_mfma_f32_32x32x16_bf16 v[16:31], v[196:199], v[84:87], v[16:31]
    ds_read_b64_tr_b16 v[108:109], v12 offset:28672
    ds_read_b64_tr_b16 v[110:111], v12 offset:29696
    s_waitcnt lgkmcnt(10)
    v_mfma_f32_32x32x16_bf16 v[16:31], v[200:203], v[88:91], v[16:31]
    ds_read_b64_tr_b16 v[80:81], v12 offset:32768
    ds_read_b64_tr_b16 v[82:83], v12 offset:33792
    s_waitcnt lgkmcnt(10)
    v_mfma_f32_32x32x16_bf16 v[16:31], v[204:207], v[92:95], v[16:31]
    ds_read_b64_tr_b16 v[84:85], v12 offset:36864
    ds_read_b64_tr_b16 v[86:87], v12 offset:37888
    s_waitcnt lgkmcnt(10)
    v_mfma_f32_32x32x16_bf16 v[16:31], v[208:211], v[96:99], v[16:31]
    ds_read_b64_tr_b16 v[88:89], v12 offset:40960
    ds_read_b64_tr_b16 v[90:91], v12 offset:41984
    s_waitcnt lgkmcnt(10)
    v_mfma_f32_32x32x16_bf16 v[16:31], v[212:215], v[100:103], v[16:31]
    ds_read_b64_tr_b16 v[92:93], v12 offset:45056
    ds_read_b64_tr_b16 v[94:95], v12 offset:46080
    s_waitcnt lgkmcnt(10)
    v_mfma_f32_32x32x16_bf16 v[16:31], v[216:219], v[104:107], v[16:31]
    ds_read_b64_tr_b16 v[96:97], v12 offset:49152
    ds_read_b64_tr_b16 v[98:99], v12 offset:50176
    s_waitcnt lgkmcnt(10)
    v_mfma_f32_32x32x16_bf16 v[16:31], v[220:223], v[108:111], v[16:31]
    ds_read_b64_tr_b16 v[100:101], v12 offset:53248
    ds_read_b64_tr_b16 v[102:103], v12 offset:54272
    s_waitcnt lgkmcnt(10)
    v_mfma_f32_32x32x16_bf16 v[16:31], v[224:227], v[80:83], v[16:31]
    ds_read_b64_tr_b16 v[104:105], v12 offset:57344
    ds_read_b64_tr_b16 v[106:107], v12 offset:58368
    s_waitcnt lgkmcnt(10)
    v_mfma_f32_32x32x16_bf16 v[16:31], v[228:231], v[84:87], v[16:31]
    ds_read_b64_tr_b16 v[108:109], v12 offset:61440
    ds_read_b64_tr_b16 v[110:111], v12 offset:62464
    s_waitcnt lgkmcnt(10)
    v_mfma_f32_32x32x16_bf16 v[16:31], v[232:235], v[88:91], v[16:31]
    s_waitcnt lgkmcnt(8)
    v_mfma_f32_32x32x16_bf16 v[16:31], v[236:239], v[92:95], v[16:31]
    s_waitcnt lgkmcnt(6)
    v_mfma_f32_32x32x16_bf16 v[16:31], v[240:243], v[96:99], v[16:31]
    s_waitcnt lgkmcnt(4)
    v_mfma_f32_32x32x16_bf16 v[16:31], v[244:247], v[100:103], v[16:31]
    s_waitcnt lgkmcnt(2)
    v_mfma_f32_32x32x16_bf16 v[16:31], v[248:251], v[104:107], v[16:31]
    s_waitcnt lgkmcnt(0)
    v_mfma_f32_32x32x16_bf16 v[16:31], v[252:255], v[108:111], v[16:31]
    ds_read_b64_tr_b16 v[80:81], v9 offset:0
    ds_read_b64_tr_b16 v[82:83], v9 offset:1024
    ds_read_b64_tr_b16 v[84:85], v9 offset:4096
    ds_read_b64_tr_b16 v[86:87], v9 offset:5120
    ds_read_b64_tr_b16 v[88:89], v9 offset:8192
    ds_read_b64_tr_b16 v[90:91], v9 offset:9216
    ds_read_b64_tr_b16 v[92:93], v9 offset:12288
    ds_read_b64_tr_b16 v[94:95], v9 offset:13312
    ds_read_b64_tr_b16 v[96:97], v9 offset:16384
    ds_read_b64_tr_b16 v[98:99], v9 offset:17408
    ds_read_b64_tr_b16 v[100:101], v9 offset:20480
    ds_read_b64_tr_b16 v[102:103], v9 offset:21504
    s_waitcnt lgkmcnt(10)
    v_mfma_f32_32x32x16_bf16 v[32:47], v[128:131], v[80:83], 0
    ds_read_b64_tr_b16 v[104:105], v9 offset:24576
    ds_read_b64_tr_b16 v[106:107], v9 offset:25600
    s_waitcnt lgkmcnt(10)
    v_mfma_f32_32x32x16_bf16 v[32:47], v[132:135], v[84:87], v[32:47]
    ds_read_b64_tr_b16 v[108:109], v9 offset:28672
    ds_read_b64_tr_b16 v[110:111], v9 offset:29696
    s_waitcnt lgkmcnt(10)
    v_mfma_f32_32x32x16_bf16 v[32:47], v[136:139], v[88:91], v[32:47]
    ds_read_b64_tr_b16 v[80:81], v9 offset:32768
    ds_read_b64_tr_b16 v[82:83], v9 offset:33792
    s_waitcnt lgkmcnt(10)
    v_mfma_f32_32x32x16_bf16 v[32:47], v[140:143], v[92:95], v[32:47]
    ds_read_b64_tr_b16 v[84:85], v9 offset:36864
    ds_read_b64_tr_b16 v[86:87], v9 offset:37888
    s_waitcnt lgkmcnt(10)
    v_mfma_f32_32x32x16_bf16 v[32:47], v[144:147], v[96:99], v[32:47]
    ds_read_b64_tr_b16 v[88:89], v9 offset:40960
    ds_read_b64_tr_b16 v[90:91], v9 offset:41984
    s_waitcnt lgkmcnt(10)
    v_mfma_f32_32x32x16_bf16 v[32:47], v[148:151], v[100:103], v[32:47]
    ds_read_b64_tr_b16 v[92:93], v9 offset:45056
    ds_read_b64_tr_b16 v[94:95], v9 offset:46080
    s_waitcnt lgkmcnt(10)
    v_mfma_f32_32x32x16_bf16 v[32:47], v[152:155], v[104:107], v[32:47]
    ds_read_b64_tr_b16 v[96:97], v9 offset:49152
    ds_read_b64_tr_b16 v[98:99], v9 offset:50176
    s_waitcnt lgkmcnt(10)
    v_mfma_f32_32x32x16_bf16 v[32:47], v[156:159], v[108:111], v[32:47]
    ds_read_b64_tr_b16 v[100:101], v9 offset:53248
    ds_read_b64_tr_b16 v[102:103], v9 offset:54272
    s_waitcnt lgkmcnt(10)
    v_mfma_f32_32x32x16_bf16 v[32:47], v[160:163], v[80:83], v[32:47]
    ds_read_b64_tr_b16 v[104:105], v9 offset:57344
    ds_read_b64_tr_b16 v[106:107], v9 offset:58368
    s_waitcnt lgkmcnt(10)
    v_mfma_f32_32x32x16_bf16 v[32:47], v[164:167], v[84:87], v[32:47]
    ds_read_b64_tr_b16 v[108:109], v9 offset:61440
    ds_read_b64_tr_b16 v[110:111], v9 offset:62464
    s_waitcnt lgkmcnt(10)
    v_mfma_f32_32x32x16_bf16 v[32:47], v[168:171], v[88:91], v[32:47]
    ds_read_b64_tr_b16 v[80:81], v13 offset:0
    ds_read_b64_tr_b16 v[82:83], v13 offset:1024
    s_waitcnt lgkmcnt(10)
    v_mfma_f32_32x32x16_bf16 v[32:47], v[172:175], v[92:95], v[32:47]
    ds_read_b64_tr_b16 v[84:85], v13 offset:4096
    ds_read_b64_tr_b16 v[86:87], v13 offset:5120
    s_waitcnt lgkmcnt(10)
    v_mfma_f32_32x32x16_bf16 v[32:47], v[176:179], v[96:99], v[32:47]
    ds_read_b64_tr_b16 v[88:89], v13 offset:8192
    ds_read_b64_tr_b16 v[90:91], v13 offset:9216
    s_waitcnt lgkmcnt(10)
    v_mfma_f32_32x32x16_bf16 v[32:47], v[180:183], v[100:103], v[32:47]
    ds_read_b64_tr_b16 v[92:93], v13 offset:12288
    ds_read_b64_tr_b16 v[94:95], v13 offset:13312
    s_waitcnt lgkmcnt(10)
    v_mfma_f32_32x32x16_bf16 v[32:47], v[184:187], v[104:107], v[32:47]
    ds_read_b64_tr_b16 v[96:97], v13 offset:16384
    ds_read_b64_tr_b16 v[98:99], v13 offset:17408
    s_waitcnt lgkmcnt(10)
    v_mfma_f32_32x32x16_bf16 v[32:47], v[188:191], v[108:111], v[32:47]
    ds_read_b64_tr_b16 v[100:101], v13 offset:20480
    ds_read_b64_tr_b16 v[102:103], v13 offset:21504
    s_waitcnt lgkmcnt(10)
    v_mfma_f32_32x32x16_bf16 v[32:47], v[192:195], v[80:83], v[32:47]
    ds_read_b64_tr_b16 v[104:105], v13 offset:24576
    ds_read_b64_tr_b16 v[106:107], v13 offset:25600
    s_waitcnt lgkmcnt(10)
    v_mfma_f32_32x32x16_bf16 v[32:47], v[196:199], v[84:87], v[32:47]
    ds_read_b64_tr_b16 v[108:109], v13 offset:28672
    ds_read_b64_tr_b16 v[110:111], v13 offset:29696
    s_waitcnt lgkmcnt(10)
    v_mfma_f32_32x32x16_bf16 v[32:47], v[200:203], v[88:91], v[32:47]
    ds_read_b64_tr_b16 v[80:81], v13 offset:32768
    ds_read_b64_tr_b16 v[82:83], v13 offset:33792
    s_waitcnt lgkmcnt(10)
    v_mfma_f32_32x32x16_bf16 v[32:47], v[204:207], v[92:95], v[32:47]
    ds_read_b64_tr_b16 v[84:85], v13 offset:36864
    ds_read_b64_tr_b16 v[86:87], v13 offset:37888
    s_waitcnt lgkmcnt(10)
    v_mfma_f32_32x32x16_bf16 v[32:47], v[208:211], v[96:99], v[32:47]
    ds_read_b64_tr_b16 v[88:89], v13 offset:40960
    ds_read_b64_tr_b16 v[90:91], v13 offset:41984
    s_waitcnt lgkmcnt(10)
    v_mfma_f32_32x32x16_bf16 v[32:47], v[212:215], v[100:103], v[32:47]
    ds_read_b64_tr_b16 v[92:93], v13 offset:45056
    ds_read_b64_tr_b16 v[94:95], v13 offset:46080
    s_waitcnt lgkmcnt(10)
    v_mfma_f32_32x32x16_bf16 v[32:47], v[216:219], v[104:107], v[32:47]
    ds_read_b64_tr_b16 v[96:97], v13 offset:49152
    ds_read_b64_tr_b16 v[98:99], v13 offset:50176
    s_waitcnt lgkmcnt(10)
    v_mfma_f32_32x32x16_bf16 v[32:47], v[220:223], v[108:111], v[32:47]
    ds_read_b64_tr_b16 v[100:101], v13 offset:53248
    ds_read_b64_tr_b16 v[102:103], v13 offset:54272
    s_waitcnt lgkmcnt(10)
    v_mfma_f32_32x32x16_bf16 v[32:47], v[224:227], v[80:83], v[32:47]
    ds_read_b64_tr_b16 v[104:105], v13 offset:57344
    ds_read_b64_tr_b16 v[106:107], v13 offset:58368
    s_waitcnt lgkmcnt(10)
    v_mfma_f32_32x32x16_bf16 v[32:47], v[228:231], v[84:87], v[32:47]
    ds_read_b64_tr_b16 v[108:109], v13 offset:61440
    ds_read_b64_tr_b16 v[110:111], v13 offset:62464
    s_waitcnt lgkmcnt(10)
    v_mfma_f32_32x32x16_bf16 v[32:47], v[232:235], v[88:91], v[32:47]
    s_waitcnt lgkmcnt(8)
    v_mfma_f32_32x32x16_bf16 v[32:47], v[236:239], v[92:95], v[32:47]
    s_waitcnt lgkmcnt(6)
    v_mfma_f32_32x32x16_bf16 v[32:47], v[240:243], v[96:99], v[32:47]
    s_waitcnt lgkmcnt(4)
    v_mfma_f32_32x32x16_bf16 v[32:47], v[244:247], v[100:103], v[32:47]
    s_waitcnt lgkmcnt(2)
    v_mfma_f32_32x32x16_bf16 v[32:47], v[248:251], v[104:107], v[32:47]
    s_waitcnt lgkmcnt(0)
    v_mfma_f32_32x32x16_bf16 v[32:47], v[252:255], v[108:111], v[32:47]
    ds_read_b64_tr_b16 v[80:81], v10 offset:0
    ds_read_b64_tr_b16 v[82:83], v10 offset:1024
    ds_read_b64_tr_b16 v[84:85], v10 offset:4096
    ds_read_b64_tr_b16 v[86:87], v10 offset:5120
    ds_read_b64_tr_b16 v[88:89], v10 offset:8192
    ds_read_b64_tr_b16 v[90:91], v10 offset:9216
    ds_read_b64_tr_b16 v[92:93], v10 offset:12288
    ds_read_b64_tr_b16 v[94:95], v10 offset:13312
    ds_read_b64_tr_b16 v[96:97], v10 offset:16384
    ds_read_b64_tr_b16 v[98:99], v10 offset:17408
    ds_read_b64_tr_b16 v[100:101], v10 offset:20480
    ds_read_b64_tr_b16 v[102:103], v10 offset:21504
    s_waitcnt lgkmcnt(10)
    v_mfma_f32_32x32x16_bf16 v[48:63], v[128:131], v[80:83], 0
    ds_read_b64_tr_b16 v[104:105], v10 offset:24576
    ds_read_b64_tr_b16 v[106:107], v10 offset:25600
    s_waitcnt lgkmcnt(10)
    v_mfma_f32_32x32x16_bf16 v[48:63], v[132:135], v[84:87], v[48:63]
    ds_read_b64_tr_b16 v[108:109], v10 offset:28672
    ds_read_b64_tr_b16 v[110:111], v10 offset:29696
    s_waitcnt lgkmcnt(10)
    v_mfma_f32_32x32x16_bf16 v[48:63], v[136:139], v[88:91], v[48:63]
    ds_read_b64_tr_b16 v[80:81], v10 offset:32768
    ds_read_b64_tr_b16 v[82:83], v10 offset:33792
    s_waitcnt lgkmcnt(10)
    v_mfma_f32_32x32x16_bf16 v[48:63], v[140:143], v[92:95], v[48:63]
    ds_read_b64_tr_b16 v[84:85], v10 offset:36864
    ds_read_b64_tr_b16 v[86:87], v10 offset:37888
    s_waitcnt lgkmcnt(10)
    v_mfma_f32_32x32x16_bf16 v[48:63], v[144:147], v[96:99], v[48:63]
    ds_read_b64_tr_b16 v[88:89], v10 offset:40960
    ds_read_b64_tr_b16 v[90:91], v10 offset:41984
    s_waitcnt lgkmcnt(10)
    v_mfma_f32_32x32x16_bf16 v[48:63], v[148:151], v[100:103], v[48:63]
    ds_read_b64_tr_b16 v[92:93], v10 offset:45056
    ds_read_b64_tr_b16 v[94:95], v10 offset:46080
    s_waitcnt lgkmcnt(10)
    v_mfma_f32_32x32x16_bf16 v[48:63], v[152:155], v[104:107], v[48:63]
    ds_read_b64_tr_b16 v[96:97], v10 offset:49152
    ds_read_b64_tr_b16 v[98:99], v10 offset:50176
    s_waitcnt lgkmcnt(10)
    v_mfma_f32_32x32x16_bf16 v[48:63], v[156:159], v[108:111], v[48:63]
    ds_read_b64_tr_b16 v[100:101], v10 offset:53248
    ds_read_b64_tr_b16 v[102:103], v10 offset:54272
    s_waitcnt lgkmcnt(10)
    v_mfma_f32_32x32x16_bf16 v[48:63], v[160:163], v[80:83], v[48:63]
    ds_read_b64_tr_b16 v[104:105], v10 offset:57344
    ds_read_b64_tr_b16 v[106:107], v10 offset:58368
    s_waitcnt lgkmcnt(10)
    v_mfma_f32_32x32x16_bf16 v[48:63], v[164:167], v[84:87], v[48:63]
    ds_read_b64_tr_b16 v[108:109], v10 offset:61440
    ds_read_b64_tr_b16 v[110:111], v10 offset:62464
    s_waitcnt lgkmcnt(10)
    v_mfma_f32_32x32x16_bf16 v[48:63], v[168:171], v[88:91], v[48:63]
    ds_read_b64_tr_b16 v[80:81], v14 offset:0
    ds_read_b64_tr_b16 v[82:83], v14 offset:1024
    s_waitcnt lgkmcnt(10)
    v_mfma_f32_32x32x16_bf16 v[48:63], v[172:175], v[92:95], v[48:63]
    ds_read_b64_tr_b16 v[84:85], v14 offset:4096
    ds_read_b64_tr_b16 v[86:87], v14 offset:5120
    s_waitcnt lgkmcnt(10)
    v_mfma_f32_32x32x16_bf16 v[48:63], v[176:179], v[96:99], v[48:63]
    ds_read_b64_tr_b16 v[88:89], v14 offset:8192
    ds_read_b64_tr_b16 v[90:91], v14 offset:9216
    s_waitcnt lgkmcnt(10)
    v_mfma_f32_32x32x16_bf16 v[48:63], v[180:183], v[100:103], v[48:63]
    ds_read_b64_tr_b16 v[92:93], v14 offset:12288
    ds_read_b64_tr_b16 v[94:95], v14 offset:13312
    s_waitcnt lgkmcnt(10)
    v_mfma_f32_32x32x16_bf16 v[48:63], v[184:187], v[104:107], v[48:63]
    ds_read_b64_tr_b16 v[96:97], v14 offset:16384
    ds_read_b64_tr_b16 v[98:99], v14 offset:17408
    s_waitcnt lgkmcnt(10)
    v_mfma_f32_32x32x16_bf16 v[48:63], v[188:191], v[108:111], v[48:63]
    ds_read_b64_tr_b16 v[100:101], v14 offset:20480
    ds_read_b64_tr_b16 v[102:103], v14 offset:21504
    s_waitcnt lgkmcnt(10)
    v_mfma_f32_32x32x16_bf16 v[48:63], v[192:195], v[80:83], v[48:63]
    ds_read_b64_tr_b16 v[104:105], v14 offset:24576
    ds_read_b64_tr_b16 v[106:107], v14 offset:25600
    s_waitcnt lgkmcnt(10)
    v_mfma_f32_32x32x16_bf16 v[48:63], v[196:199], v[84:87], v[48:63]
    ds_read_b64_tr_b16 v[108:109], v14 offset:28672
    ds_read_b64_tr_b16 v[110:111], v14 offset:29696
    s_waitcnt lgkmcnt(10)
    v_mfma_f32_32x32x16_bf16 v[48:63], v[200:203], v[88:91], v[48:63]
    ds_read_b64_tr_b16 v[80:81], v14 offset:32768
    ds_read_b64_tr_b16 v[82:83], v14 offset:33792
    s_waitcnt lgkmcnt(10)
    v_mfma_f32_32x32x16_bf16 v[48:63], v[204:207], v[92:95], v[48:63]
    ds_read_b64_tr_b16 v[84:85], v14 offset:36864
    ds_read_b64_tr_b16 v[86:87], v14 offset:37888
    s_waitcnt lgkmcnt(10)
    v_mfma_f32_32x32x16_bf16 v[48:63], v[208:211], v[96:99], v[48:63]
    ds_read_b64_tr_b16 v[88:89], v14 offset:40960
    ds_read_b64_tr_b16 v[90:91], v14 offset:41984
    s_waitcnt lgkmcnt(10)
    v_mfma_f32_32x32x16_bf16 v[48:63], v[212:215], v[100:103], v[48:63]
    ds_read_b64_tr_b16 v[92:93], v14 offset:45056
    ds_read_b64_tr_b16 v[94:95], v14 offset:46080
    s_waitcnt lgkmcnt(10)
    v_mfma_f32_32x32x16_bf16 v[48:63], v[216:219], v[104:107], v[48:63]
    ds_read_b64_tr_b16 v[96:97], v14 offset:49152
    ds_read_b64_tr_b16 v[98:99], v14 offset:50176
    s_waitcnt lgkmcnt(10)
    v_mfma_f32_32x32x16_bf16 v[48:63], v[220:223], v[108:111], v[48:63]
    ds_read_b64_tr_b16 v[100:101], v14 offset:53248
    ds_read_b64_tr_b16 v[102:103], v14 offset:54272
    s_waitcnt lgkmcnt(10)
    v_mfma_f32_32x32x16_bf16 v[48:63], v[224:227], v[80:83], v[48:63]
    ds_read_b64_tr_b16 v[104:105], v14 offset:57344
    ds_read_b64_tr_b16 v[106:107], v14 offset:58368
    s_waitcnt lgkmcnt(10)
    v_mfma_f32_32x32x16_bf16 v[48:63], v[228:231], v[84:87], v[48:63]
    ds_read_b64_tr_b16 v[108:109], v14 offset:61440
    ds_read_b64_tr_b16 v[110:111], v14 offset:62464
    s_waitcnt lgkmcnt(10)
    v_mfma_f32_32x32x16_bf16 v[48:63], v[232:235], v[88:91], v[48:63]
    s_waitcnt lgkmcnt(8)
    v_mfma_f32_32x32x16_bf16 v[48:63], v[236:239], v[92:95], v[48:63]
    s_waitcnt lgkmcnt(6)
    v_mfma_f32_32x32x16_bf16 v[48:63], v[240:243], v[96:99], v[48:63]
    s_waitcnt lgkmcnt(4)
    v_mfma_f32_32x32x16_bf16 v[48:63], v[244:247], v[100:103], v[48:63]
    s_waitcnt lgkmcnt(2)
    v_mfma_f32_32x32x16_bf16 v[48:63], v[248:251], v[104:107], v[48:63]
    s_waitcnt lgkmcnt(0)
    v_mfma_f32_32x32x16_bf16 v[48:63], v[252:255], v[108:111], v[48:63]
    ds_read_b64_tr_b16 v[80:81], v11 offset:0
    ds_read_b64_tr_b16 v[82:83], v11 offset:1024
    ds_read_b64_tr_b16 v[84:85], v11 offset:4096
    ds_read_b64_tr_b16 v[86:87], v11 offset:5120
    ds_read_b64_tr_b16 v[88:89], v11 offset:8192
    ds_read_b64_tr_b16 v[90:91], v11 offset:9216
    ds_read_b64_tr_b16 v[92:93], v11 offset:12288
    ds_read_b64_tr_b16 v[94:95], v11 offset:13312
    ds_read_b64_tr_b16 v[96:97], v11 offset:16384
    ds_read_b64_tr_b16 v[98:99], v11 offset:17408
    ds_read_b64_tr_b16 v[100:101], v11 offset:20480
    ds_read_b64_tr_b16 v[102:103], v11 offset:21504
    s_waitcnt lgkmcnt(10)
    v_mfma_f32_32x32x16_bf16 v[64:79], v[128:131], v[80:83], 0
    ds_read_b64_tr_b16 v[104:105], v11 offset:24576
    ds_read_b64_tr_b16 v[106:107], v11 offset:25600
    s_waitcnt lgkmcnt(10)
    v_mfma_f32_32x32x16_bf16 v[64:79], v[132:135], v[84:87], v[64:79]
    ds_read_b64_tr_b16 v[108:109], v11 offset:28672
    ds_read_b64_tr_b16 v[110:111], v11 offset:29696
    s_waitcnt lgkmcnt(10)
    v_mfma_f32_32x32x16_bf16 v[64:79], v[136:139], v[88:91], v[64:79]
    ds_read_b64_tr_b16 v[80:81], v11 offset:32768
    ds_read_b64_tr_b16 v[82:83], v11 offset:33792
    s_waitcnt lgkmcnt(10)
    v_mfma_f32_32x32x16_bf16 v[64:79], v[140:143], v[92:95], v[64:79]
    ds_read_b64_tr_b16 v[84:85], v11 offset:36864
    ds_read_b64_tr_b16 v[86:87], v11 offset:37888
    s_waitcnt lgkmcnt(10)
    v_mfma_f32_32x32x16_bf16 v[64:79], v[144:147], v[96:99], v[64:79]
    ds_read_b64_tr_b16 v[88:89], v11 offset:40960
    ds_read_b64_tr_b16 v[90:91], v11 offset:41984
    s_waitcnt lgkmcnt(10)
    v_mfma_f32_32x32x16_bf16 v[64:79], v[148:151], v[100:103], v[64:79]
    ds_read_b64_tr_b16 v[92:93], v11 offset:45056
    ds_read_b64_tr_b16 v[94:95], v11 offset:46080
    s_waitcnt lgkmcnt(10)
    v_mfma_f32_32x32x16_bf16 v[64:79], v[152:155], v[104:107], v[64:79]
    ds_read_b64_tr_b16 v[96:97], v11 offset:49152
    ds_read_b64_tr_b16 v[98:99], v11 offset:50176
    s_waitcnt lgkmcnt(10)
    v_mfma_f32_32x32x16_bf16 v[64:79], v[156:159], v[108:111], v[64:79]
    ds_read_b64_tr_b16 v[100:101], v11 offset:53248
    ds_read_b64_tr_b16 v[102:103], v11 offset:54272
    s_waitcnt lgkmcnt(10)
    v_mfma_f32_32x32x16_bf16 v[64:79], v[160:163], v[80:83], v[64:79]
    ds_read_b64_tr_b16 v[104:105], v11 offset:57344
    ds_read_b64_tr_b16 v[106:107], v11 offset:58368
    s_waitcnt lgkmcnt(10)
    v_mfma_f32_32x32x16_bf16 v[64:79], v[164:167], v[84:87], v[64:79]
    ds_read_b64_tr_b16 v[108:109], v11 offset:61440
    ds_read_b64_tr_b16 v[110:111], v11 offset:62464
    s_waitcnt lgkmcnt(10)
    v_mfma_f32_32x32x16_bf16 v[64:79], v[168:171], v[88:91], v[64:79]
    ds_read_b64_tr_b16 v[80:81], v15 offset:0
    ds_read_b64_tr_b16 v[82:83], v15 offset:1024
    s_waitcnt lgkmcnt(10)
    v_mfma_f32_32x32x16_bf16 v[64:79], v[172:175], v[92:95], v[64:79]
    ds_read_b64_tr_b16 v[84:85], v15 offset:4096
    ds_read_b64_tr_b16 v[86:87], v15 offset:5120
    s_waitcnt lgkmcnt(10)
    v_mfma_f32_32x32x16_bf16 v[64:79], v[176:179], v[96:99], v[64:79]
    ds_read_b64_tr_b16 v[88:89], v15 offset:8192
    ds_read_b64_tr_b16 v[90:91], v15 offset:9216
    s_waitcnt lgkmcnt(10)
    v_mfma_f32_32x32x16_bf16 v[64:79], v[180:183], v[100:103], v[64:79]
    ds_read_b64_tr_b16 v[92:93], v15 offset:12288
    ds_read_b64_tr_b16 v[94:95], v15 offset:13312
    s_waitcnt lgkmcnt(10)
    v_mfma_f32_32x32x16_bf16 v[64:79], v[184:187], v[104:107], v[64:79]
    ds_read_b64_tr_b16 v[96:97], v15 offset:16384
    ds_read_b64_tr_b16 v[98:99], v15 offset:17408
    s_waitcnt lgkmcnt(10)
    v_mfma_f32_32x32x16_bf16 v[64:79], v[188:191], v[108:111], v[64:79]
    ds_read_b64_tr_b16 v[100:101], v15 offset:20480
    ds_read_b64_tr_b16 v[102:103], v15 offset:21504
    s_waitcnt lgkmcnt(10)
    v_mfma_f32_32x32x16_bf16 v[64:79], v[192:195], v[80:83], v[64:79]
    ds_read_b64_tr_b16 v[104:105], v15 offset:24576
    ds_read_b64_tr_b16 v[106:107], v15 offset:25600
    s_waitcnt lgkmcnt(10)
    v_mfma_f32_32x32x16_bf16 v[64:79], v[196:199], v[84:87], v[64:79]
    ds_read_b64_tr_b16 v[108:109], v15 offset:28672
    ds_read_b64_tr_b16 v[110:111], v15 offset:29696
    s_waitcnt lgkmcnt(10)
    v_mfma_f32_32x32x16_bf16 v[64:79], v[200:203], v[88:91], v[64:79]
    ds_read_b64_tr_b16 v[80:81], v15 offset:32768
    ds_read_b64_tr_b16 v[82:83], v15 offset:33792
    s_waitcnt lgkmcnt(10)
    v_mfma_f32_32x32x16_bf16 v[64:79], v[204:207], v[92:95], v[64:79]
    ds_read_b64_tr_b16 v[84:85], v15 offset:36864
    ds_read_b64_tr_b16 v[86:87], v15 offset:37888
    s_waitcnt lgkmcnt(10)
    v_mfma_f32_32x32x16_bf16 v[64:79], v[208:211], v[96:99], v[64:79]
    ds_read_b64_tr_b16 v[88:89], v15 offset:40960
    ds_read_b64_tr_b16 v[90:91], v15 offset:41984
    s_waitcnt lgkmcnt(10)
    v_mfma_f32_32x32x16_bf16 v[64:79], v[212:215], v[100:103], v[64:79]
    ds_read_b64_tr_b16 v[92:93], v15 offset:45056
    ds_read_b64_tr_b16 v[94:95], v15 offset:46080
    s_waitcnt lgkmcnt(10)
    v_mfma_f32_32x32x16_bf16 v[64:79], v[216:219], v[104:107], v[64:79]
    ds_read_b64_tr_b16 v[96:97], v15 offset:49152
    ds_read_b64_tr_b16 v[98:99], v15 offset:50176
    s_waitcnt lgkmcnt(10)
    v_mfma_f32_32x32x16_bf16 v[64:79], v[220:223], v[108:111], v[64:79]
    ds_read_b64_tr_b16 v[100:101], v15 offset:53248
    ds_read_b64_tr_b16 v[102:103], v15 offset:54272
    s_waitcnt lgkmcnt(10)
    v_mfma_f32_32x32x16_bf16 v[64:79], v[224:227], v[80:83], v[64:79]
    ds_read_b64_tr_b16 v[104:105], v15 offset:57344
    ds_read_b64_tr_b16 v[106:107], v15 offset:58368
    s_waitcnt lgkmcnt(10)
    v_mfma_f32_32x32x16_bf16 v[64:79], v[228:231], v[84:87], v[64:79]
    ds_read_b64_tr_b16 v[108:109], v15 offset:61440
    ds_read_b64_tr_b16 v[110:111], v15 offset:62464
    s_waitcnt lgkmcnt(10)
    v_mfma_f32_32x32x16_bf16 v[64:79], v[232:235], v[88:91], v[64:79]
    s_waitcnt lgkmcnt(8)
    v_mfma_f32_32x32x16_bf16 v[64:79], v[236:239], v[92:95], v[64:79]
    s_waitcnt lgkmcnt(6)
    v_mfma_f32_32x32x16_bf16 v[64:79], v[240:243], v[96:99], v[64:79]
    s_waitcnt lgkmcnt(4)
    v_mfma_f32_32x32x16_bf16 v[64:79], v[244:247], v[100:103], v[64:79]
    s_waitcnt lgkmcnt(2)
    v_mfma_f32_32x32x16_bf16 v[64:79], v[248:251], v[104:107], v[64:79]
    s_waitcnt lgkmcnt(0)
    v_mfma_f32_32x32x16_bf16 v[64:79], v[252:255], v[108:111], v[64:79]
    v_cvt_pk_bf16_f32 v80, v16, v17
    v_cvt_pk_bf16_f32 v81, v18, v19
    v_cvt_pk_bf16_f32 v82, v20, v21
    v_cvt_pk_bf16_f32 v83, v22, v23
    v_cvt_pk_bf16_f32 v84, v24, v25
    v_cvt_pk_bf16_f32 v85, v26, v27
    v_cvt_pk_bf16_f32 v86, v28, v29
    v_cvt_pk_bf16_f32 v87, v30, v31
    buffer_store_dwordx4 v[80:83], v3, s[40:43], s53 offen offset:0
    buffer_store_dwordx4 v[84:87], v3, s[40:43], s53 offen offset:16
    s_add_u32 s53, s53, 524288
    v_cvt_pk_bf16_f32 v88, v32, v33
    v_cvt_pk_bf16_f32 v89, v34, v35
    v_cvt_pk_bf16_f32 v90, v36, v37
    v_cvt_pk_bf16_f32 v91, v38, v39
    v_cvt_pk_bf16_f32 v92, v40, v41
    v_cvt_pk_bf16_f32 v93, v42, v43
    v_cvt_pk_bf16_f32 v94, v44, v45
    v_cvt_pk_bf16_f32 v95, v46, v47
    buffer_store_dwordx4 v[88:91], v3, s[40:43], s53 offen offset:0
    buffer_store_dwordx4 v[92:95], v3, s[40:43], s53 offen offset:16
    s_add_u32 s53, s53, 524288
    v_cvt_pk_bf16_f32 v96, v48, v49
    v_cvt_pk_bf16_f32 v97, v50, v51
    v_cvt_pk_bf16_f32 v98, v52, v53
    v_cvt_pk_bf16_f32 v99, v54, v55
    v_cvt_pk_bf16_f32 v100, v56, v57
    v_cvt_pk_bf16_f32 v101, v58, v59
    v_cvt_pk_bf16_f32 v102, v60, v61
    v_cvt_pk_bf16_f32 v103, v62, v63
    buffer_store_dwordx4 v[96:99], v3, s[40:43], s53 offen offset:0
    buffer_store_dwordx4 v[100:103], v3, s[40:43], s53 offen offset:16
    s_add_u32 s53, s53, 524288
    v_cvt_pk_bf16_f32 v104, v64, v65
    v_cvt_pk_bf16_f32 v105, v66, v67
    v_cvt_pk_bf16_f32 v106, v68, v69
    v_cvt_pk_bf16_f32 v107, v70, v71
    v_cvt_pk_bf16_f32 v108, v72, v73
    v_cvt_pk_bf16_f32 v109, v74, v75
    v_cvt_pk_bf16_f32 v110, v76, v77
    v_cvt_pk_bf16_f32 v111, v78, v79
    buffer_store_dwordx4 v[104:107], v3, s[40:43], s53 offen offset:0
    buffer_store_dwordx4 v[108:111], v3, s[40:43], s53 offen offset:16
    s_add_u32 s53, s53, 524288
OP:
    s_sub_u32 s51, s45, 160
    s_and_b32 s48, s51, 15
    s_lshr_b32 s49, s51, 4
    s_and_b32 s64, s48, 0
    s_and_b32 s52, s49, 1
    s_lshl_b32 s52, s52, 1
    s_cmp_ge_u32 s51, 64
    s_cselect_b32 s49, s52, s49
    s_cselect_b32 s50, 0, 0
    s_cselect_b32 s59, 0, 62
    s_cselect_b32 s60, 1, 4
    s_cselect_b32 s61, 3, 4
    s_cselect_b32 s62, 0, 1
    s_mov_b32 s63, 1
    s_lshl_b32 s60, s60, 16
    s_lshl_b32 s61, s61, 16
    s_lshl_b32 s52, s50, 2
    s_add_u32 s49, s49, s52
    v_mbcnt_lo_u32_b32 v8, -1, 0
    v_mbcnt_hi_u32_b32 v8, -1, v8
    v_lshlrev_b32 v0, 4, v8
    v_bfe_u32 v9, v8, 3, 1
    v_lshlrev_b32 v9, 5, v9
    v_bfe_u32 v10, v8, 2, 1
    v_add_u32 v9, v9, v10
    v_bfe_u32 v10, v8, 4, 1
    v_lshl_add_u32 v9, v10, 3, v9
    v_lshrrev_b32 v10, 5, v8
    v_lshl_add_u32 v9, v10, 2, v9
    v_and_b32 v10, 3, v8
    v_lshlrev_b32 v11, 4, v10
    v_lshl_add_u32 v6, v9, 10, v11
    s_lshl_b32 s51, s44, 20
    s_lshl_b32 s52, s48, 6
    s_add_u32 s51, s51, s52
    v_add_u32 v6, s51, v6
    v_lshrrev_b32 v9, 2, v8
    v_lshlrev_b32 v9, 6, v9
    v_lshl_add_u32 v5, v10, 3, v9
    s_lshl_b32 s53, s44, 15
    v_add_u32 v5, s53, v5
    s_mov_b32 s40, s24
    s_mov_b32 s41, s25
    s_mov_b32 s42, 4194304
    s_mov_b32 s43, 0x20000
    s_and_b32 s51, s45, 31
    s_lshl_b32 s51, s51, 13
    s_lshl_b32 s52, s44, 20
    s_add_u32 s51, s51, s52
    v_lshlrev_b32 v9, 7, v8
    v_add_u32 v200, s51, v9
    s_mov_b32 s51, 0
    buffer_load_dword v201, v200, s[40:43], s51 offen
    s_mov_b32 s51, 262144
    buffer_load_dword v202, v200, s[40:43], s51 offen
    s_mov_b32 s51, 524288
    buffer_load_dword v203, v200, s[40:43], s51 offen
    s_barrier
    s_add_u32 m0, s53, 0
    s_mov_b32 s51, 0
    buffer_load_dwordx4 v6, s[40:43], s51 offen lds
    s_add_u32 m0, s53, 1024
    s_mov_b32 s51, 2048
    buffer_load_dwordx4 v6, s[40:43], s51 offen lds
    s_add_u32 m0, s53, 2048
    s_mov_b32 s51, 16384
    buffer_load_dwordx4 v6, s[40:43], s51 offen lds
    s_add_u32 m0, s53, 3072
    s_mov_b32 s51, 18432
    buffer_load_dwordx4 v6, s[40:43], s51 offen lds
    s_add_u32 m0, s53, 4096
    s_mov_b32 s51, 65536
    buffer_load_dwordx4 v6, s[40:43], s51 offen lds
    s_add_u32 m0, s53, 5120
    s_mov_b32 s51, 67584
    buffer_load_dwordx4 v6, s[40:43], s51 offen lds
    s_add_u32 m0, s53, 6144
    s_mov_b32 s51, 81920
    buffer_load_dwordx4 v6, s[40:43], s51 offen lds
    s_add_u32 m0, s53, 7168
    s_mov_b32 s51, 83968
    buffer_load_dwordx4 v6, s[40:43], s51 offen lds
    s_add_u32 m0, s53, 8192
    s_mov_b32 s51, 131072
    buffer_load_dwordx4 v6, s[40:43], s51 offen lds
    s_add_u32 m0, s53, 9216
    s_mov_b32 s51, 133120
    buffer_load_dwordx4 v6, s[40:43], s51 offen lds
    s_add_u32 m0, s53, 10240
    s_mov_b32 s51, 147456
    buffer_load_dwordx4 v6, s[40:43], s51 offen lds
    s_add_u32 m0, s53, 11264
    s_mov_b32 s51, 149504
    buffer_load_dwordx4 v6, s[40:43], s51 offen lds
    s_add_u32 m0, s53, 12288
    s_mov_b32 s51, 196608
    buffer_load_dwordx4 v6, s[40:43], s51 offen lds
    s_add_u32 m0, s53, 13312
    s_mov_b32 s51, 198656
    buffer_load_dwordx4 v6, s[40:43], s51 offen lds
    s_add_u32 m0, s53, 14336
    s_mov_b32 s51, 212992
    buffer_load_dwordx4 v6, s[40:43], s51 offen lds
    s_add_u32 m0, s53, 15360
    s_mov_b32 s51, 215040
    buffer_load_dwordx4 v6, s[40:43], s51 offen lds
    s_mov_b32 s51, 786432
    buffer_load_dword v204, v200, s[40:43], s51 offen
    s_add_u32 m0, s53, 16384
    s_mov_b32 s51, 262144
    buffer_load_dwordx4 v6, s[40:43], s51 offen lds
    s_add_u32 m0, s53, 17408
    s_mov_b32 s51, 264192
    buffer_load_dwordx4 v6, s[40:43], s51 offen lds
    s_add_u32 m0, s53, 18432
    s_mov_b32 s51, 278528
    buffer_load_dwordx4 v6, s[40:43], s51 offen lds
    s_add_u32 m0, s53, 19456
    s_mov_b32 s51, 280576
    buffer_load_dwordx4 v6, s[40:43], s51 offen lds
    s_add_u32 m0, s53, 20480
    s_mov_b32 s51, 327680
    buffer_load_dwordx4 v6, s[40:43], s51 offen lds
    s_add_u32 m0, s53, 21504
    s_mov_b32 s51, 329728
    buffer_load_dwordx4 v6, s[40:43], s51 offen lds
    s_add_u32 m0, s53, 22528
    s_mov_b32 s51, 344064
    buffer_load_dwordx4 v6, s[40:43], s51 offen lds
    s_add_u32 m0, s53, 23552
    s_mov_b32 s51, 346112
    buffer_load_dwordx4 v6, s[40:43], s51 offen lds
    s_add_u32 m0, s53, 24576
    s_mov_b32 s51, 393216
    buffer_load_dwordx4 v6, s[40:43], s51 offen lds
    s_add_u32 m0, s53, 25600
    s_mov_b32 s51, 395264
    buffer_load_dwordx4 v6, s[40:43], s51 offen lds
    s_add_u32 m0, s53, 26624
    s_mov_b32 s51, 409600
    buffer_load_dwordx4 v6, s[40:43], s51 offen lds
    s_add_u32 m0, s53, 27648
    s_mov_b32 s51, 411648
    buffer_load_dwordx4 v6, s[40:43], s51 offen lds
    s_add_u32 m0, s53, 28672
    s_mov_b32 s51, 458752
    buffer_load_dwordx4 v6, s[40:43], s51 offen lds
    s_add_u32 m0, s53, 29696
    s_mov_b32 s51, 460800
    buffer_load_dwordx4 v6, s[40:43], s51 offen lds
    s_add_u32 m0, s53, 30720
    s_mov_b32 s51, 475136
    buffer_load_dwordx4 v6, s[40:43], s51 offen lds
    s_add_u32 m0, s53, 31744
    s_mov_b32 s51, 477184
    buffer_load_dwordx4 v6, s[40:43], s51 offen lds
    v_mov_b32 v9, 0x4444
    v_mov_b32 v10, 0xeeee
    v_and_b32 v11, 8, v8
    v_cmp_ne_u32 vcc, 0, v11
    s_nop 1
    v_cndmask_b32 v1, v9, v10, vcc
    v_and_b32 v9, 7, v8
    s_lshl_b32 s51, s44, 5
    v_lshlrev_b32 v2, 2, v9
    v_add_u32 v2, s51, v2
    v_bfe_u32 v160, v8, 3, 2
    v_lshl_add_u32 v2, v160, 7, v2
    v_mov_b32 v7, 0
    s_lshl_b32 s51, s44, 8
    s_add_u32 s51, s51, 131072
    v_lshlrev_b32 v9, 2, v8
    v_add_u32 v3, s51, v9
    s_lshl_b32 s51, s44, 10
    s_add_u32 s51, s51, 131072
    v_add_u32 v161, s51, v9
    v_bfe_u32 v9, v8, 4, 1
    v_lshlrev_b32 v9, 13, v9
    v_lshrrev_b32 v10, 5, v8
    v_lshl_add_u32 v9, v10, 5, v9
    v_and_b32 v10, 15, v8
    v_lshl_add_u32 v9, v10, 1, v9
    v_lshlrev_b32 v10, 31, v8
    s_lshl_b32 s51, s44, 11
    v_add3_u32 v4, v9, v10, s51
    s_lshl_b32 s56, s49, 14
    s_lshl_b32 s52, s48, 6
    s_add_u32 s56, s56, s52
    s_add_u32 s56, s56, 1024
    s_lshl_b32 s55, s49, 16
    s_lshl_b32 s52, s44, 14
    s_add_u32 s55, s55, s52
    s_add_u32 s55, s55, 45088768
    s_waitcnt vmcnt(16)
    ds_read_b64_tr_b16 a[0:1], v5 offset:0
    ds_read_b64_tr_b16 a[8:9], v5 offset:32
    ds_read_b64_tr_b16 a[2:3], v5 offset:1024
    ds_read_b64_tr_b16 a[10:11], v5 offset:1056
    ds_read_b64_tr_b16 a[4:5], v5 offset:2048
    ds_read_b64_tr_b16 a[12:13], v5 offset:2080
    ds_read_b64_tr_b16 a[6:7], v5 offset:3072
    ds_read_b64_tr_b16 a[14:15], v5 offset:3104
    ds_read_b64_tr_b16 a[16:17], v5 offset:4096
    ds_read_b64_tr_b16 a[24:25], v5 offset:4128
    ds_read_b64_tr_b16 a[18:19], v5 offset:5120
    ds_read_b64_tr_b16 a[26:27], v5 offset:5152
    ds_read_b64_tr_b16 a[20:21], v5 offset:6144
    ds_read_b64_tr_b16 a[28:29], v5 offset:6176
    ds_read_b64_tr_b16 a[22:23], v5 offset:7168
    ds_read_b64_tr_b16 a[30:31], v5 offset:7200
    ds_read_b64_tr_b16 a[32:33], v5 offset:8192
    ds_read_b64_tr_b16 a[40:41], v5 offset:8224
    ds_read_b64_tr_b16 a[34:35], v5 offset:9216
    ds_read_b64_tr_b16 a[42:43], v5 offset:9248
    ds_read_b64_tr_b16 a[36:37], v5 offset:10240
    ds_read_b64_tr_b16 a[44:45], v5 offset:10272
    ds_read_b64_tr_b16 a[38:39], v5 offset:11264
    ds_read_b64_tr_b16 a[46:47], v5 offset:11296
    ds_read_b64_tr_b16 a[48:49], v5 offset:12288
    ds_read_b64_tr_b16 a[56:57], v5 offset:12320
    ds_read_b64_tr_b16 a[50:51], v5 offset:13312
    ds_read_b64_tr_b16 a[58:59], v5 offset:13344
    ds_read_b64_tr_b16 a[52:53], v5 offset:14336
    ds_read_b64_tr_b16 a[60:61], v5 offset:14368
    ds_read_b64_tr_b16 a[54:55], v5 offset:15360
    ds_read_b64_tr_b16 a[62:63], v5 offset:15392
    s_waitcnt lgkmcnt(0)
    s_add_u32 m0, s53, 0
    s_mov_b32 s51, 524288
    buffer_load_dwordx4 v6, s[40:43], s51 offen lds
    s_add_u32 m0, s53, 1024
    s_mov_b32 s51, 526336
    buffer_load_dwordx4 v6, s[40:43], s51 offen lds
    s_add_u32 m0, s53, 2048
    s_mov_b32 s51, 540672
    buffer_load_dwordx4 v6, s[40:43], s51 offen lds
    s_add_u32 m0, s53, 3072
    s_mov_b32 s51, 542720
    buffer_load_dwordx4 v6, s[40:43], s51 offen lds
    s_add_u32 m0, s53, 4096
    s_mov_b32 s51, 589824
    buffer_load_dwordx4 v6, s[40:43], s51 offen lds
    s_add_u32 m0, s53, 5120
    s_mov_b32 s51, 591872
    buffer_load_dwordx4 v6, s[40:43], s51 offen lds
    s_add_u32 m0, s53, 6144
    s_mov_b32 s51, 606208
    buffer_load_dwordx4 v6, s[40:43], s51 offen lds
    s_add_u32 m0, s53, 7168
    s_mov_b32 s51, 608256
    buffer_load_dwordx4 v6, s[40:43], s51 offen lds
    s_add_u32 m0, s53, 8192
    s_mov_b32 s51, 655360
    buffer_load_dwordx4 v6, s[40:43], s51 offen lds
    s_add_u32 m0, s53, 9216
    s_mov_b32 s51, 657408
    buffer_load_dwordx4 v6, s[40:43], s51 offen lds
    s_add_u32 m0, s53, 10240
    s_mov_b32 s51, 671744
    buffer_load_dwordx4 v6, s[40:43], s51 offen lds
    s_add_u32 m0, s53, 11264
    s_mov_b32 s51, 673792
    buffer_load_dwordx4 v6, s[40:43], s51 offen lds
    s_add_u32 m0, s53, 12288
    s_mov_b32 s51, 720896
    buffer_load_dwordx4 v6, s[40:43], s51 offen lds
    s_add_u32 m0, s53, 13312
    s_mov_b32 s51, 722944
    buffer_load_dwordx4 v6, s[40:43], s51 offen lds
    s_add_u32 m0, s53, 14336
    s_mov_b32 s51, 737280
    buffer_load_dwordx4 v6, s[40:43], s51 offen lds
    s_add_u32 m0, s53, 15360
    s_mov_b32 s51, 739328
    buffer_load_dwordx4 v6, s[40:43], s51 offen lds
    s_waitcnt vmcnt(16)
    ds_read_b64_tr_b16 a[64:65], v5 offset:16384
    ds_read_b64_tr_b16 a[72:73], v5 offset:16416
    ds_read_b64_tr_b16 a[66:67], v5 offset:17408
    ds_read_b64_tr_b16 a[74:75], v5 offset:17440
    ds_read_b64_tr_b16 a[68:69], v5 offset:18432
    ds_read_b64_tr_b16 a[76:77], v5 offset:18464
    ds_read_b64_tr_b16 a[70:71], v5 offset:19456
    ds_read_b64_tr_b16 a[78:79], v5 offset:19488
    ds_read_b64_tr_b16 a[80:81], v5 offset:20480
    ds_read_b64_tr_b16 a[88:89], v5 offset:20512
    ds_read_b64_tr_b16 a[82:83], v5 offset:21504
    ds_read_b64_tr_b16 a[90:91], v5 offset:21536
    ds_read_b64_tr_b16 a[84:85], v5 offset:22528
    ds_read_b64_tr_b16 a[92:93], v5 offset:22560
    ds_read_b64_tr_b16 a[86:87], v5 offset:23552
    ds_read_b64_tr_b16 a[94:95], v5 offset:23584
    ds_read_b64_tr_b16 a[96:97], v5 offset:24576
    ds_read_b64_tr_b16 a[104:105], v5 offset:24608
    ds_read_b64_tr_b16 a[98:99], v5 offset:25600
    ds_read_b64_tr_b16 a[106:107], v5 offset:25632
    ds_read_b64_tr_b16 a[100:101], v5 offset:26624
    ds_read_b64_tr_b16 a[108:109], v5 offset:26656
    ds_read_b64_tr_b16 a[102:103], v5 offset:27648
    ds_read_b64_tr_b16 a[110:111], v5 offset:27680
    ds_read_b64_tr_b16 a[112:113], v5 offset:28672
    ds_read_b64_tr_b16 a[120:121], v5 offset:28704
    ds_read_b64_tr_b16 a[114:115], v5 offset:29696
    ds_read_b64_tr_b16 a[122:123], v5 offset:29728
    ds_read_b64_tr_b16 a[116:117], v5 offset:30720
    ds_read_b64_tr_b16 a[124:125], v5 offset:30752
    ds_read_b64_tr_b16 a[118:119], v5 offset:31744
    ds_read_b64_tr_b16 a[126:127], v5 offset:31776
    s_waitcnt lgkmcnt(0)
    s_add_u32 m0, s53, 16384
    s_mov_b32 s51, 786432
    buffer_load_dwordx4 v6, s[40:43], s51 offen lds
    s_add_u32 m0, s53, 17408
    s_mov_b32 s51, 788480
    buffer_load_dwordx4 v6, s[40:43], s51 offen lds
    s_add_u32 m0, s53, 18432
    s_mov_b32 s51, 802816
    buffer_load_dwordx4 v6, s[40:43], s51 offen lds
    s_add_u32 m0, s53, 19456
    s_mov_b32 s51, 804864
    buffer_load_dwordx4 v6, s[40:43], s51 offen lds
    s_add_u32 m0, s53, 20480
    s_mov_b32 s51, 851968
    buffer_load_dwordx4 v6, s[40:43], s51 offen lds
    s_add_u32 m0, s53, 21504
    s_mov_b32 s51, 854016
    buffer_load_dwordx4 v6, s[40:43], s51 offen lds
    s_add_u32 m0, s53, 22528
    s_mov_b32 s51, 868352
    buffer_load_dwordx4 v6, s[40:43], s51 offen lds
    s_add_u32 m0, s53, 23552
    s_mov_b32 s51, 870400
    buffer_load_dwordx4 v6, s[40:43], s51 offen lds
    s_add_u32 m0, s53, 24576
    s_mov_b32 s51, 917504
    buffer_load_dwordx4 v6, s[40:43], s51 offen lds
    s_add_u32 m0, s53, 25600
    s_mov_b32 s51, 919552
    buffer_load_dwordx4 v6, s[40:43], s51 offen lds
    s_add_u32 m0, s53, 26624
    s_mov_b32 s51, 933888
    buffer_load_dwordx4 v6, s[40:43], s51 offen lds
    s_add_u32 m0, s53, 27648
    s_mov_b32 s51, 935936
    buffer_load_dwordx4 v6, s[40:43], s51 offen lds
    s_add_u32 m0, s53, 28672
    s_mov_b32 s51, 983040
    buffer_load_dwordx4 v6, s[40:43], s51 offen lds
    s_add_u32 m0, s53, 29696
    s_mov_b32 s51, 985088
    buffer_load_dwordx4 v6, s[40:43], s51 offen lds
    s_add_u32 m0, s53, 30720
    s_mov_b32 s51, 999424
    buffer_load_dwordx4 v6, s[40:43], s51 offen lds
    s_add_u32 m0, s53, 31744
    s_mov_b32 s51, 1001472
    buffer_load_dwordx4 v6, s[40:43], s51 offen lds
    s_waitcnt vmcnt(16)
    ds_read_b64_tr_b16 a[128:129], v5 offset:0
    ds_read_b64_tr_b16 a[136:137], v5 offset:32
    ds_read_b64_tr_b16 a[130:131], v5 offset:1024
    ds_read_b64_tr_b16 a[138:139], v5 offset:1056
    ds_read_b64_tr_b16 a[132:133], v5 offset:2048
    ds_read_b64_tr_b16 a[140:141], v5 offset:2080
    ds_read_b64_tr_b16 a[134:135], v5 offset:3072
    ds_read_b64_tr_b16 a[142:143], v5 offset:3104
    ds_read_b64_tr_b16 a[144:145], v5 offset:4096
    ds_read_b64_tr_b16 a[152:153], v5 offset:4128
    ds_read_b64_tr_b16 a[146:147], v5 offset:5120
    ds_read_b64_tr_b16 a[154:155], v5 offset:5152
    ds_read_b64_tr_b16 a[148:149], v5 offset:6144
    ds_read_b64_tr_b16 a[156:157], v5 offset:6176
    ds_read_b64_tr_b16 a[150:151], v5 offset:7168
    ds_read_b64_tr_b16 a[158:159], v5 offset:7200
    ds_read_b64_tr_b16 a[160:161], v5 offset:8192
    ds_read_b64_tr_b16 a[168:169], v5 offset:8224
    ds_read_b64_tr_b16 a[162:163], v5 offset:9216
    ds_read_b64_tr_b16 a[170:171], v5 offset:9248
    ds_read_b64_tr_b16 a[164:165], v5 offset:10240
    ds_read_b64_tr_b16 a[172:173], v5 offset:10272
    ds_read_b64_tr_b16 a[166:167], v5 offset:11264
    ds_read_b64_tr_b16 a[174:175], v5 offset:11296
    ds_read_b64_tr_b16 a[176:177], v5 offset:12288
    ds_read_b64_tr_b16 a[184:185], v5 offset:12320
    ds_read_b64_tr_b16 a[178:179], v5 offset:13312
    ds_read_b64_tr_b16 a[186:187], v5 offset:13344
    ds_read_b64_tr_b16 a[180:181], v5 offset:14336
    ds_read_b64_tr_b16 a[188:189], v5 offset:14368
    ds_read_b64_tr_b16 a[182:183], v5 offset:15360
    ds_read_b64_tr_b16 a[190:191], v5 offset:15392
    s_waitcnt lgkmcnt(0)
    s_waitcnt vmcnt(0)
    ds_read_b64_tr_b16 a[192:193], v5 offset:16384
    ds_read_b64_tr_b16 a[200:201], v5 offset:16416
    ds_read_b64_tr_b16 a[194:195], v5 offset:17408
    ds_read_b64_tr_b16 a[202:203], v5 offset:17440
    ds_read_b64_tr_b16 a[196:197], v5 offset:18432
    ds_read_b64_tr_b16 a[204:205], v5 offset:18464
    ds_read_b64_tr_b16 a[198:199], v5 offset:19456
    ds_read_b64_tr_b16 a[206:207], v5 offset:19488
    ds_read_b64_tr_b16 a[208:209], v5 offset:20480
    ds_read_b64_tr_b16 a[216:217], v5 offset:20512
    ds_read_b64_tr_b16 a[210:211], v5 offset:21504
    ds_read_b64_tr_b16 a[218:219], v5 offset:21536
    ds_read_b64_tr_b16 a[212:213], v5 offset:22528
    ds_read_b64_tr_b16 a[220:221], v5 offset:22560
    ds_read_b64_tr_b16 a[214:215], v5 offset:23552
    ds_read_b64_tr_b16 a[222:223], v5 offset:23584
    ds_read_b64_tr_b16 a[224:225], v5 offset:24576
    ds_read_b64_tr_b16 a[232:233], v5 offset:24608
    ds_read_b64_tr_b16 a[226:227], v5 offset:25600
    ds_read_b64_tr_b16 a[234:235], v5 offset:25632
    ds_read_b64_tr_b16 a[228:229], v5 offset:26624
    ds_read_b64_tr_b16 a[236:237], v5 offset:26656
    ds_read_b64_tr_b16 a[230:231], v5 offset:27648
    ds_read_b64_tr_b16 a[238:239], v5 offset:27680
    ds_read_b64_tr_b16 a[240:241], v5 offset:28672
    ds_read_b64_tr_b16 a[248:249], v5 offset:28704
    ds_read_b64_tr_b16 a[242:243], v5 offset:29696
    ds_read_b64_tr_b16 a[250:251], v5 offset:29728
    ds_read_b64_tr_b16 a[244:245], v5 offset:30720
    ds_read_b64_tr_b16 a[252:253], v5 offset:30752
    ds_read_b64_tr_b16 a[246:247], v5 offset:31744
    ds_read_b64_tr_b16 a[254:255], v5 offset:31776
    s_waitcnt lgkmcnt(0)
    s_mov_b32 s40, s28
    s_mov_b32 s41, s29
    s_mov_b32 s42, 4194304
    s_mov_b32 s43, 0x20000
    s_mov_b32 s54, 0
    v_mov_b32 v9, 4
OP_INIT:
    global_load_dword v10, v9, s[30:31] sc1
    s_add_u32 s54, s54, 1
    s_cmp_gt_u32 s54, 65536
    s_cbranch_scc1 EXIT
    s_waitcnt vmcnt(0)
    v_readfirstlane_b32 s51, v10
    s_nop 0
    s_cmp_ge_u32 s51, 128
    s_cbranch_scc1 OP_INIT_OK
    s_sleep 4
    s_branch OP_INIT
OP_INIT_OK:
    s_mov_b32 s57, 4096
    s_mov_b32 s58, 0
    s_cmp_lg_u32 s59, 0
    s_cbranch_scc1 OP_LOOP
    s_mov_b32 s54, 0
OP_NAP:
    s_sleep 40
    buffer_load_dword v7, v2, s[36:39], s57 offen sc1
    s_add_u32 s54, s54, 1
    s_cmp_gt_u32 s54, 65536
    s_cbranch_scc1 EXIT
    s_waitcnt vmcnt(0)
    v_lshl_add_u32 v7, v7, 2, v160
    v_cmp_ge_u32 vcc, 59, v7
    s_cbranch_vccnz OP_NAP
    s_getpc_b64 s[66:67]
    v_lshlrev_b32 v24, 1, v0
    global_load_dword v24, v24, s[66:67] offset:256
    s_branch OP_S62
OP_LOOP:
    v_mov_b64 v[8:9], 0
    v_mov_b64 v[10:11], 0
    v_mov_b64 v[12:13], 0
    v_mov_b64 v[14:15], 0
    s_cmp_lg_u32 s58, 0
    s_cbranch_scc1 OP_HAVE0
    s_mov_b32 s54, 0
OP_W0:
    buffer_load_dword v7, v2, s[36:39], s57 offen sc1
    s_add_u32 s54, s54, 1
    s_cmp_gt_u32 s54, 65536
    s_cbranch_scc1 EXIT
    s_waitcnt vmcnt(0)
    v_lshl_add_u32 v7, v7, 2, v160
    v_cmp_ge_u32 vcc, s50, v7
    s_cbranch_vccz OP_GO0
    s_sleep 6
    s_branch OP_W0
OP_GO0:
    s_add_u32 s51, s55, 0
    buffer_load_dwordx4 v[32:35], v0, s[36:39], s51 offen offset:0 sc1
    buffer_load_dwordx4 v[36:39], v0, s[36:39], s51 offen offset:1024 sc1
    buffer_load_dwordx4 v[40:43], v0, s[36:39], s51 offen offset:2048 sc1
    buffer_load_dwordx4 v[44:47], v0, s[36:39], s51 offen offset:3072 sc1
    s_add_u32 s51, s55, 4096
    buffer_load_dwordx4 v[48:51], v0, s[36:39], s51 offen offset:0 sc1
    buffer_load_dwordx4 v[52:55], v0, s[36:39], s51 offen offset:1024 sc1
    buffer_load_dwordx4 v[56:59], v0, s[36:39], s51 offen offset:2048 sc1
    buffer_load_dwordx4 v[60:63], v0, s[36:39], s51 offen offset:3072 sc1
    s_add_u32 s51, s55, 8192
    buffer_load_dwordx4 v[64:67], v0, s[36:39], s51 offen offset:0 sc1
    buffer_load_dwordx4 v[68:71], v0, s[36:39], s51 offen offset:1024 sc1
    buffer_load_dwordx4 v[72:75], v0, s[36:39], s51 offen offset:2048 sc1
    buffer_load_dwordx4 v[76:79], v0, s[36:39], s51 offen offset:3072 sc1
    s_add_u32 s51, s55, 12288
    buffer_load_dwordx4 v[80:83], v0, s[36:39], s51 offen offset:0 sc1
    buffer_load_dwordx4 v[84:87], v0, s[36:39], s51 offen offset:1024 sc1
    buffer_load_dwordx4 v[88:91], v0, s[36:39], s51 offen offset:2048 sc1
    buffer_load_dwordx4 v[92:95], v0, s[36:39], s51 offen offset:3072 sc1
OP_HAVE0:
    s_add_u32 s50, s50, s62
    s_add_u32 s55, s55, s60
    v_cmp_ge_u32 vcc, s50, v7
    s_mov_b32 s58, 0
    s_cbranch_vccnz OP_FINE0
    s_mov_b32 s58, 1
    s_add_u32 s51, s55, 0
    buffer_load_dwordx4 v[96:99], v0, s[36:39], s51 offen offset:0 sc1
    buffer_load_dwordx4 v[100:103], v0, s[36:39], s51 offen offset:1024 sc1
    buffer_load_dwordx4 v[104:107], v0, s[36:39], s51 offen offset:2048 sc1
    s_waitcnt vmcnt(18)
    v_smfmac_f32_16x16x64_bf16 v[8:11], v[32:35], a[0:7], v1
    v_smfmac_f32_16x16x64_bf16 v[12:15], v[32:35], a[8:15], v1
    buffer_load_dwordx4 v[108:111], v0, s[36:39], s51 offen offset:3072 sc1
    s_waitcnt vmcnt(18)
    v_smfmac_f32_16x16x64_bf16 v[8:11], v[36:39], a[16:23], v1
    v_smfmac_f32_16x16x64_bf16 v[12:15], v[36:39], a[24:31], v1
    s_add_u32 s51, s55, 4096
    buffer_load_dwordx4 v[112:115], v0, s[36:39], s51 offen offset:0 sc1
    s_waitcnt vmcnt(18)
    v_smfmac_f32_16x16x64_bf16 v[8:11], v[40:43], a[32:39], v1
    v_smfmac_f32_16x16x64_bf16 v[12:15], v[40:43], a[40:47], v1
    buffer_load_dwordx4 v[116:119], v0, s[36:39], s51 offen offset:1024 sc1
    s_waitcnt vmcnt(18)
    v_smfmac_f32_16x16x64_bf16 v[8:11], v[44:47], a[48:55], v1
    v_smfmac_f32_16x16x64_bf16 v[12:15], v[44:47], a[56:63], v1
    buffer_load_dwordx4 v[120:123], v0, s[36:39], s51 offen offset:2048 sc1
    s_waitcnt vmcnt(18)
    v_smfmac_f32_16x16x64_bf16 v[8:11], v[48:51], a[64:71], v1
    v_smfmac_f32_16x16x64_bf16 v[12:15], v[48:51], a[72:79], v1
    buffer_load_dwordx4 v[124:127], v0, s[36:39], s51 offen offset:3072 sc1
    s_waitcnt vmcnt(18)
    v_smfmac_f32_16x16x64_bf16 v[8:11], v[52:55], a[80:87], v1
    v_smfmac_f32_16x16x64_bf16 v[12:15], v[52:55], a[88:95], v1
    s_add_u32 s51, s55, 8192
    buffer_load_dwordx4 v[128:131], v0, s[36:39], s51 offen offset:0 sc1
    s_waitcnt vmcnt(18)
    v_smfmac_f32_16x16x64_bf16 v[8:11], v[56:59], a[96:103], v1
    v_smfmac_f32_16x16x64_bf16 v[12:15], v[56:59], a[104:111], v1
    buffer_load_dwordx4 v[132:135], v0, s[36:39], s51 offen offset:1024 sc1
    s_waitcnt vmcnt(18)
    v_smfmac_f32_16x16x64_bf16 v[8:11], v[60:63], a[112:119], v1
    v_smfmac_f32_16x16x64_bf16 v[12:15], v[60:63], a[120:127], v1
    buffer_load_dwordx4 v[136:139], v0, s[36:39], s51 offen offset:2048 sc1
    s_waitcnt vmcnt(18)
    v_smfmac_f32_16x16x64_bf16 v[8:11], v[64:67], a[128:135], v1
    v_smfmac_f32_16x16x64_bf16 v[12:15], v[64:67], a[136:143], v1
    buffer_load_dwordx4 v[140:143], v0, s[36:39], s51 offen offset:3072 sc1
    s_waitcnt vmcnt(18)
    v_smfmac_f32_16x16x64_bf16 v[8:11], v[68:71], a[144:151], v1
    v_smfmac_f32_16x16x64_bf16 v[12:15], v[68:71], a[152:159], v1
    s_add_u32 s51, s55, 12288
    buffer_load_dwordx4 v[144:147], v0, s[36:39], s51 offen offset:0 sc1
    s_waitcnt vmcnt(18)
    v_smfmac_f32_16x16x64_bf16 v[8:11], v[72:75], a[160:167], v1
    v_smfmac_f32_16x16x64_bf16 v[12:15], v[72:75], a[168:175], v1
    buffer_load_dwordx4 v[148:151], v0, s[36:39], s51 offen offset:1024 sc1
    s_waitcnt vmcnt(18)
    v_smfmac_f32_16x16x64_bf16 v[8:11], v[76:79], a[176:183], v1
    v_smfmac_f32_16x16x64_bf16 v[12:15], v[76:79], a[184:191], v1
    buffer_load_dwordx4 v[152:155], v0, s[36:39], s51 offen offset:2048 sc1
    s_waitcnt vmcnt(18)
    v_smfmac_f32_16x16x64_bf16 v[8:11], v[80:83], a[192:199], v1
    v_smfmac_f32_16x16x64_bf16 v[12:15], v[80:83], a[200:207], v1
    buffer_load_dwordx4 v[156:159], v0, s[36:39], s51 offen offset:3072 sc1
    s_waitcnt vmcnt(18)
    v_smfmac_f32_16x16x64_bf16 v[8:11], v[84:87], a[208:215], v1
    v_smfmac_f32_16x16x64_bf16 v[12:15], v[84:87], a[216:223], v1
    s_waitcnt vmcnt(17)
    v_smfmac_f32_16x16x64_bf16 v[8:11], v[88:91], a[224:231], v1
    v_smfmac_f32_16x16x64_bf16 v[12:15], v[88:91], a[232:239], v1
    s_waitcnt vmcnt(16)
    v_smfmac_f32_16x16x64_bf16 v[8:11], v[92:95], a[240:247], v1
    v_smfmac_f32_16x16x64_bf16 v[12:15], v[92:95], a[248:255], v1
    s_branch OP_RED0
OP_FINE0:
    s_waitcnt vmcnt(15)
    v_smfmac_f32_16x16x64_bf16 v[8:11], v[32:35], a[0:7], v1
    v_smfmac_f32_16x16x64_bf16 v[12:15], v[32:35], a[8:15], v1
    s_waitcnt vmcnt(14)
    v_smfmac_f32_16x16x64_bf16 v[8:11], v[36:39], a[16:23], v1
    v_smfmac_f32_16x16x64_bf16 v[12:15], v[36:39], a[24:31], v1
    s_waitcnt vmcnt(13)
    v_smfmac_f32_16x16x64_bf16 v[8:11], v[40:43], a[32:39], v1
    v_smfmac_f32_16x16x64_bf16 v[12:15], v[40:43], a[40:47], v1
    s_waitcnt vmcnt(12)
    v_smfmac_f32_16x16x64_bf16 v[8:11], v[44:47], a[48:55], v1
    v_smfmac_f32_16x16x64_bf16 v[12:15], v[44:47], a[56:63], v1
    s_waitcnt vmcnt(11)
    v_smfmac_f32_16x16x64_bf16 v[8:11], v[48:51], a[64:71], v1
    v_smfmac_f32_16x16x64_bf16 v[12:15], v[48:51], a[72:79], v1
    s_waitcnt vmcnt(10)
    v_smfmac_f32_16x16x64_bf16 v[8:11], v[52:55], a[80:87], v1
    v_smfmac_f32_16x16x64_bf16 v[12:15], v[52:55], a[88:95], v1
    s_waitcnt vmcnt(9)
    v_smfmac_f32_16x16x64_bf16 v[8:11], v[56:59], a[96:103], v1
    v_smfmac_f32_16x16x64_bf16 v[12:15], v[56:59], a[104:111], v1
    s_waitcnt vmcnt(8)
    v_smfmac_f32_16x16x64_bf16 v[8:11], v[60:63], a[112:119], v1
    v_smfmac_f32_16x16x64_bf16 v[12:15], v[60:63], a[120:127], v1
    s_waitcnt vmcnt(7)
    v_smfmac_f32_16x16x64_bf16 v[8:11], v[64:67], a[128:135], v1
    v_smfmac_f32_16x16x64_bf16 v[12:15], v[64:67], a[136:143], v1
    s_waitcnt vmcnt(6)
    v_smfmac_f32_16x16x64_bf16 v[8:11], v[68:71], a[144:151], v1
    v_smfmac_f32_16x16x64_bf16 v[12:15], v[68:71], a[152:159], v1
    s_waitcnt vmcnt(5)
    v_smfmac_f32_16x16x64_bf16 v[8:11], v[72:75], a[160:167], v1
    v_smfmac_f32_16x16x64_bf16 v[12:15], v[72:75], a[168:175], v1
    s_waitcnt vmcnt(4)
    v_smfmac_f32_16x16x64_bf16 v[8:11], v[76:79], a[176:183], v1
    v_smfmac_f32_16x16x64_bf16 v[12:15], v[76:79], a[184:191], v1
    s_waitcnt vmcnt(3)
    v_smfmac_f32_16x16x64_bf16 v[8:11], v[80:83], a[192:199], v1
    v_smfmac_f32_16x16x64_bf16 v[12:15], v[80:83], a[200:207], v1
    s_waitcnt vmcnt(2)
    v_smfmac_f32_16x16x64_bf16 v[8:11], v[84:87], a[208:215], v1
    v_smfmac_f32_16x16x64_bf16 v[12:15], v[84:87], a[216:223], v1
    s_waitcnt vmcnt(1)
    v_smfmac_f32_16x16x64_bf16 v[8:11], v[88:91], a[224:231], v1
    v_smfmac_f32_16x16x64_bf16 v[12:15], v[88:91], a[232:239], v1
    s_waitcnt vmcnt(0)
    v_smfmac_f32_16x16x64_bf16 v[8:11], v[92:95], a[240:247], v1
    v_smfmac_f32_16x16x64_bf16 v[12:15], v[92:95], a[248:255], v1
OP_RED0:
    s_nop 7
    v_permlane32_swap_b32 v8, v12
    v_permlane32_swap_b32 v9, v13
    v_permlane32_swap_b32 v10, v14
    v_permlane32_swap_b32 v11, v15
    v_add_f32 v8, v8, v12
    v_add_f32 v9, v9, v13
    v_add_f32 v10, v10, v14
    v_add_f32 v11, v11, v15
    ds_write2st64_b32 v3, v8, v9 offset0:0 offset1:4
    ds_write2st64_b32 v3, v10, v11 offset0:8 offset1:12
    s_waitcnt lgkmcnt(0)
    s_barrier
    ds_read2st64_b32 v[16:17], v161 offset0:0 offset1:1
    ds_read2st64_b32 v[18:19], v161 offset0:2 offset1:3
    s_waitcnt lgkmcnt(0)
    v_add_f32 v16, v16, v17
    v_add_f32 v18, v18, v19
    v_add_f32 v16, v16, v18
    s_nop 1
    v_mov_b32_dpp v17, v16 quad_perm:[1,0,3,2] row_mask:0xf bank_mask:0xf
    v_cvt_pk_bf16_f32 v16, v16, v17
    buffer_store_dword v16, v4, s[40:43], s56 offen sc1
OP_NEXT0:
    s_lshr_b32 s51, s60, 2
    s_add_u32 s56, s56, s51
    v_mov_b64 v[8:9], 0
    v_mov_b64 v[10:11], 0
    v_mov_b64 v[12:13], 0
    v_mov_b64 v[14:15], 0
    s_cmp_lg_u32 s58, 0
    s_cbranch_scc1 OP_HAVE1
    s_mov_b32 s54, 0
OP_W1:
    buffer_load_dword v7, v2, s[36:39], s57 offen sc1
    s_add_u32 s54, s54, 1
    s_cmp_gt_u32 s54, 65536
    s_cbranch_scc1 EXIT
    s_waitcnt vmcnt(0)
    v_lshl_add_u32 v7, v7, 2, v160
    v_cmp_ge_u32 vcc, s50, v7
    s_cbranch_vccz OP_GO1
    s_sleep 6
    s_branch OP_W1
OP_GO1:
    s_add_u32 s51, s55, 0
    buffer_load_dwordx4 v[96:99], v0, s[36:39], s51 offen offset:0 sc1
    buffer_load_dwordx4 v[100:103], v0, s[36:39], s51 offen offset:1024 sc1
    buffer_load_dwordx4 v[104:107], v0, s[36:39], s51 offen offset:2048 sc1
    buffer_load_dwordx4 v[108:111], v0, s[36:39], s51 offen offset:3072 sc1
    s_add_u32 s51, s55, 4096
    buffer_load_dwordx4 v[112:115], v0, s[36:39], s51 offen offset:0 sc1
    buffer_load_dwordx4 v[116:119], v0, s[36:39], s51 offen offset:1024 sc1
    buffer_load_dwordx4 v[120:123], v0, s[36:39], s51 offen offset:2048 sc1
    buffer_load_dwordx4 v[124:127], v0, s[36:39], s51 offen offset:3072 sc1
    s_add_u32 s51, s55, 8192
    buffer_load_dwordx4 v[128:131], v0, s[36:39], s51 offen offset:0 sc1
    buffer_load_dwordx4 v[132:135], v0, s[36:39], s51 offen offset:1024 sc1
    buffer_load_dwordx4 v[136:139], v0, s[36:39], s51 offen offset:2048 sc1
    buffer_load_dwordx4 v[140:143], v0, s[36:39], s51 offen offset:3072 sc1
    s_add_u32 s51, s55, 12288
    buffer_load_dwordx4 v[144:147], v0, s[36:39], s51 offen offset:0 sc1
    buffer_load_dwordx4 v[148:151], v0, s[36:39], s51 offen offset:1024 sc1
    buffer_load_dwordx4 v[152:155], v0, s[36:39], s51 offen offset:2048 sc1
    buffer_load_dwordx4 v[156:159], v0, s[36:39], s51 offen offset:3072 sc1
OP_HAVE1:
    s_add_u32 s50, s50, s63
    s_add_u32 s55, s55, s61
    v_cmp_ge_u32 vcc, s50, v7
    s_mov_b32 s58, 0
    s_cbranch_vccnz OP_FINE1
    s_mov_b32 s58, 1
    s_add_u32 s51, s55, 0
    buffer_load_dwordx4 v[32:35], v0, s[36:39], s51 offen offset:0 sc1
    buffer_load_dwordx4 v[36:39], v0, s[36:39], s51 offen offset:1024 sc1
    buffer_load_dwordx4 v[40:43], v0, s[36:39], s51 offen offset:2048 sc1
    s_waitcnt vmcnt(18)
    v_smfmac_f32_16x16x64_bf16 v[8:11], v[96:99], a[0:7], v1
    v_smfmac_f32_16x16x64_bf16 v[12:15], v[96:99], a[8:15], v1
    buffer_load_dwordx4 v[44:47], v0, s[36:39], s51 offen offset:3072 sc1
    s_waitcnt vmcnt(18)
    v_smfmac_f32_16x16x64_bf16 v[8:11], v[100:103], a[16:23], v1
    v_smfmac_f32_16x16x64_bf16 v[12:15], v[100:103], a[24:31], v1
    s_add_u32 s51, s55, 4096
    buffer_load_dwordx4 v[48:51], v0, s[36:39], s51 offen offset:0 sc1
    s_waitcnt vmcnt(18)
    v_smfmac_f32_16x16x64_bf16 v[8:11], v[104:107], a[32:39], v1
    v_smfmac_f32_16x16x64_bf16 v[12:15], v[104:107], a[40:47], v1
    buffer_load_dwordx4 v[52:55], v0, s[36:39], s51 offen offset:1024 sc1
    s_waitcnt vmcnt(18)
    v_smfmac_f32_16x16x64_bf16 v[8:11], v[108:111], a[48:55], v1
    v_smfmac_f32_16x16x64_bf16 v[12:15], v[108:111], a[56:63], v1
    buffer_load_dwordx4 v[56:59], v0, s[36:39], s51 offen offset:2048 sc1
    s_waitcnt vmcnt(18)
    v_smfmac_f32_16x16x64_bf16 v[8:11], v[112:115], a[64:71], v1
    v_smfmac_f32_16x16x64_bf16 v[12:15], v[112:115], a[72:79], v1
    buffer_load_dwordx4 v[60:63], v0, s[36:39], s51 offen offset:3072 sc1
    s_waitcnt vmcnt(18)
    v_smfmac_f32_16x16x64_bf16 v[8:11], v[116:119], a[80:87], v1
    v_smfmac_f32_16x16x64_bf16 v[12:15], v[116:119], a[88:95], v1
    s_add_u32 s51, s55, 8192
    buffer_load_dwordx4 v[64:67], v0, s[36:39], s51 offen offset:0 sc1
    s_waitcnt vmcnt(18)
    v_smfmac_f32_16x16x64_bf16 v[8:11], v[120:123], a[96:103], v1
    v_smfmac_f32_16x16x64_bf16 v[12:15], v[120:123], a[104:111], v1
    buffer_load_dwordx4 v[68:71], v0, s[36:39], s51 offen offset:1024 sc1
    s_waitcnt vmcnt(18)
    v_smfmac_f32_16x16x64_bf16 v[8:11], v[124:127], a[112:119], v1
    v_smfmac_f32_16x16x64_bf16 v[12:15], v[124:127], a[120:127], v1
    buffer_load_dwordx4 v[72:75], v0, s[36:39], s51 offen offset:2048 sc1
    s_waitcnt vmcnt(18)
    v_smfmac_f32_16x16x64_bf16 v[8:11], v[128:131], a[128:135], v1
    v_smfmac_f32_16x16x64_bf16 v[12:15], v[128:131], a[136:143], v1
    buffer_load_dwordx4 v[76:79], v0, s[36:39], s51 offen offset:3072 sc1
    s_waitcnt vmcnt(18)
    v_smfmac_f32_16x16x64_bf16 v[8:11], v[132:135], a[144:151], v1
    v_smfmac_f32_16x16x64_bf16 v[12:15], v[132:135], a[152:159], v1
    s_add_u32 s51, s55, 12288
    buffer_load_dwordx4 v[80:83], v0, s[36:39], s51 offen offset:0 sc1
    s_waitcnt vmcnt(18)
    v_smfmac_f32_16x16x64_bf16 v[8:11], v[136:139], a[160:167], v1
    v_smfmac_f32_16x16x64_bf16 v[12:15], v[136:139], a[168:175], v1
    buffer_load_dwordx4 v[84:87], v0, s[36:39], s51 offen offset:1024 sc1
    s_waitcnt vmcnt(18)
    v_smfmac_f32_16x16x64_bf16 v[8:11], v[140:143], a[176:183], v1
    v_smfmac_f32_16x16x64_bf16 v[12:15], v[140:143], a[184:191], v1
    buffer_load_dwordx4 v[88:91], v0, s[36:39], s51 offen offset:2048 sc1
    s_waitcnt vmcnt(18)
    v_smfmac_f32_16x16x64_bf16 v[8:11], v[144:147], a[192:199], v1
    v_smfmac_f32_16x16x64_bf16 v[12:15], v[144:147], a[200:207], v1
    buffer_load_dwordx4 v[92:95], v0, s[36:39], s51 offen offset:3072 sc1
    s_waitcnt vmcnt(18)
    v_smfmac_f32_16x16x64_bf16 v[8:11], v[148:151], a[208:215], v1
    v_smfmac_f32_16x16x64_bf16 v[12:15], v[148:151], a[216:223], v1
    s_waitcnt vmcnt(17)
    v_smfmac_f32_16x16x64_bf16 v[8:11], v[152:155], a[224:231], v1
    v_smfmac_f32_16x16x64_bf16 v[12:15], v[152:155], a[232:239], v1
    s_waitcnt vmcnt(16)
    v_smfmac_f32_16x16x64_bf16 v[8:11], v[156:159], a[240:247], v1
    v_smfmac_f32_16x16x64_bf16 v[12:15], v[156:159], a[248:255], v1
    s_branch OP_RED1
OP_FINE1:
    s_waitcnt vmcnt(15)
    v_smfmac_f32_16x16x64_bf16 v[8:11], v[96:99], a[0:7], v1
    v_smfmac_f32_16x16x64_bf16 v[12:15], v[96:99], a[8:15], v1
    s_waitcnt vmcnt(14)
    v_smfmac_f32_16x16x64_bf16 v[8:11], v[100:103], a[16:23], v1
    v_smfmac_f32_16x16x64_bf16 v[12:15], v[100:103], a[24:31], v1
    s_waitcnt vmcnt(13)
    v_smfmac_f32_16x16x64_bf16 v[8:11], v[104:107], a[32:39], v1
    v_smfmac_f32_16x16x64_bf16 v[12:15], v[104:107], a[40:47], v1
    s_waitcnt vmcnt(12)
    v_smfmac_f32_16x16x64_bf16 v[8:11], v[108:111], a[48:55], v1
    v_smfmac_f32_16x16x64_bf16 v[12:15], v[108:111], a[56:63], v1
    s_waitcnt vmcnt(11)
    v_smfmac_f32_16x16x64_bf16 v[8:11], v[112:115], a[64:71], v1
    v_smfmac_f32_16x16x64_bf16 v[12:15], v[112:115], a[72:79], v1
    s_waitcnt vmcnt(10)
    v_smfmac_f32_16x16x64_bf16 v[8:11], v[116:119], a[80:87], v1
    v_smfmac_f32_16x16x64_bf16 v[12:15], v[116:119], a[88:95], v1
    s_waitcnt vmcnt(9)
    v_smfmac_f32_16x16x64_bf16 v[8:11], v[120:123], a[96:103], v1
    v_smfmac_f32_16x16x64_bf16 v[12:15], v[120:123], a[104:111], v1
    s_waitcnt vmcnt(8)
    v_smfmac_f32_16x16x64_bf16 v[8:11], v[124:127], a[112:119], v1
    v_smfmac_f32_16x16x64_bf16 v[12:15], v[124:127], a[120:127], v1
    s_waitcnt vmcnt(7)
    v_smfmac_f32_16x16x64_bf16 v[8:11], v[128:131], a[128:135], v1
    v_smfmac_f32_16x16x64_bf16 v[12:15], v[128:131], a[136:143], v1
    s_waitcnt vmcnt(6)
    v_smfmac_f32_16x16x64_bf16 v[8:11], v[132:135], a[144:151], v1
    v_smfmac_f32_16x16x64_bf16 v[12:15], v[132:135], a[152:159], v1
    s_waitcnt vmcnt(5)
    v_smfmac_f32_16x16x64_bf16 v[8:11], v[136:139], a[160:167], v1
    v_smfmac_f32_16x16x64_bf16 v[12:15], v[136:139], a[168:175], v1
    s_waitcnt vmcnt(4)
    v_smfmac_f32_16x16x64_bf16 v[8:11], v[140:143], a[176:183], v1
    v_smfmac_f32_16x16x64_bf16 v[12:15], v[140:143], a[184:191], v1
    s_waitcnt vmcnt(3)
    v_smfmac_f32_16x16x64_bf16 v[8:11], v[144:147], a[192:199], v1
    v_smfmac_f32_16x16x64_bf16 v[12:15], v[144:147], a[200:207], v1
    s_waitcnt vmcnt(2)
    v_smfmac_f32_16x16x64_bf16 v[8:11], v[148:151], a[208:215], v1
    v_smfmac_f32_16x16x64_bf16 v[12:15], v[148:151], a[216:223], v1
    s_waitcnt vmcnt(1)
    v_smfmac_f32_16x16x64_bf16 v[8:11], v[152:155], a[224:231], v1
    v_smfmac_f32_16x16x64_bf16 v[12:15], v[152:155], a[232:239], v1
    s_waitcnt vmcnt(0)
    v_smfmac_f32_16x16x64_bf16 v[8:11], v[156:159], a[240:247], v1
    v_smfmac_f32_16x16x64_bf16 v[12:15], v[156:159], a[248:255], v1
OP_RED1:
    s_nop 7
    v_permlane32_swap_b32 v8, v12
    v_permlane32_swap_b32 v9, v13
    v_permlane32_swap_b32 v10, v14
    v_permlane32_swap_b32 v11, v15
    v_add_f32 v8, v8, v12
    v_add_f32 v9, v9, v13
    v_add_f32 v10, v10, v14
    v_add_f32 v11, v11, v15
    ds_write2st64_b32 v3, v8, v9 offset0:16 offset1:20
    ds_write2st64_b32 v3, v10, v11 offset0:24 offset1:28
    s_waitcnt lgkmcnt(0)
    s_barrier
    ds_read2st64_b32 v[16:17], v161 offset0:16 offset1:17
    ds_read2st64_b32 v[18:19], v161 offset0:18 offset1:19
    s_waitcnt lgkmcnt(0)
    v_add_f32 v16, v16, v17
    v_add_f32 v18, v18, v19
    v_add_f32 v16, v16, v18
    s_nop 1
    v_mov_b32_dpp v17, v16 quad_perm:[1,0,3,2] row_mask:0xf bank_mask:0xf
    v_cvt_pk_bf16_f32 v16, v16, v17
    buffer_store_dword v16, v4, s[40:43], s56 offen sc1
OP_NEXT1:
    s_lshr_b32 s51, s61, 2
    s_add_u32 s56, s56, s51
    s_cmp_lt_u32 s50, s59
    s_cbranch_scc1 OP_LOOP
    s_cmp_eq_u32 s50, 62
    s_cbranch_scc1 OP_LAST
    s_cmp_lg_u32 s50, 0
    s_cbranch_scc1 OP_END
OP_S62:
    s_mov_b32 s50, 62
    s_mov_b32 s59, 63
    s_mov_b32 s58, 0
    s_add_u32 s55, s55, 16252928
    s_add_u32 s56, s56, 4063232
    s_branch OP_LOOP
OP_END:
    s_waitcnt vmcnt(0)
    s_endpgm
OP_LAST:
    s_barrier
    s_add_u32 s55, s55, 262144
    s_add_u32 s56, s56, 65536
    s_mov_b32 s54, 0
    v_lshrrev_b32 v16, 6, v0
    v_lshlrev_b32 v16, 10, v16
    v_bfe_u32 v17, v0, 5, 1
    v_lshl_add_u32 v16, v17, 7, v16
    v_bfe_u32 v17, v0, 4, 1
    v_lshl_add_u32 v16, v17, 9, v16
    v_or_b32 v16, 1664, v16
OP_L1:
    buffer_load_dword v17, v16, s[36:39], s55 offen offset:320 sc1
    s_add_u32 s54, s54, 1
    s_cmp_gt_u32 s54, 65536
    s_cbranch_scc1 EXIT
    s_waitcnt vmcnt(0)
    v_cmp_eq_u32 vcc, -1, v17
    s_cbranch_vccnz OP_L1
    s_add_u32 s51, s55, 0
    buffer_load_dwordx4 v[96:99], v0, s[36:39], s51 offen offset:0 sc1
    buffer_load_dwordx4 v[100:103], v0, s[36:39], s51 offen offset:1024 sc1
    buffer_load_dwordx4 v[104:107], v0, s[36:39], s51 offen offset:2048 sc1
    buffer_load_dwordx4 v[108:111], v0, s[36:39], s51 offen offset:3072 sc1
    s_add_u32 s51, s55, 4096
    buffer_load_dwordx4 v[112:115], v0, s[36:39], s51 offen offset:0 sc1
    buffer_load_dwordx4 v[116:119], v0, s[36:39], s51 offen offset:1024 sc1
    buffer_load_dwordx4 v[120:123], v0, s[36:39], s51 offen offset:2048 sc1
    buffer_load_dwordx4 v[124:127], v0, s[36:39], s51 offen offset:3072 sc1
    s_add_u32 s51, s55, 8192
    buffer_load_dwordx4 v[128:131], v0, s[36:39], s51 offen offset:0 sc1
    buffer_load_dwordx4 v[132:135], v0, s[36:39], s51 offen offset:1024 sc1
    buffer_load_dwordx4 v[136:139], v0, s[36:39], s51 offen offset:2048 sc1
    buffer_load_dwordx4 v[140:143], v0, s[36:39], s51 offen offset:3072 sc1
    s_add_u32 s51, s55, 12288
    buffer_load_dwordx4 v[144:147], v0, s[36:39], s51 offen offset:0 sc1
    buffer_load_dwordx4 v[148:151], v0, s[36:39], s51 offen offset:1024 sc1
    buffer_load_dwordx4 v[152:155], v0, s[36:39], s51 offen offset:2048 sc1
    buffer_load_dwordx4 v[156:159], v0, s[36:39], s51 offen offset:3072 sc1
    v_mov_b64 v[8:9], 0
    v_mov_b64 v[10:11], 0
    v_mov_b64 v[12:13], 0
    v_mov_b64 v[14:15], 0
    v_mov_b32 v17, 0
    s_waitcnt vmcnt(15)
    v_smfmac_f32_16x16x64_bf16 v[8:11], v[96:99], a[0:7], v1
    v_max3_u32 v17, v17, v96, v97
    v_smfmac_f32_16x16x64_bf16 v[12:15], v[96:99], a[8:15], v1
    v_max3_u32 v17, v17, v98, v99
    s_waitcnt vmcnt(14)
    v_smfmac_f32_16x16x64_bf16 v[8:11], v[100:103], a[16:23], v1
    v_max3_u32 v17, v17, v100, v101
    v_smfmac_f32_16x16x64_bf16 v[12:15], v[100:103], a[24:31], v1
    v_max3_u32 v17, v17, v102, v103
    s_waitcnt vmcnt(13)
    v_smfmac_f32_16x16x64_bf16 v[8:11], v[104:107], a[32:39], v1
    v_max3_u32 v17, v17, v104, v105
    v_smfmac_f32_16x16x64_bf16 v[12:15], v[104:107], a[40:47], v1
    v_max3_u32 v17, v17, v106, v107
    s_waitcnt vmcnt(12)
    v_smfmac_f32_16x16x64_bf16 v[8:11], v[108:111], a[48:55], v1
    v_max3_u32 v17, v17, v108, v109
    v_smfmac_f32_16x16x64_bf16 v[12:15], v[108:111], a[56:63], v1
    v_max3_u32 v17, v17, v110, v111
    s_waitcnt vmcnt(11)
    v_smfmac_f32_16x16x64_bf16 v[8:11], v[112:115], a[64:71], v1
    v_max3_u32 v17, v17, v112, v113
    v_smfmac_f32_16x16x64_bf16 v[12:15], v[112:115], a[72:79], v1
    v_max3_u32 v17, v17, v114, v115
    s_waitcnt vmcnt(10)
    v_smfmac_f32_16x16x64_bf16 v[8:11], v[116:119], a[80:87], v1
    v_max3_u32 v17, v17, v116, v117
    v_smfmac_f32_16x16x64_bf16 v[12:15], v[116:119], a[88:95], v1
    v_max3_u32 v17, v17, v118, v119
    s_waitcnt vmcnt(9)
    v_smfmac_f32_16x16x64_bf16 v[8:11], v[120:123], a[96:103], v1
    v_max3_u32 v17, v17, v120, v121
    v_smfmac_f32_16x16x64_bf16 v[12:15], v[120:123], a[104:111], v1
    v_max3_u32 v17, v17, v122, v123
    s_waitcnt vmcnt(8)
    v_smfmac_f32_16x16x64_bf16 v[8:11], v[124:127], a[112:119], v1
    v_max3_u32 v17, v17, v124, v125
    v_smfmac_f32_16x16x64_bf16 v[12:15], v[124:127], a[120:127], v1
    v_max3_u32 v17, v17, v126, v127
    s_waitcnt vmcnt(7)
    v_smfmac_f32_16x16x64_bf16 v[8:11], v[128:131], a[128:135], v1
    v_max3_u32 v17, v17, v128, v129
    v_smfmac_f32_16x16x64_bf16 v[12:15], v[128:131], a[136:143], v1
    v_max3_u32 v17, v17, v130, v131
    s_waitcnt vmcnt(6)
    v_smfmac_f32_16x16x64_bf16 v[8:11], v[132:135], a[144:151], v1
    v_max3_u32 v17, v17, v132, v133
    v_smfmac_f32_16x16x64_bf16 v[12:15], v[132:135], a[152:159], v1
    v_max3_u32 v17, v17, v134, v135
    s_waitcnt vmcnt(5)
    v_smfmac_f32_16x16x64_bf16 v[8:11], v[136:139], a[160:167], v1
    v_max3_u32 v17, v17, v136, v137
    v_smfmac_f32_16x16x64_bf16 v[12:15], v[136:139], a[168:175], v1
    v_max3_u32 v17, v17, v138, v139
    s_waitcnt vmcnt(4)
    v_smfmac_f32_16x16x64_bf16 v[8:11], v[140:143], a[176:183], v1
    v_max3_u32 v17, v17, v140, v141
    v_smfmac_f32_16x16x64_bf16 v[12:15], v[140:143], a[184:191], v1
    v_max3_u32 v17, v17, v142, v143
    s_waitcnt vmcnt(3)
    v_smfmac_f32_16x16x64_bf16 v[8:11], v[144:147], a[192:199], v1
    v_max3_u32 v17, v17, v144, v145
    v_smfmac_f32_16x16x64_bf16 v[12:15], v[144:147], a[200:207], v1
    v_max3_u32 v17, v17, v146, v147
    s_waitcnt vmcnt(2)
    v_smfmac_f32_16x16x64_bf16 v[8:11], v[148:151], a[208:215], v1
    v_max3_u32 v17, v17, v148, v149
    v_smfmac_f32_16x16x64_bf16 v[12:15], v[148:151], a[216:223], v1
    v_max3_u32 v17, v17, v150, v151
    s_waitcnt vmcnt(1)
    v_smfmac_f32_16x16x64_bf16 v[8:11], v[152:155], a[224:231], v1
    v_max3_u32 v17, v17, v152, v153
    v_smfmac_f32_16x16x64_bf16 v[12:15], v[152:155], a[232:239], v1
    v_max3_u32 v17, v17, v154, v155
    s_waitcnt vmcnt(0)
    v_smfmac_f32_16x16x64_bf16 v[8:11], v[156:159], a[240:247], v1
    v_max3_u32 v17, v17, v156, v157
    v_smfmac_f32_16x16x64_bf16 v[12:15], v[156:159], a[248:255], v1
    v_max3_u32 v17, v17, v158, v159
    v_cmp_eq_u32 vcc, -1, v17
    s_mov_b32 s50, 64
    s_cbranch_vccnz OP_L1
    s_branch OP_RED1
INIT:
    s_cmp_ge_u32 s45, 256
    s_cbranch_scc1 EXIT
    s_sub_u32 s48, s45, 224
    v_lshlrev_b32 v1, 4, v0
    v_mov_b64 v[4:5], -1
    v_mov_b64 v[6:7], -1
    s_mul_i32 s49, s48, 8448
    s_add_u32 s49, s49, 1048576
    buffer_store_dwordx4 v[4:7], v1, s[36:39], s49 offen sc1
    s_add_u32 s49, s49, 4096
    buffer_store_dwordx4 v[4:7], v1, s[36:39], s49 offen sc1
    v_lshlrev_b32 v2, 2, v0
    s_lshl_b32 s49, s48, 10
    s_add_u32 s50, s49, 65536
    buffer_store_dword v4, v2, s[36:39], s50 offen sc1
    s_add_u32 s50, s49, 98304
    buffer_store_dword v4, v2, s[36:39], s50 offen sc1
    s_lshl_b32 s50, s48, 14
    s_add_u32 s50, s50, 36708352
    buffer_store_dwordx4 v[4:7], v1, s[36:39], s50 offen sc1
    s_add_u32 s50, s50, 4096
    buffer_store_dwordx4 v[4:7], v1, s[36:39], s50 offen sc1
    s_add_u32 s50, s50, 4096
    buffer_store_dwordx4 v[4:7], v1, s[36:39], s50 offen sc1
    s_add_u32 s50, s50, 4096
    buffer_store_dwordx4 v[4:7], v1, s[36:39], s50 offen sc1
    s_add_u32 s50, s50, 4096
    s_lshl_b32 s50, s48, 13
    s_add_u32 s50, s50, 61603840
    buffer_store_dwordx4 v[4:7], v1, s[36:39], s50 offen sc1
    s_add_u32 s50, s50, 4096
    buffer_store_dwordx4 v[4:7], v1, s[36:39], s50 offen sc1
    s_mov_b32 s40, s16
    s_mov_b32 s41, s17
    s_mov_b32 s42, 8192
    s_mov_b32 s43, 0x20000
    s_cmp_lg_u32 s48, 1
    s_cbranch_scc1 INIT_NM
    v_bfe_u32 v8, v0, 2, 2
    v_and_b32 v9, 1, v0
    v_lshl_add_u32 v8, v8, 1, v9
    v_lshlrev_b32 v8, 10, v8
    v_lshrrev_b32 v9, 6, v0
    v_lshl_add_u32 v8, v9, 8, v8
    v_bfe_u32 v9, v0, 5, 1
    v_lshl_add_u32 v8, v9, 6, v8
    v_bfe_u32 v9, v0, 4, 1
    v_lshl_add_u32 v8, v9, 3, v8
    v_bfe_u32 v9, v0, 1, 1
    v_lshl_add_u32 v8, v9, 5, v8
    buffer_load_dwordx2 v[12:13], v8, s[40:43], 0 offen
    buffer_load_dwordx2 v[14:15], v8, s[40:43], 0 offen offset:128
    buffer_load_dwordx2 v[16:17], v8, s[40:43], 0 offen offset:16
    buffer_load_dwordx2 v[18:19], v8, s[40:43], 0 offen offset:144
    s_mov_b32 s50, 36700160
    s_mov_b32 s51, 36704256
    s_mov_b32 s52, 0x05040100
    s_mov_b32 s53, 0x07060302
    s_waitcnt vmcnt(0)
    v_perm_b32 v20, v14, v12, s52
    v_perm_b32 v21, v14, v12, s53
    v_perm_b32 v22, v15, v13, s52
    v_perm_b32 v23, v15, v13, s53
    v_perm_b32 v24, v18, v16, s52
    v_perm_b32 v25, v18, v16, s53
    v_perm_b32 v26, v19, v17, s52
    v_perm_b32 v27, v19, v17, s53
    buffer_store_dwordx4 v[20:23], v1, s[36:39], s50 offen sc1
    buffer_store_dwordx4 v[24:27], v1, s[36:39], s51 offen sc1
INIT_NM:
    v_mov_b32 v3, 0
    s_add_u32 s50, s49, 0
    buffer_store_dword v3, v2, s[36:39], s50 offen sc1
    s_waitcnt vmcnt(0)
    v_mov_b32 v4, 1
    v_mov_b32 v5, 4
    s_mov_b64 exec, 1
    global_atomic_add v5, v4, s[30:31]
    s_mov_b64 exec, -1
    s_lshl_b32 s49, s48, 15
    v_lshlrev_b32 v1, 7, v0
    s_mov_b32 s40, s14
    s_mov_b32 s41, s15
    s_mov_b32 s42, 524288
    s_mov_b32 s43, 0x20000
    buffer_load_dword v8, v1, s[40:43], s49 offen
    s_mov_b32 s40, s24
    s_mov_b32 s41, s25
    s_mov_b32 s42, 4194304
    s_mov_b32 s43, 0x20000
    buffer_load_dword v9, v1, s[40:43], s49 offen
    s_add_u32 s49, s49, 1048576
    buffer_load_dword v10, v1, s[40:43], s49 offen
    s_add_u32 s49, s49, 1048576
    buffer_load_dword v11, v1, s[40:43], s49 offen
    s_add_u32 s49, s49, 1048576
    buffer_load_dword v12, v1, s[40:43], s49 offen
    s_add_u32 s49, s49, 1048576
    s_waitcnt vmcnt(0)
    s_cmp_eq_u32 s45, 224
    s_cbranch_scc1 PA
    s_branch OP
EXIT:
    s_endpgm
.section .rodata,"a"
.p2align 6
.amdhsa_kernel concat_heads__spectral_gfnet__memory_aug_recurrent_mem_tr__prompt_kernel
  .amdhsa_next_free_vgpr 512
  .amdhsa_next_free_sgpr 102
  .amdhsa_accum_offset 256
  .amdhsa_group_segment_fixed_size 0
  .amdhsa_kernarg_size 104
  .amdhsa_user_sgpr_count 2
  .amdhsa_user_sgpr_kernarg_segment_ptr 1
  .amdhsa_system_sgpr_workgroup_id_x 1
.end_amdhsa_kernel
```
